```python
import torch

def _softmax(x, axis=-1):
    return torch.softmax(x, dim=axis)
def _gelu(x):
    return torch.nn.functional.gelu(x, approximate="tanh")
def _silu(x):
    return torch.nn.functional.silu(x)
def _sigmoid(x):
    return torch.sigmoid(x)
def _layernorm(x, axis=-1, eps=1e-5):
    m = x.mean(dim=axis, keepdim=True)
    v = x.var(dim=axis, keepdim=True, unbiased=False)
    return (x - m) / torch.sqrt(v + eps)
def _scatter_add(tgt, idx, src, axis=0):
    return tgt.clone().index_add_(axis, idx, src)
def _segment_sum(src, seg, n):
    out = torch.zeros((n,) + src.shape[1:], dtype=src.dtype)
    return out.index_add_(0, seg, src)
def _pad(x, pw):
    flat = tuple(v for pair in reversed(pw) for v in pair)
    return torch.nn.functional.pad(x, flat)

kernel_name = 'gated_mix__ssm_conv_s4d__dense_activation_mish__prompt'

def setup_inputs():

    _w = (lambda a: (lambda t: t.to(torch.bfloat16) if t.is_floating_point() else t)(torch.as_tensor(a)))
    def _A_setup():
        Bsz, L, D, N = 1, 2048, 576, 128
        return {
            "u": _w((lambda *s: torch.randn(*s, dtype=torch.bfloat16) * 0.05)(Bsz, L, D)),
            "log_A_real": _w((lambda *s: torch.randn(*s, dtype=torch.bfloat16) * 6.4)(D, N) * 0.5),
            "A_imag": _w((lambda *s: torch.randn(*s, dtype=torch.bfloat16) * 0.05)(D, N) * 3.14),
            "C_real": _w((lambda *s: torch.randn(*s, dtype=torch.bfloat16) * 0.1)(D, N) / N ** 0.5),
            "C_imag": _w((lambda *s: torch.randn(*s, dtype=torch.bfloat16) * 0.1)(D, N) / N ** 0.5),
            "log_dt": _w((lambda *s: torch.randn(*s, dtype=torch.bfloat16) * 0.05)(D) * 0.5 - 4.0),
            "D_skip": _w((lambda *s: torch.randn(*s, dtype=torch.bfloat16) * 0.05)(D)),
        }
    _A_in = _A_setup()

    def _B_setup():
        B, S, D, F = 1, 2048, 576, 4608
        return {
            "x": _w((lambda *s: torch.randn(*s, dtype=torch.bfloat16) * 0.05)(B, S, D)),
            "w1": _w((lambda *s: torch.randn(*s, dtype=torch.bfloat16) * 6.4)(D, F) * (D ** -0.5)),
            "b1": _w((lambda *s: torch.randn(*s, dtype=torch.bfloat16) * 0.05)(F)),
            "w2": _w((lambda *s: torch.randn(*s, dtype=torch.bfloat16) * 0.05)(F, D) * (F ** -0.5)),
        }
    _B_in = _B_setup()

    return {
        "A_u": _A_in["u"],
        "A_log_A_real": _A_in["log_A_real"],
        "A_A_imag": _A_in["A_imag"],
        "A_C_real": _A_in["C_real"],
        "A_C_imag": _A_in["C_imag"],
        "A_log_dt": _A_in["log_dt"],
        "A_D_skip": _A_in["D_skip"],
        "B_x": _B_in["x"],
        "B_w1": _B_in["w1"],
        "B_b1": _B_in["b1"],
        "B_w2": _B_in["w2"],
        "gate_w": _w((lambda *s: torch.randn(*s, dtype=torch.bfloat16) * 0.05)(576) * 16.0),
    }

def reference(A_u, A_log_A_real, A_A_imag, A_C_real, A_C_imag, A_log_dt, A_D_skip, B_x, B_w1, B_b1, B_w2, gate_w):
    def _A_ref(u, log_A_real, A_imag, C_real, C_imag, log_dt, D_skip):
        L = u.shape[1]
        dt = torch.exp(log_dt)
        A = -torch.exp(log_A_real) + 1j * A_imag
        C = (C_real + 1j * C_imag) * dt[:, None]
        pos = (lambda x, dt: x.to(dt))(torch.arange(L), log_dt.dtype)
        P = torch.exp((A * dt[:, None])[:, :, None] * pos[None, None, :])
        K = 2.0 * torch.einsum("dn,dnl->dl", C, P).real
        L2 = 2 * L
        u_t = (lambda x, *d: x.permute(*d))(u, 0, 2, 1)
        Kf = (lambda x, *a, **k: torch.fft.rfft(x.float(), *a, **k))(K, L2)
        Uf = (lambda x, *a, **k: torch.fft.rfft(x.float(), *a, **k))(u_t, L2)
        y = (lambda x, *a, **k: torch.fft.irfft(x, *a, **k).to(torch.bfloat16))(Uf * Kf[None, :, :], L2)[:, :, :L]
        y = (lambda x, *d: x.permute(*d))(y, 0, 2, 1)
        return y + u * D_skip[None, None, :]

    def _B_ref(x, w1, b1, w2):
        h = torch.einsum("bsd,df->bsf", x, w1) + b1
        sp = torch.log1p(torch.exp(-torch.abs(h))) + torch.where(h > 0, h, torch.zeros_like(h))
        act = h * torch.tanh(sp)
        return torch.einsum("bsf,fd->bsd", act, w2)

    x = A_u
    g = _sigmoid((x * gate_w).sum(-1, keepdims=True))
    a = _A_ref(x, A_log_A_real, A_A_imag, A_C_real, A_C_imag, A_log_dt, A_D_skip)
    b = _B_ref(x, B_w1, B_b1, B_w2)
    return g * a + (1 - g) * b
```

```asm
; @launch kernel=main_kernel grid=(256,1,1) block=(512,1,1) lds=163840
; @launch kernel=red_kernel grid=(256,1,1) block=(576,1,1) lds=0
.amdgcn_target "amdgcn-amd-amdhsa--gfx950"
.text
.globl main_kernel
.p2align 8
.type main_kernel,@function
main_kernel:
  s_cmp_ge_u32 s2, 256
  s_cbranch_scc1 L_main_end
  s_cmp_ge_u32 s2, 192
  s_cbranch_scc1 L_abr
  s_load_dwordx2 s[4:5], s[0:1], 0
  s_load_dwordx4 s[36:39], s[0:1], 64
  s_load_dwordx2 s[40:41], s[0:1], 80
  s_load_dwordx2 s[42:43], s[0:1], 112
  s_load_dwordx2 s[64:65], s[0:1], 104
  s_memrealtime s[66:67]
  v_lshrrev_b32 v13, 6, v0
  v_and_b32 v1, 63, v0
  s_and_b32 s44, s2, 7
  s_lshr_b32 s45, s2, 3
  v_readfirstlane_b32 s35, v13
  s_and_b32 s46, s44, 1
  s_lshl_b32 s46, s46, 3
  s_and_b32 s47, s45, 7
  s_add_u32 s46, s46, s47
  s_lshr_b32 s47, s44, 1
  s_mul_i32 s47, s47, 3
  s_lshr_b32 s45, s45, 3
  s_add_u32 s47, s47, s45
  s_mul_i32 s28, s47, 768
  s_mul_i32 s30, s46, 147456
  s_lshl_b32 s32, s35, 10
  v_lshrrev_b32 v14, 3, v1
  v_and_b32 v15, 7, v1
  v_lshl_add_u32 v16, v13, 3, v14
  v_lshrrev_b32 v17, 1, v14
  v_and_b32 v18, 1, v17
  v_lshlrev_b32 v18, 2, v18
  v_xor_b32 v18, v18, v15
  v_lshlrev_b32 v18, 4, v18
  v_mul_u32_u24 v4, 9216, v16
  v_add_u32 v4, v4, v18
  v_mul_u32_u24 v19, 1152, v16
  v_add_u32 v5, v19, v18
  v_and_b32 v20, 1, v13
  v_lshl_add_u32 v20, v20, 2, v17
  v_xor_b32 v20, v20, v15
  v_lshl_add_u32 v6, v20, 4, v19
  v_lshlrev_b32 v21, 1, v0
  s_waitcnt lgkmcnt(0)
  s_mov_b32 s12, s36
  s_mov_b32 s13, s37
  s_mov_b32 s14, 5308416
  s_mov_b32 s15, 0x20000
  s_mov_b32 s8, s4
  s_mov_b32 s9, s5
  s_mov_b32 s10, 2359296
  s_mov_b32 s11, 0x20000
  s_mov_b32 s24, s38
  s_mov_b32 s25, s39
  s_mov_b32 s26, 9216
  s_mov_b32 s27, 0x20000
  buffer_load_ushort v22, v21, s[24:27], s28 offen
  s_add_u32 s50, s45, 1
  s_cmp_ge_u32 s50, 3
  s_cselect_b32 s50, 0, s50
  s_add_u32 s51, s50, 1
  s_cmp_ge_u32 s51, 3
  s_cselect_b32 s51, 0, s51
  s_mul_i32 s33, s50, 1769472
  s_add_u32 s33, s33, s28
  s_add_u32 s6, s36, s33
  s_addc_u32 s7, s37, 0
  s_mul_i32 s33, s50, 384
  s_add_u32 s3, s30, s33
  s_mul_i32 s33, s51, 1769472
  s_add_u32 s33, s33, s28
  s_add_u32 s26, s36, s33
  s_addc_u32 s27, s37, 0
  s_mul_i32 s33, s51, 384
  s_add_u32 s25, s30, s33
  s_mul_i32 s33, s45, 1769472
  s_add_u32 s33, s33, s28
  s_add_u32 s76, s36, s33
  s_addc_u32 s77, s37, 0
  s_mul_i32 s33, s45, 384
  s_add_u32 s30, s30, s33
  s_add_u32 m0, s32, 0
  s_add_u32 s74, s76, 0
  s_addc_u32 s75, s77, 0
  global_load_lds_dwordx4 v4, s[74:75]
  s_add_u32 m0, s32, 73728
  s_add_u32 s33, s30, 0
  buffer_load_dwordx4 v6, s[8:11], s33 offen lds
  s_add_u32 m0, s32, 81920
  s_add_u32 s33, s30, 73728
  buffer_load_dwordx4 v6, s[8:11], s33 offen lds
  s_add_u32 m0, s32, 8192
  s_add_u32 s74, s76, 589824
  s_addc_u32 s75, s77, 0
  global_load_lds_dwordx4 v4, s[74:75]
  s_add_u32 m0, s32, 90112
  s_add_u32 s33, s30, 128
  buffer_load_dwordx4 v6, s[8:11], s33 offen lds
  s_add_u32 m0, s32, 98304
  s_add_u32 s33, s30, 73856
  buffer_load_dwordx4 v6, s[8:11], s33 offen lds
  s_add_u32 m0, s32, 16384
  s_add_u32 s74, s76, 1179648
  s_addc_u32 s75, s77, 0
  global_load_lds_dwordx4 v4, s[74:75]
  s_add_u32 m0, s32, 106496
  s_add_u32 s33, s30, 256
  buffer_load_dwordx4 v6, s[8:11], s33 offen lds
  s_add_u32 m0, s32, 114688
  s_add_u32 s33, s30, 73984
  buffer_load_dwordx4 v6, s[8:11], s33 offen lds
  s_cmp_ge_u32 s35, 2
  s_cbranch_scc1 L_st_done
  s_and_b32 s33, s46, 7
  s_lshl_b32 s49, s35, 3
  s_add_u32 s33, s33, s49
  s_add_u32 s33, s33, 3
  s_min_u32 s33, s33, 17
  s_cmp_ge_u32 s33, 9
  s_cselect_b32 s49, 128, 0
  s_cselect_b32 s50, 9, 0
  s_sub_u32 s33, s33, s50
  s_mul_i32 s50, s45, 3
  s_add_u32 s33, s33, s50
  s_cmp_ge_u32 s33, 9
  s_cselect_b32 s50, 9, 0
  s_sub_u32 s33, s33, s50
  s_mul_i32 s33, s33, 589824
  s_add_u32 s33, s33, s49
  s_add_u32 s33, s33, s28
  v_mul_u32_u24 v23, 9216, v1
  buffer_load_dword v24, v23, s[12:15], s33 offen
L_st_done:
  s_getpc_b64 s[48:49]
L_mlp_pc:
  v_lshlrev_b32 v23, 7, v0
  v_min_u32 v30, L_abr-L_mlp_pc, v23
  global_load_dword v24, v30, s[48:49]
  s_mov_b32 s16, s40
  s_mov_b32 s17, s41
  s_mov_b32 s18, 5308416
  s_mov_b32 s19, 0x20000
  s_mov_b32 s20, s42
  s_mov_b32 s21, s43
  s_mov_b32 s22, 268435456
  s_mov_b32 s23, 0x20000
  s_mul_i32 s29, s47, 442368
  s_lshr_b32 s31, s47, 1
  s_lshl_b32 s31, s31, 4
  s_add_u32 s31, s31, s46
  s_mul_i32 s31, s31, 147456
  s_and_b32 s33, s47, 1
  s_mul_i32 s49, s33, 640
  s_add_u32 s52, s29, s49
  s_sub_u32 s53, s29, s49
  s_mul_i32 s49, s33, 20480
  s_add_u32 s54, s31, s49
  s_sub_u32 s55, s31, s49
  s_mul_i32 s49, s33, 14155776
  s_add_u32 s56, s31, s49
  s_lshl_b32 s57, s47, 4
  s_add_u32 s57, s57, s46
  s_lshl_b32 s57, s57, 7
  s_add_u32 s57, s57, 41943040
  s_xor_b32 s58, s57, 2048
  v_lshlrev_b32 v29, 2, v1
  v_mov_b32 v31, 0
  s_cmp_eq_u32 s35, 0
  s_cselect_b32 exec_lo, -1, 0
  s_mov_b32 exec_hi, 0
  buffer_store_dword v31, v29, s[20:23], s57 offen sc0 sc1
  s_mov_b64 exec, -1
  s_mov_b32 s60, s64
  s_mov_b32 s61, s65
  s_mov_b32 s62, 256
  s_mov_b32 s63, 0x20000
  v_mov_b32 v31, 0
  s_mov_b32 s69, 0
  s_cmp_eq_u32 s35, 0
  s_cselect_b64 s[70:71], 1, 0
  s_or_b32 s33, s2, s35
  s_cmp_lg_u32 s33, 0
  s_cbranch_scc1 L_nononce
  s_or_b32 s66, s66, 1
  s_andn2_b32 s66, s66, 2
  v_mov_b32 v30, s66
  buffer_store_dword v30, v31, s[60:63], 0 offen sc0 sc1
L_nononce:
  s_add_u32 s78, s40, s52
  s_addc_u32 s79, s41, 0
  s_add_u32 s80, s40, s29
  s_addc_u32 s81, s41, 0
  s_add_u32 s82, s40, s53
  s_addc_u32 s83, s41, 0
  s_add_u32 s33, s55, 20480
  s_add_u32 s84, s42, s54
  s_addc_u32 s85, s43, 0
  s_add_u32 s86, s42, s56
  s_addc_u32 s87, s43, 0
  s_add_u32 s72, s42, s33
  s_addc_u32 s73, s43, 0
  s_mov_b32 s34, 1069066811
  s_mov_b32 s68, 0xffff0000
  v_lshrrev_b32 v14, 5, v1
  v_bfe_u32 v15, v1, 2, 2
  v_bfe_u32 v16, v1, 4, 1
  v_lshlrev_b32 v16, 5, v16
  v_and_b32 v17, 3, v1
  v_lshl_add_u32 v16, v17, 3, v16
  v_lshrrev_b32 v17, 2, v13
  v_lshrrev_b32 v18, 1, v15
  v_xor_b32 v18, v18, v17
  v_lshl_add_u32 v16, v18, 6, v16
  v_lshl_add_u32 v18, v14, 3, v15
  v_lshl_add_u32 v2, v18, 7, v16
  v_add_u32 v7, 65536, v2
  v_lshl_add_u32 v18, v14, 2, v15
  v_lshl_add_u32 v3, v18, 7, v16
  v_add_u32 v28, 65536, v3
  v_and_b32 v18, 3, v13
  v_lshlrev_b32 v8, 12, v18
  v_lshl_add_u32 v8, v1, 4, v8
  v_add_u32 v9, 73728, v8
  v_add_u32 v25, 139264, v8
  v_lshl_add_u32 v10, v17, 11, v9
  v_lshl_add_u32 v26, v17, 11, v25
  v_lshl_add_u32 v27, v17, 11, v8
  v_lshlrev_b32 v11, 7, v17
  v_lshl_add_u32 v11, v14, 4, v11
  v_add_u32 v11, 155648, v11
  v_mul_u32_u24 v12, 36864, v18
  v_lshl_add_u32 v12, v1, 4, v12
  v_lshl_add_u32 v12, v17, 11, v12
  v_and_b32 v19, 31, v1
  v_lshl_add_u32 v19, v18, 5, v19
  v_bfe_u32 v20, v19, 1, 3
  v_xor_b32 v20, v20, v14
  v_lshlrev_b32 v20, 4, v20
  v_lshl_add_u32 v20, v19, 7, v20
  v_add_u32 v64, 73728, v20
  v_xor_b32 v65, 32, v64
  v_xor_b32 v66, 64, v64
  v_xor_b32 v67, 96, v64
  v_add_u32 v68, 65536, v64
  v_add_u32 v69, 65536, v65
  v_add_u32 v70, 65536, v66
  v_add_u32 v71, 65536, v67
  s_waitcnt vmcnt(11)
  v_lshlrev_b32 v22, 16, v22
  v_lshlrev_b32 v21, 2, v0
  v_add_u32 v21, 155648, v21
  v_cmp_gt_u32 vcc, 384, v0
  s_nop 3
  s_and_saveexec_b64 s[50:51], vcc
  ds_write_b32 v21, v22
  s_mov_b64 exec, s[50:51]
  v_add_u32 v21, 131072, v3
  s_mov_b32 s24, 0
  s_waitcnt vmcnt(8) lgkmcnt(0)
  s_barrier
  ds_read_b128 a[0:3], v64 offset:0
  ds_read_b64_tr_b16 a[144:145], v2 offset:0
  ds_read_b64_tr_b16 a[146:147], v2 offset:512
  ds_read_b128 a[4:7], v65 offset:0
  ds_read_b64_tr_b16 a[148:149], v2 offset:2048
  ds_read_b64_tr_b16 a[150:151], v2 offset:2560
  ds_read_b128 v[32:35], v11 offset:0
  ds_read_b128 v[36:39], v11 offset:32
  ds_read_b128 v[40:43], v11 offset:64
  ds_read_b128 v[44:47], v11 offset:96
  .p2align 3
  s_waitcnt lgkmcnt(0)
  v_mfma_f32_32x32x16_bf16 v[32:47], a[144:147], a[0:3], v[32:47]
  ds_read_b128 a[8:11], v66 offset:0
  ds_read_b64_tr_b16 a[152:153], v2 offset:4096
  ds_read_b64_tr_b16 a[154:155], v2 offset:4608
  s_add_u32 m0, s32, 24576
  s_add_u32 s74, s6, 0
  s_addc_u32 s75, s7, 0
  global_load_lds_dwordx4 v4, s[74:75]
  v_mfma_f32_32x32x16_bf16 v[32:47], a[148:151], a[4:7], v[32:47]
  ds_read_b128 a[12:15], v67 offset:0
  ds_read_b64_tr_b16 a[156:157], v2 offset:6144
  ds_read_b64_tr_b16 a[158:159], v2 offset:6656
  s_add_u32 m0, s32, 122880
  s_add_u32 s33, s3, 0
  buffer_load_dwordx4 v6, s[8:11], s33 offen lds
  s_waitcnt vmcnt(7) lgkmcnt(3)
  v_mfma_f32_32x32x16_bf16 v[32:47], a[152:155], a[8:11], v[32:47]
  s_barrier
  ds_read_b128 a[16:19], v64 offset:16384
  ds_read_b64_tr_b16 a[144:145], v2 offset:8192
  ds_read_b64_tr_b16 a[146:147], v2 offset:8704
  s_waitcnt lgkmcnt(3)
  v_mfma_f32_32x32x16_bf16 v[32:47], a[156:159], a[12:15], v[32:47]
  ds_read_b128 a[20:23], v65 offset:16384
  ds_read_b64_tr_b16 a[148:149], v2 offset:10240
  ds_read_b64_tr_b16 a[150:151], v2 offset:10752
  s_add_u32 m0, s32, 131072
  s_add_u32 s33, s3, 73728
  buffer_load_dwordx4 v6, s[8:11], s33 offen lds
  s_waitcnt lgkmcnt(3)
  v_mfma_f32_32x32x16_bf16 v[32:47], a[144:147], a[16:19], v[32:47]
  ds_read_b128 a[24:27], v66 offset:16384
  ds_read_b64_tr_b16 a[152:153], v2 offset:12288
  ds_read_b64_tr_b16 a[154:155], v2 offset:12800
  s_add_u32 m0, s32, 32768
  s_add_u32 s74, s6, 589824
  s_addc_u32 s75, s7, 0
  global_load_lds_dwordx4 v4, s[74:75]
  s_waitcnt lgkmcnt(3)
  v_mfma_f32_32x32x16_bf16 v[32:47], a[148:151], a[20:23], v[32:47]
  ds_read_b128 a[28:31], v67 offset:16384
  ds_read_b64_tr_b16 a[156:157], v2 offset:14336
  ds_read_b64_tr_b16 a[158:159], v2 offset:14848
  s_add_u32 m0, s32, 139264
  s_add_u32 s33, s3, 128
  buffer_load_dwordx4 v6, s[8:11], s33 offen lds
  s_waitcnt vmcnt(7) lgkmcnt(3)
  v_mfma_f32_32x32x16_bf16 v[32:47], a[152:155], a[24:27], v[32:47]
  s_barrier
  ds_read_b128 a[32:35], v64 offset:32768
  ds_read_b64_tr_b16 a[144:145], v2 offset:16384
  ds_read_b64_tr_b16 a[146:147], v2 offset:16896
  s_waitcnt lgkmcnt(3)
  v_mfma_f32_32x32x16_bf16 v[32:47], a[156:159], a[28:31], v[32:47]
  ds_read_b128 a[36:39], v65 offset:32768
  ds_read_b64_tr_b16 a[148:149], v2 offset:18432
  ds_read_b64_tr_b16 a[150:151], v2 offset:18944
  s_add_u32 m0, s32, 147456
  s_add_u32 s33, s3, 73856
  buffer_load_dwordx4 v6, s[8:11], s33 offen lds
  s_waitcnt lgkmcnt(3)
  v_mfma_f32_32x32x16_bf16 v[32:47], a[144:147], a[32:35], v[32:47]
  ds_read_b128 a[40:43], v66 offset:32768
  ds_read_b64_tr_b16 a[152:153], v2 offset:20480
  ds_read_b64_tr_b16 a[154:155], v2 offset:20992
  s_add_u32 m0, s32, 40960
  s_add_u32 s74, s6, 1179648
  s_addc_u32 s75, s7, 0
  global_load_lds_dwordx4 v4, s[74:75]
  s_waitcnt lgkmcnt(3)
  v_mfma_f32_32x32x16_bf16 v[32:47], a[148:151], a[36:39], v[32:47]
  ds_read_b128 a[44:47], v67 offset:32768
  ds_read_b64_tr_b16 a[156:157], v2 offset:22528
  ds_read_b64_tr_b16 a[158:159], v2 offset:23040
  s_add_u32 m0, s32, 73728
  s_add_u32 s33, s3, 256
  buffer_load_dwordx4 v6, s[8:11], s33 offen lds
  s_waitcnt vmcnt(5) lgkmcnt(3)
  v_mfma_f32_32x32x16_bf16 v[32:47], a[152:155], a[40:43], v[32:47]
  s_barrier
  ds_read_b128 a[48:51], v64 offset:49152
  ds_read_b64_tr_b16 a[144:145], v2 offset:24576
  ds_read_b64_tr_b16 a[146:147], v2 offset:25088
  s_waitcnt lgkmcnt(3)
  v_mfma_f32_32x32x16_bf16 v[32:47], a[156:159], a[44:47], v[32:47]
  ds_read_b128 a[52:55], v65 offset:49152
  ds_read_b64_tr_b16 a[148:149], v2 offset:26624
  ds_read_b64_tr_b16 a[150:151], v2 offset:27136
  s_add_u32 m0, s32, 81920
  s_add_u32 s33, s3, 73984
  buffer_load_dwordx4 v6, s[8:11], s33 offen lds
  s_waitcnt lgkmcnt(3)
  v_mfma_f32_32x32x16_bf16 v[32:47], a[144:147], a[48:51], v[32:47]
  ds_read_b128 a[56:59], v66 offset:49152
  ds_read_b64_tr_b16 a[152:153], v2 offset:28672
  ds_read_b64_tr_b16 a[154:155], v2 offset:29184
  s_add_u32 m0, s32, 49152
  s_add_u32 s74, s26, 0
  s_addc_u32 s75, s27, 0
  global_load_lds_dwordx4 v4, s[74:75]
  s_waitcnt lgkmcnt(3)
  v_mfma_f32_32x32x16_bf16 v[32:47], a[148:151], a[52:55], v[32:47]
  ds_read_b128 a[60:63], v67 offset:49152
  ds_read_b64_tr_b16 a[156:157], v2 offset:30720
  ds_read_b64_tr_b16 a[158:159], v2 offset:31232
  s_add_u32 m0, s32, 90112
  s_add_u32 s33, s25, 0
  buffer_load_dwordx4 v6, s[8:11], s33 offen lds
  s_waitcnt vmcnt(5) lgkmcnt(3)
  v_mfma_f32_32x32x16_bf16 v[32:47], a[152:155], a[56:59], v[32:47]
  s_barrier
  ds_read_b128 a[64:67], v68 offset:0
  ds_read_b64_tr_b16 a[144:145], v2 offset:32768
  ds_read_b64_tr_b16 a[146:147], v2 offset:33280
  s_waitcnt lgkmcnt(3)
  v_mfma_f32_32x32x16_bf16 v[32:47], a[156:159], a[60:63], v[32:47]
  ds_read_b128 a[68:71], v69 offset:0
  ds_read_b64_tr_b16 a[148:149], v2 offset:34816
  ds_read_b64_tr_b16 a[150:151], v2 offset:35328
  s_add_u32 m0, s32, 98304
  s_add_u32 s33, s25, 73728
  buffer_load_dwordx4 v6, s[8:11], s33 offen lds
  s_waitcnt lgkmcnt(3)
  v_mfma_f32_32x32x16_bf16 v[32:47], a[144:147], a[64:67], v[32:47]
  ds_read_b128 a[72:75], v70 offset:0
  ds_read_b64_tr_b16 a[152:153], v2 offset:36864
  ds_read_b64_tr_b16 a[154:155], v2 offset:37376
  s_add_u32 m0, s32, 57344
  s_add_u32 s74, s26, 589824
  s_addc_u32 s75, s27, 0
  global_load_lds_dwordx4 v4, s[74:75]
  s_waitcnt lgkmcnt(3)
  v_mfma_f32_32x32x16_bf16 v[32:47], a[148:151], a[68:71], v[32:47]
  ds_read_b128 a[76:79], v71 offset:0
  ds_read_b64_tr_b16 a[156:157], v2 offset:38912
  ds_read_b64_tr_b16 a[158:159], v2 offset:39424
  s_add_u32 m0, s32, 106496
  s_add_u32 s33, s25, 128
  buffer_load_dwordx4 v6, s[8:11], s33 offen lds
  s_waitcnt vmcnt(5) lgkmcnt(3)
  v_mfma_f32_32x32x16_bf16 v[32:47], a[152:155], a[72:75], v[32:47]
  s_barrier
  ds_read_b128 a[80:83], v64 offset:0
  ds_read_b64_tr_b16 a[144:145], v2 offset:40960
  ds_read_b64_tr_b16 a[146:147], v2 offset:41472
  s_waitcnt lgkmcnt(3)
  v_mfma_f32_32x32x16_bf16 v[32:47], a[156:159], a[76:79], v[32:47]
  ds_read_b128 a[84:87], v65 offset:0
  ds_read_b64_tr_b16 a[148:149], v2 offset:43008
  ds_read_b64_tr_b16 a[150:151], v2 offset:43520
  s_add_u32 m0, s32, 114688
  s_add_u32 s33, s25, 73856
  buffer_load_dwordx4 v6, s[8:11], s33 offen lds
  s_waitcnt lgkmcnt(3)
  v_mfma_f32_32x32x16_bf16 v[32:47], a[144:147], a[80:83], v[32:47]
  ds_read_b128 a[88:91], v66 offset:0
  ds_read_b64_tr_b16 a[152:153], v2 offset:45056
  ds_read_b64_tr_b16 a[154:155], v2 offset:45568
  s_add_u32 m0, s32, 65536
  s_add_u32 s74, s26, 1179648
  s_addc_u32 s75, s27, 0
  global_load_lds_dwordx4 v4, s[74:75]
  s_waitcnt lgkmcnt(3)
  v_mfma_f32_32x32x16_bf16 v[32:47], a[148:151], a[84:87], v[32:47]
  ds_read_b128 a[92:95], v67 offset:0
  ds_read_b64_tr_b16 a[156:157], v2 offset:47104
  ds_read_b64_tr_b16 a[158:159], v2 offset:47616
  s_add_u32 m0, s32, 122880
  s_add_u32 s33, s25, 256
  buffer_load_dwordx4 v6, s[8:11], s33 offen lds
  s_waitcnt vmcnt(5) lgkmcnt(3)
  v_mfma_f32_32x32x16_bf16 v[32:47], a[152:155], a[88:91], v[32:47]
  s_barrier
  ds_read_b128 a[96:99], v64 offset:16384
  ds_read_b64_tr_b16 a[144:145], v2 offset:49152
  ds_read_b64_tr_b16 a[146:147], v2 offset:49664
  s_waitcnt lgkmcnt(3)
  v_mfma_f32_32x32x16_bf16 v[32:47], a[156:159], a[92:95], v[32:47]
  ds_read_b128 a[100:103], v65 offset:16384
  ds_read_b64_tr_b16 a[148:149], v2 offset:51200
  ds_read_b64_tr_b16 a[150:151], v2 offset:51712
  s_add_u32 m0, s32, 131072
  s_add_u32 s33, s25, 73984
  buffer_load_dwordx4 v6, s[8:11], s33 offen lds
  s_waitcnt lgkmcnt(3)
  v_mfma_f32_32x32x16_bf16 v[32:47], a[144:147], a[96:99], v[32:47]
  ds_read_b128 a[104:107], v66 offset:16384
  ds_read_b64_tr_b16 a[152:153], v2 offset:53248
  ds_read_b64_tr_b16 a[154:155], v2 offset:53760
  s_add_u32 m0, s32, 0
  s_add_u32 s74, s76, 128
  s_addc_u32 s75, s77, 0
  global_load_lds_dwordx4 v4, s[74:75]
  s_waitcnt lgkmcnt(3)
  v_mfma_f32_32x32x16_bf16 v[32:47], a[148:151], a[100:103], v[32:47]
  ds_read_b128 a[108:111], v67 offset:16384
  ds_read_b64_tr_b16 a[156:157], v2 offset:55296
  ds_read_b64_tr_b16 a[158:159], v2 offset:55808
  s_add_u32 m0, s32, 8192
  s_add_u32 s74, s76, 589952
  s_addc_u32 s75, s77, 0
  global_load_lds_dwordx4 v4, s[74:75]
  s_waitcnt vmcnt(5) lgkmcnt(3)
  v_mfma_f32_32x32x16_bf16 v[32:47], a[152:155], a[104:107], v[32:47]
  s_barrier
  ds_read_b128 a[112:115], v64 offset:32768
  ds_read_b64_tr_b16 a[144:145], v2 offset:57344
  ds_read_b64_tr_b16 a[146:147], v2 offset:57856
  s_waitcnt lgkmcnt(3)
  v_mfma_f32_32x32x16_bf16 v[32:47], a[156:159], a[108:111], v[32:47]
  ds_read_b128 a[116:119], v65 offset:32768
  ds_read_b64_tr_b16 a[148:149], v2 offset:59392
  ds_read_b64_tr_b16 a[150:151], v2 offset:59904
  s_add_u32 m0, s32, 16384
  s_add_u32 s74, s76, 1179776
  s_addc_u32 s75, s77, 0
  global_load_lds_dwordx4 v4, s[74:75]
  s_waitcnt lgkmcnt(3)
  v_mfma_f32_32x32x16_bf16 v[32:47], a[144:147], a[112:115], v[32:47]
  ds_read_b128 a[120:123], v66 offset:32768
  ds_read_b64_tr_b16 a[152:153], v2 offset:61440
  ds_read_b64_tr_b16 a[154:155], v2 offset:61952
  ds_read_b128 v[48:51], v11 offset:256
  s_add_u32 m0, s32, 24576
  s_add_u32 s74, s6, 128
  s_addc_u32 s75, s7, 0
  global_load_lds_dwordx4 v4, s[74:75]
  s_waitcnt lgkmcnt(4)
  v_mfma_f32_32x32x16_bf16 v[32:47], a[148:151], a[116:119], v[32:47]
  ds_read_b128 a[124:127], v67 offset:32768
  ds_read_b64_tr_b16 a[156:157], v2 offset:63488
  ds_read_b64_tr_b16 a[158:159], v2 offset:64000
  ds_read_b128 v[52:55], v11 offset:288
  s_add_u32 m0, s32, 32768
  s_add_u32 s74, s6, 589952
  s_addc_u32 s75, s7, 0
  global_load_lds_dwordx4 v4, s[74:75]
  s_waitcnt vmcnt(5) lgkmcnt(5)
  v_mfma_f32_32x32x16_bf16 v[32:47], a[152:155], a[120:123], v[32:47]
  s_barrier
  ds_read_b128 a[128:131], v64 offset:49152
  ds_read_b64_tr_b16 a[144:145], v7 offset:0
  ds_read_b64_tr_b16 a[146:147], v7 offset:512
  ds_read_b128 v[56:59], v11 offset:320
  s_waitcnt lgkmcnt(5)
  v_mfma_f32_32x32x16_bf16 v[32:47], a[156:159], a[124:127], v[32:47]
  ds_read_b128 a[132:135], v65 offset:49152
  ds_read_b64_tr_b16 a[148:149], v7 offset:2048
  ds_read_b64_tr_b16 a[150:151], v7 offset:2560
  ds_read_b128 v[60:63], v11 offset:352
  s_add_u32 m0, s32, 40960
  s_add_u32 s74, s6, 1179776
  s_addc_u32 s75, s7, 0
  global_load_lds_dwordx4 v4, s[74:75]
  s_waitcnt lgkmcnt(5)
  v_mfma_f32_32x32x16_bf16 v[32:47], a[144:147], a[128:131], v[32:47]
  ds_read_b128 a[136:139], v66 offset:49152
  ds_read_b64_tr_b16 a[152:153], v7 offset:4096
  ds_read_b64_tr_b16 a[154:155], v7 offset:4608
  s_add_u32 m0, s32, 49152
  s_add_u32 s74, s26, 128
  s_addc_u32 s75, s27, 0
  global_load_lds_dwordx4 v4, s[74:75]
  s_waitcnt lgkmcnt(4)
  v_mfma_f32_32x32x16_bf16 v[32:47], a[148:151], a[132:135], v[32:47]
  ds_read_b128 a[140:143], v67 offset:49152
  ds_read_b64_tr_b16 a[156:157], v7 offset:6144
  ds_read_b64_tr_b16 a[158:159], v7 offset:6656
  s_add_u32 m0, s32, 57344
  s_add_u32 s74, s26, 589952
  s_addc_u32 s75, s27, 0
  global_load_lds_dwordx4 v4, s[74:75]
  s_waitcnt vmcnt(5) lgkmcnt(3)
  v_mfma_f32_32x32x16_bf16 v[32:47], a[152:155], a[136:139], v[32:47]
  s_barrier
  ds_read_b64_tr_b16 a[144:145], v2 offset:0
  ds_read_b64_tr_b16 a[146:147], v2 offset:512
  s_waitcnt lgkmcnt(2)
  v_mfma_f32_32x32x16_bf16 v[32:47], a[156:159], a[140:143], v[32:47]
  ds_read_b64_tr_b16 a[148:149], v2 offset:2048
  ds_read_b64_tr_b16 a[150:151], v2 offset:2560
  s_add_u32 m0, s32, 65536
  s_add_u32 s74, s26, 1179776
  s_addc_u32 s75, s27, 0
  global_load_lds_dwordx4 v4, s[74:75]
  s_waitcnt lgkmcnt(2)
  v_mfma_f32_32x32x16_bf16 v[48:63], a[144:147], a[0:3], v[48:63]
  ds_read_b64_tr_b16 a[152:153], v2 offset:4096
  ds_read_b64_tr_b16 a[154:155], v2 offset:4608
  s_waitcnt lgkmcnt(2)
  v_mfma_f32_32x32x16_bf16 v[48:63], a[148:151], a[4:7], v[48:63]
  ds_read_b64_tr_b16 a[156:157], v2 offset:6144
  ds_read_b64_tr_b16 a[158:159], v2 offset:6656
  v_mul_f32_e64 v64, v32, s34
  v_mul_f32_e64 v65, v33, s34
  v_exp_f32_e64 v64, v64
  v_mul_f32_e64 v66, v34, s34
  s_waitcnt lgkmcnt(2)
  v_mfma_f32_32x32x16_bf16 v[48:63], a[152:155], a[8:11], v[48:63]
  ds_read_b64_tr_b16 a[144:145], v2 offset:8192
  ds_read_b64_tr_b16 a[146:147], v2 offset:8704
  v_exp_f32_e64 v65, v65
  v_fma_f32 v70, v64, 0.5, 1.0
  v_mul_f32_e64 v67, v35, s34
  s_waitcnt lgkmcnt(2)
  v_mfma_f32_32x32x16_bf16 v[48:63], a[156:159], a[12:15], v[48:63]
  ds_read_b64_tr_b16 a[148:149], v2 offset:10240
  ds_read_b64_tr_b16 a[150:151], v2 offset:10752
  v_exp_f32_e64 v66, v66
  v_fma_f32 v71, v65, 0.5, 1.0
  v_fma_f32 v70, v64, v70, 1.0
  s_waitcnt lgkmcnt(2)
  v_mfma_f32_32x32x16_bf16 v[48:63], a[144:147], a[16:19], v[48:63]
  ds_read_b64_tr_b16 a[152:153], v2 offset:12288
  ds_read_b64_tr_b16 a[154:155], v2 offset:12800
  v_mul_f32_e64 v68, v36, s34
  v_exp_f32_e64 v67, v67
  v_fma_f32 v72, v66, 0.5, 1.0
  s_waitcnt lgkmcnt(2)
  v_mfma_f32_32x32x16_bf16 v[48:63], a[148:151], a[20:23], v[48:63]
  ds_read_b64_tr_b16 a[156:157], v2 offset:14336
  ds_read_b64_tr_b16 a[158:159], v2 offset:14848
  v_fma_f32 v71, v65, v71, 1.0
  v_rcp_f32_e64 v70, v70
  v_mul_f32_e64 v69, v37, s34
  s_waitcnt lgkmcnt(2)
  v_mfma_f32_32x32x16_bf16 v[48:63], a[152:155], a[24:27], v[48:63]
  ds_read_b64_tr_b16 a[144:145], v2 offset:16384
  ds_read_b64_tr_b16 a[146:147], v2 offset:16896
  v_exp_f32_e64 v68, v68
  v_fma_f32 v73, v67, 0.5, 1.0
  v_fma_f32 v72, v66, v72, 1.0
  s_waitcnt lgkmcnt(2)
  v_mfma_f32_32x32x16_bf16 v[48:63], a[156:159], a[28:31], v[48:63]
  ds_read_b64_tr_b16 a[148:149], v2 offset:18432
  ds_read_b64_tr_b16 a[150:151], v2 offset:18944
  v_rcp_f32_e64 v71, v71
  v_fma_f32 v70, -v32, v70, v32
  v_mul_f32_e64 v64, v38, s34
  v_exp_f32_e64 v69, v69
  s_waitcnt lgkmcnt(2)
  v_mfma_f32_32x32x16_bf16 v[48:63], a[144:147], a[32:35], v[48:63]
  ds_read_b64_tr_b16 a[152:153], v2 offset:20480
  ds_read_b64_tr_b16 a[154:155], v2 offset:20992
  v_fma_f32 v74, v68, 0.5, 1.0
  v_fma_f32 v73, v67, v73, 1.0
  v_rcp_f32_e64 v72, v72
  s_waitcnt lgkmcnt(2)
  v_mfma_f32_32x32x16_bf16 v[48:63], a[148:151], a[36:39], v[48:63]
  ds_read_b64_tr_b16 a[156:157], v2 offset:22528
  ds_read_b64_tr_b16 a[158:159], v2 offset:23040
  v_fma_f32 v71, -v33, v71, v33
  v_mul_f32_e64 v65, v39, s34
  v_exp_f32_e64 v64, v64
  s_waitcnt vmcnt(3) lgkmcnt(2)
  v_mfma_f32_32x32x16_bf16 v[48:63], a[152:155], a[40:43], v[48:63]
  s_barrier
  ds_read_b64_tr_b16 a[144:145], v2 offset:24576
  ds_read_b64_tr_b16 a[146:147], v2 offset:25088
  v_fma_f32 v75, v69, 0.5, 1.0
  v_fma_f32 v74, v68, v74, 1.0
  v_rcp_f32_e64 v73, v73
  s_waitcnt lgkmcnt(2)
  v_mfma_f32_32x32x16_bf16 v[48:63], a[156:159], a[44:47], v[48:63]
  ds_read_b64_tr_b16 a[148:149], v2 offset:26624
  ds_read_b64_tr_b16 a[150:151], v2 offset:27136
  v_fma_f32 v72, -v34, v72, v34
  v_cvt_pk_bf16_f32 v80, v70, v71
  v_mul_f32_e64 v66, v40, s34
  s_waitcnt lgkmcnt(2)
  v_mfma_f32_32x32x16_bf16 v[48:63], a[144:147], a[48:51], v[48:63]
  ds_read_b64_tr_b16 a[152:153], v2 offset:28672
  ds_read_b64_tr_b16 a[154:155], v2 offset:29184
  v_exp_f32_e64 v65, v65
  v_fma_f32 v70, v64, 0.5, 1.0
  v_fma_f32 v75, v69, v75, 1.0
  s_add_u32 m0, s32, 0
  s_add_u32 s74, s76, 256
  s_addc_u32 s75, s77, 0
  global_load_lds_dwordx4 v4, s[74:75]
  s_waitcnt lgkmcnt(2)
  v_mfma_f32_32x32x16_bf16 v[48:63], a[148:151], a[52:55], v[48:63]
  ds_read_b64_tr_b16 a[156:157], v2 offset:30720
  ds_read_b64_tr_b16 a[158:159], v2 offset:31232
  v_rcp_f32_e64 v74, v74
  v_fma_f32 v73, -v35, v73, v35
  ds_read_b128 v[32:35], v11 offset:512
  v_mul_f32_e64 v67, v41, s34
  s_waitcnt lgkmcnt(3)
  v_mfma_f32_32x32x16_bf16 v[48:63], a[152:155], a[56:59], v[48:63]
  ds_read_b64_tr_b16 a[144:145], v2 offset:32768
  ds_read_b64_tr_b16 a[146:147], v2 offset:33280
  v_exp_f32_e64 v66, v66
  v_fma_f32 v71, v65, 0.5, 1.0
  v_fma_f32 v70, v64, v70, 1.0
  v_rcp_f32_e64 v75, v75
  s_waitcnt lgkmcnt(3)
  v_mfma_f32_32x32x16_bf16 v[48:63], a[156:159], a[60:63], v[48:63]
  ds_read_b64_tr_b16 a[148:149], v2 offset:34816
  ds_read_b64_tr_b16 a[150:151], v2 offset:35328
  v_fma_f32 v74, -v36, v74, v36
  v_cvt_pk_bf16_f32 v81, v72, v73
  v_mul_f32_e64 v68, v42, s34
  s_waitcnt lgkmcnt(2)
  v_mfma_f32_32x32x16_bf16 v[48:63], a[144:147], a[64:67], v[48:63]
  ds_read_b64_tr_b16 a[152:153], v2 offset:36864
  ds_read_b64_tr_b16 a[154:155], v2 offset:37376
  v_exp_f32_e64 v67, v67
  v_fma_f32 v72, v66, 0.5, 1.0
  v_fma_f32 v71, v65, v71, 1.0
  s_add_u32 m0, s32, 8192
  s_add_u32 s74, s76, 590080
  s_addc_u32 s75, s77, 0
  global_load_lds_dwordx4 v4, s[74:75]
  s_waitcnt lgkmcnt(2)
  v_mfma_f32_32x32x16_bf16 v[48:63], a[148:151], a[68:71], v[48:63]
  ds_read_b64_tr_b16 a[156:157], v2 offset:38912
  ds_read_b64_tr_b16 a[158:159], v2 offset:39424
  v_rcp_f32_e64 v70, v70
  v_fma_f32 v75, -v37, v75, v37
  v_mul_f32_e64 v69, v43, s34
  s_waitcnt lgkmcnt(2)
  v_mfma_f32_32x32x16_bf16 v[48:63], a[152:155], a[72:75], v[48:63]
  ds_read_b64_tr_b16 a[144:145], v2 offset:40960
  ds_read_b64_tr_b16 a[146:147], v2 offset:41472
  v_exp_f32_e64 v68, v68
  v_fma_f32 v73, v67, 0.5, 1.0
  v_fma_f32 v72, v66, v72, 1.0
  s_waitcnt lgkmcnt(2)
  v_mfma_f32_32x32x16_bf16 v[48:63], a[156:159], a[76:79], v[48:63]
  ds_read_b64_tr_b16 a[148:149], v2 offset:43008
  ds_read_b64_tr_b16 a[150:151], v2 offset:43520
  v_rcp_f32_e64 v71, v71
  v_fma_f32 v70, -v38, v70, v38
  v_cvt_pk_bf16_f32 v82, v74, v75
  s_waitcnt lgkmcnt(2)
  v_mfma_f32_32x32x16_bf16 v[48:63], a[144:147], a[80:83], v[48:63]
  ds_read_b64_tr_b16 a[152:153], v2 offset:45056
  ds_read_b64_tr_b16 a[154:155], v2 offset:45568
  v_mul_f32_e64 v64, v44, s34
  v_exp_f32_e64 v69, v69
  v_fma_f32 v74, v68, 0.5, 1.0
  v_fma_f32 v73, v67, v73, 1.0
  s_add_u32 m0, s32, 16384
  s_add_u32 s74, s76, 1179904
  s_addc_u32 s75, s77, 0
  global_load_lds_dwordx4 v4, s[74:75]
  s_waitcnt lgkmcnt(2)
  v_mfma_f32_32x32x16_bf16 v[48:63], a[148:151], a[84:87], v[48:63]
  ds_read_b64_tr_b16 a[156:157], v2 offset:47104
  ds_read_b64_tr_b16 a[158:159], v2 offset:47616
  v_rcp_f32_e64 v72, v72
  v_fma_f32 v71, -v39, v71, v39
  ds_read_b128 v[36:39], v11 offset:544
  s_waitcnt vmcnt(3) lgkmcnt(3)
  v_mfma_f32_32x32x16_bf16 v[48:63], a[152:155], a[88:91], v[48:63]
  s_barrier
  ds_read_b64_tr_b16 a[144:145], v2 offset:49152
  ds_read_b64_tr_b16 a[146:147], v2 offset:49664
  v_mul_f32_e64 v65, v45, s34
  v_exp_f32_e64 v64, v64
  v_fma_f32 v75, v69, 0.5, 1.0
  v_fma_f32 v74, v68, v74, 1.0
  s_waitcnt lgkmcnt(3)
  v_mfma_f32_32x32x16_bf16 v[48:63], a[156:159], a[92:95], v[48:63]
  ds_read_b64_tr_b16 a[148:149], v2 offset:51200
  ds_read_b64_tr_b16 a[150:151], v2 offset:51712
  v_rcp_f32_e64 v73, v73
  v_fma_f32 v72, -v40, v72, v40
  v_cvt_pk_bf16_f32 v83, v70, v71
  s_waitcnt lgkmcnt(2)
  v_mfma_f32_32x32x16_bf16 v[48:63], a[144:147], a[96:99], v[48:63]
  ds_read_b64_tr_b16 a[152:153], v2 offset:53248
  ds_read_b64_tr_b16 a[154:155], v2 offset:53760
  ds_write_b128 v10, v[80:83] offset:0
  v_mul_f32_e64 v66, v46, s34
  v_exp_f32_e64 v65, v65
  v_fma_f32 v70, v64, 0.5, 1.0
  s_add_u32 m0, s32, 24576
  s_add_u32 s74, s6, 256
  s_addc_u32 s75, s7, 0
  global_load_lds_dwordx4 v4, s[74:75]
  s_waitcnt lgkmcnt(3)
  v_mfma_f32_32x32x16_bf16 v[48:63], a[148:151], a[100:103], v[48:63]
  ds_read_b64_tr_b16 a[156:157], v2 offset:55296
  ds_read_b64_tr_b16 a[158:159], v2 offset:55808
  v_fma_f32 v75, v69, v75, 1.0
  v_rcp_f32_e64 v74, v74
  v_fma_f32 v73, -v41, v73, v41
  s_waitcnt lgkmcnt(3)
  v_mfma_f32_32x32x16_bf16 v[48:63], a[152:155], a[104:107], v[48:63]
  ds_read_b64_tr_b16 a[144:145], v2 offset:57344
  ds_read_b64_tr_b16 a[146:147], v2 offset:57856
  v_mul_f32_e64 v67, v47, s34
  v_exp_f32_e64 v66, v66
  v_fma_f32 v71, v65, 0.5, 1.0
  s_waitcnt lgkmcnt(2)
  v_mfma_f32_32x32x16_bf16 v[48:63], a[156:159], a[108:111], v[48:63]
  ds_read_b64_tr_b16 a[148:149], v2 offset:59392
  ds_read_b64_tr_b16 a[150:151], v2 offset:59904
  v_fma_f32 v70, v64, v70, 1.0
  v_rcp_f32_e64 v75, v75
  v_fma_f32 v74, -v42, v74, v42
  s_waitcnt lgkmcnt(2)
  v_mfma_f32_32x32x16_bf16 v[48:63], a[144:147], a[112:115], v[48:63]
  ds_read_b64_tr_b16 a[152:153], v2 offset:61440
  ds_read_b64_tr_b16 a[154:155], v2 offset:61952
  v_cvt_pk_bf16_f32 v84, v72, v73
  v_exp_f32_e64 v67, v67
  v_fma_f32 v72, v66, 0.5, 1.0
  s_add_u32 m0, s32, 32768
  s_add_u32 s74, s6, 590080
  s_addc_u32 s75, s7, 0
  global_load_lds_dwordx4 v4, s[74:75]
  s_waitcnt lgkmcnt(2)
  v_mfma_f32_32x32x16_bf16 v[48:63], a[148:151], a[116:119], v[48:63]
  ds_read_b64_tr_b16 a[156:157], v2 offset:63488
  ds_read_b64_tr_b16 a[158:159], v2 offset:64000
  v_fma_f32 v71, v65, v71, 1.0
  v_rcp_f32_e64 v70, v70
  v_fma_f32 v75, -v43, v75, v43
  ds_read_b128 v[40:43], v11 offset:576
  s_waitcnt lgkmcnt(3)
  v_mfma_f32_32x32x16_bf16 v[48:63], a[152:155], a[120:123], v[48:63]
  ds_read_b64_tr_b16 a[144:145], v7 offset:0
  ds_read_b64_tr_b16 a[146:147], v7 offset:512
  v_fma_f32 v73, v67, 0.5, 1.0
  v_fma_f32 v72, v66, v72, 1.0
  v_rcp_f32_e64 v71, v71
  s_waitcnt lgkmcnt(3)
  v_mfma_f32_32x32x16_bf16 v[48:63], a[156:159], a[124:127], v[48:63]
  ds_read_b64_tr_b16 a[148:149], v7 offset:2048
  ds_read_b64_tr_b16 a[150:151], v7 offset:2560
  v_fma_f32 v70, -v44, v70, v44
  v_cvt_pk_bf16_f32 v85, v74, v75
  v_fma_f32 v73, v67, v73, 1.0
  v_rcp_f32_e64 v72, v72
  s_waitcnt lgkmcnt(2)
  v_mfma_f32_32x32x16_bf16 v[48:63], a[144:147], a[128:131], v[48:63]
  ds_read_b64_tr_b16 a[152:153], v7 offset:4096
  ds_read_b64_tr_b16 a[154:155], v7 offset:4608
  v_fma_f32 v71, -v45, v71, v45
  v_rcp_f32_e64 v73, v73
  v_fma_f32 v72, -v46, v72, v46
  s_add_u32 m0, s32, 40960
  s_add_u32 s74, s6, 1179904
  s_addc_u32 s75, s7, 0
  global_load_lds_dwordx4 v4, s[74:75]
  s_waitcnt lgkmcnt(2)
  v_mfma_f32_32x32x16_bf16 v[48:63], a[148:151], a[132:135], v[48:63]
  ds_read_b64_tr_b16 a[156:157], v7 offset:6144
  ds_read_b64_tr_b16 a[158:159], v7 offset:6656
  v_cvt_pk_bf16_f32 v86, v70, v71
  v_fma_f32 v73, -v47, v73, v47
  ds_read_b128 v[44:47], v11 offset:608
  v_cvt_pk_bf16_f32 v87, v72, v73
  ds_write_b128 v10, v[84:87] offset:1024
  s_waitcnt vmcnt(3) lgkmcnt(4)
  v_mfma_f32_32x32x16_bf16 v[48:63], a[152:155], a[136:139], v[48:63]
  s_barrier
  ds_read_b64_tr_b16 a[144:145], v2 offset:0
  ds_read_b64_tr_b16 a[146:147], v2 offset:512
  s_waitcnt lgkmcnt(4)
  v_mfma_f32_32x32x16_bf16 v[48:63], a[156:159], a[140:143], v[48:63]
  ds_read_b64_tr_b16 a[148:149], v2 offset:2048
  ds_read_b64_tr_b16 a[150:151], v2 offset:2560
  s_waitcnt lgkmcnt(2)
  v_mfma_f32_32x32x16_bf16 v[32:47], a[144:147], a[0:3], v[32:47]
  ds_read_b64_tr_b16 a[152:153], v2 offset:4096
  ds_read_b64_tr_b16 a[154:155], v2 offset:4608
  s_add_u32 m0, s32, 49152
  s_add_u32 s74, s26, 256
  s_addc_u32 s75, s27, 0
  global_load_lds_dwordx4 v4, s[74:75]
  s_waitcnt lgkmcnt(2)
  v_mfma_f32_32x32x16_bf16 v[32:47], a[148:151], a[4:7], v[32:47]
  ds_read_b64_tr_b16 a[156:157], v2 offset:6144
  ds_read_b64_tr_b16 a[158:159], v2 offset:6656
  v_mul_f32_e64 v64, v48, s34
  v_mul_f32_e64 v65, v49, s34
  v_exp_f32_e64 v64, v64
  v_mul_f32_e64 v66, v50, s34
  s_waitcnt lgkmcnt(2)
  v_mfma_f32_32x32x16_bf16 v[32:47], a[152:155], a[8:11], v[32:47]
  ds_read_b64_tr_b16 a[144:145], v2 offset:8192
  ds_read_b64_tr_b16 a[146:147], v2 offset:8704
  v_exp_f32_e64 v65, v65
  v_fma_f32 v70, v64, 0.5, 1.0
  v_mul_f32_e64 v67, v51, s34
  s_waitcnt lgkmcnt(2)
  v_mfma_f32_32x32x16_bf16 v[32:47], a[156:159], a[12:15], v[32:47]
  ds_read_b64_tr_b16 a[148:149], v2 offset:10240
  ds_read_b64_tr_b16 a[150:151], v2 offset:10752
  v_exp_f32_e64 v66, v66
  v_fma_f32 v71, v65, 0.5, 1.0
  v_fma_f32 v70, v64, v70, 1.0
  s_waitcnt lgkmcnt(2)
  v_mfma_f32_32x32x16_bf16 v[32:47], a[144:147], a[16:19], v[32:47]
  ds_read_b64_tr_b16 a[152:153], v2 offset:12288
  ds_read_b64_tr_b16 a[154:155], v2 offset:12800
  v_mul_f32_e64 v68, v52, s34
  v_exp_f32_e64 v67, v67
  v_fma_f32 v72, v66, 0.5, 1.0
  s_add_u32 m0, s32, 57344
  s_add_u32 s74, s26, 590080
  s_addc_u32 s75, s27, 0
  global_load_lds_dwordx4 v4, s[74:75]
  s_waitcnt lgkmcnt(2)
  v_mfma_f32_32x32x16_bf16 v[32:47], a[148:151], a[20:23], v[32:47]
  ds_read_b64_tr_b16 a[156:157], v2 offset:14336
  ds_read_b64_tr_b16 a[158:159], v2 offset:14848
  v_fma_f32 v71, v65, v71, 1.0
  v_rcp_f32_e64 v70, v70
  v_mul_f32_e64 v69, v53, s34
  s_waitcnt lgkmcnt(2)
  v_mfma_f32_32x32x16_bf16 v[32:47], a[152:155], a[24:27], v[32:47]
  ds_read_b64_tr_b16 a[144:145], v2 offset:16384
  ds_read_b64_tr_b16 a[146:147], v2 offset:16896
  v_exp_f32_e64 v68, v68
  v_fma_f32 v73, v67, 0.5, 1.0
  v_fma_f32 v72, v66, v72, 1.0
  s_waitcnt lgkmcnt(2)
  v_mfma_f32_32x32x16_bf16 v[32:47], a[156:159], a[28:31], v[32:47]
  ds_read_b64_tr_b16 a[148:149], v2 offset:18432
  ds_read_b64_tr_b16 a[150:151], v2 offset:18944
  v_rcp_f32_e64 v71, v71
  v_fma_f32 v70, -v48, v70, v48
  v_mul_f32_e64 v64, v54, s34
  v_exp_f32_e64 v69, v69
  s_waitcnt lgkmcnt(2)
  v_mfma_f32_32x32x16_bf16 v[32:47], a[144:147], a[32:35], v[32:47]
  ds_read_b64_tr_b16 a[152:153], v2 offset:20480
  ds_read_b64_tr_b16 a[154:155], v2 offset:20992
  v_fma_f32 v74, v68, 0.5, 1.0
  v_fma_f32 v73, v67, v73, 1.0
  v_rcp_f32_e64 v72, v72
  s_add_u32 m0, s32, 65536
  s_add_u32 s74, s26, 1179904
  s_addc_u32 s75, s27, 0
  global_load_lds_dwordx4 v4, s[74:75]
  s_waitcnt lgkmcnt(2)
  v_mfma_f32_32x32x16_bf16 v[32:47], a[148:151], a[36:39], v[32:47]
  ds_read_b64_tr_b16 a[156:157], v2 offset:22528
  ds_read_b64_tr_b16 a[158:159], v2 offset:23040
  v_fma_f32 v71, -v49, v71, v49
  v_mul_f32_e64 v65, v55, s34
  v_exp_f32_e64 v64, v64
  s_waitcnt vmcnt(3) lgkmcnt(2)
  v_mfma_f32_32x32x16_bf16 v[32:47], a[152:155], a[40:43], v[32:47]
  s_barrier
  ds_read_b64_tr_b16 a[144:145], v2 offset:24576
  ds_read_b64_tr_b16 a[146:147], v2 offset:25088
  v_fma_f32 v75, v69, 0.5, 1.0
  v_fma_f32 v74, v68, v74, 1.0
  v_rcp_f32_e64 v73, v73
  s_waitcnt lgkmcnt(2)
  v_mfma_f32_32x32x16_bf16 v[32:47], a[156:159], a[44:47], v[32:47]
  ds_read_b64_tr_b16 a[148:149], v2 offset:26624
  ds_read_b64_tr_b16 a[150:151], v2 offset:27136
  v_fma_f32 v72, -v50, v72, v50
  v_cvt_pk_bf16_f32 v80, v70, v71
  v_mul_f32_e64 v66, v56, s34
  s_waitcnt lgkmcnt(2)
  v_mfma_f32_32x32x16_bf16 v[32:47], a[144:147], a[48:51], v[32:47]
  ds_read_b64_tr_b16 a[152:153], v2 offset:28672
  ds_read_b64_tr_b16 a[154:155], v2 offset:29184
  v_exp_f32_e64 v65, v65
  v_fma_f32 v70, v64, 0.5, 1.0
  v_fma_f32 v75, v69, v75, 1.0
  s_add_u32 m0, s32, 0
  s_add_u32 s74, s76, 384
  s_addc_u32 s75, s77, 0
  global_load_lds_dwordx4 v4, s[74:75]
  s_waitcnt lgkmcnt(2)
  v_mfma_f32_32x32x16_bf16 v[32:47], a[148:151], a[52:55], v[32:47]
  ds_read_b64_tr_b16 a[156:157], v2 offset:30720
  ds_read_b64_tr_b16 a[158:159], v2 offset:31232
  v_rcp_f32_e64 v74, v74
  v_fma_f32 v73, -v51, v73, v51
  ds_read_b128 v[48:51], v11 offset:768
  v_mul_f32_e64 v67, v57, s34
  s_waitcnt lgkmcnt(3)
  v_mfma_f32_32x32x16_bf16 v[32:47], a[152:155], a[56:59], v[32:47]
  ds_read_b64_tr_b16 a[144:145], v2 offset:32768
  ds_read_b64_tr_b16 a[146:147], v2 offset:33280
  v_exp_f32_e64 v66, v66
  v_fma_f32 v71, v65, 0.5, 1.0
  v_fma_f32 v70, v64, v70, 1.0
  v_rcp_f32_e64 v75, v75
  s_waitcnt lgkmcnt(3)
  v_mfma_f32_32x32x16_bf16 v[32:47], a[156:159], a[60:63], v[32:47]
  ds_read_b64_tr_b16 a[148:149], v2 offset:34816
  ds_read_b64_tr_b16 a[150:151], v2 offset:35328
  v_fma_f32 v74, -v52, v74, v52
  v_cvt_pk_bf16_f32 v81, v72, v73
  v_mul_f32_e64 v68, v58, s34
  s_waitcnt lgkmcnt(2)
  v_mfma_f32_32x32x16_bf16 v[32:47], a[144:147], a[64:67], v[32:47]
  ds_read_b64_tr_b16 a[152:153], v2 offset:36864
  ds_read_b64_tr_b16 a[154:155], v2 offset:37376
  v_exp_f32_e64 v67, v67
  v_fma_f32 v72, v66, 0.5, 1.0
  v_fma_f32 v71, v65, v71, 1.0
  s_add_u32 m0, s32, 8192
  s_add_u32 s74, s76, 590208
  s_addc_u32 s75, s77, 0
  global_load_lds_dwordx4 v4, s[74:75]
  s_waitcnt lgkmcnt(2)
  v_mfma_f32_32x32x16_bf16 v[32:47], a[148:151], a[68:71], v[32:47]
  ds_read_b64_tr_b16 a[156:157], v2 offset:38912
  ds_read_b64_tr_b16 a[158:159], v2 offset:39424
  v_rcp_f32_e64 v70, v70
  v_fma_f32 v75, -v53, v75, v53
  v_mul_f32_e64 v69, v59, s34
  s_waitcnt lgkmcnt(2)
  v_mfma_f32_32x32x16_bf16 v[32:47], a[152:155], a[72:75], v[32:47]
  ds_read_b64_tr_b16 a[144:145], v2 offset:40960
  ds_read_b64_tr_b16 a[146:147], v2 offset:41472
  v_exp_f32_e64 v68, v68
  v_fma_f32 v73, v67, 0.5, 1.0
  v_fma_f32 v72, v66, v72, 1.0
  s_waitcnt lgkmcnt(2)
  v_mfma_f32_32x32x16_bf16 v[32:47], a[156:159], a[76:79], v[32:47]
  ds_read_b64_tr_b16 a[148:149], v2 offset:43008
  ds_read_b64_tr_b16 a[150:151], v2 offset:43520
  v_rcp_f32_e64 v71, v71
  v_fma_f32 v70, -v54, v70, v54
  v_cvt_pk_bf16_f32 v82, v74, v75
  s_waitcnt lgkmcnt(2)
  v_mfma_f32_32x32x16_bf16 v[32:47], a[144:147], a[80:83], v[32:47]
  ds_read_b64_tr_b16 a[152:153], v2 offset:45056
  ds_read_b64_tr_b16 a[154:155], v2 offset:45568
  v_mul_f32_e64 v64, v60, s34
  v_exp_f32_e64 v69, v69
  v_fma_f32 v74, v68, 0.5, 1.0
  v_fma_f32 v73, v67, v73, 1.0
  s_add_u32 m0, s32, 16384
  s_add_u32 s74, s76, 1180032
  s_addc_u32 s75, s77, 0
  global_load_lds_dwordx4 v4, s[74:75]
  s_waitcnt lgkmcnt(2)
  v_mfma_f32_32x32x16_bf16 v[32:47], a[148:151], a[84:87], v[32:47]
  ds_read_b64_tr_b16 a[156:157], v2 offset:47104
  ds_read_b64_tr_b16 a[158:159], v2 offset:47616
  v_rcp_f32_e64 v72, v72
  v_fma_f32 v71, -v55, v71, v55
  ds_read_b128 v[52:55], v11 offset:800
  s_waitcnt vmcnt(3) lgkmcnt(3)
  v_mfma_f32_32x32x16_bf16 v[32:47], a[152:155], a[88:91], v[32:47]
  s_barrier
  ds_read_b64_tr_b16 a[144:145], v2 offset:49152
  ds_read_b64_tr_b16 a[146:147], v2 offset:49664
  v_mul_f32_e64 v65, v61, s34
  v_exp_f32_e64 v64, v64
  v_fma_f32 v75, v69, 0.5, 1.0
  v_fma_f32 v74, v68, v74, 1.0
  s_waitcnt lgkmcnt(3)
  v_mfma_f32_32x32x16_bf16 v[32:47], a[156:159], a[92:95], v[32:47]
  ds_read_b64_tr_b16 a[148:149], v2 offset:51200
  ds_read_b64_tr_b16 a[150:151], v2 offset:51712
  v_rcp_f32_e64 v73, v73
  v_fma_f32 v72, -v56, v72, v56
  v_cvt_pk_bf16_f32 v83, v70, v71
  s_waitcnt lgkmcnt(2)
  v_mfma_f32_32x32x16_bf16 v[32:47], a[144:147], a[96:99], v[32:47]
  ds_read_b64_tr_b16 a[152:153], v2 offset:53248
  ds_read_b64_tr_b16 a[154:155], v2 offset:53760
  ds_write_b128 v10, v[80:83] offset:16384
  v_mul_f32_e64 v66, v62, s34
  v_exp_f32_e64 v65, v65
  v_fma_f32 v70, v64, 0.5, 1.0
  s_add_u32 m0, s32, 24576
  s_add_u32 s74, s6, 384
  s_addc_u32 s75, s7, 0
  global_load_lds_dwordx4 v4, s[74:75]
  s_waitcnt lgkmcnt(3)
  v_mfma_f32_32x32x16_bf16 v[32:47], a[148:151], a[100:103], v[32:47]
  ds_read_b64_tr_b16 a[156:157], v2 offset:55296
  ds_read_b64_tr_b16 a[158:159], v2 offset:55808
  v_fma_f32 v75, v69, v75, 1.0
  v_rcp_f32_e64 v74, v74
  v_fma_f32 v73, -v57, v73, v57
  s_waitcnt lgkmcnt(3)
  v_mfma_f32_32x32x16_bf16 v[32:47], a[152:155], a[104:107], v[32:47]
  ds_read_b64_tr_b16 a[144:145], v2 offset:57344
  ds_read_b64_tr_b16 a[146:147], v2 offset:57856
  v_mul_f32_e64 v67, v63, s34
  v_exp_f32_e64 v66, v66
  v_fma_f32 v71, v65, 0.5, 1.0
  s_waitcnt lgkmcnt(2)
  v_mfma_f32_32x32x16_bf16 v[32:47], a[156:159], a[108:111], v[32:47]
  ds_read_b64_tr_b16 a[148:149], v2 offset:59392
  ds_read_b64_tr_b16 a[150:151], v2 offset:59904
  v_fma_f32 v70, v64, v70, 1.0
  v_rcp_f32_e64 v75, v75
  v_fma_f32 v74, -v58, v74, v58
  s_waitcnt lgkmcnt(2)
  v_mfma_f32_32x32x16_bf16 v[32:47], a[144:147], a[112:115], v[32:47]
  ds_read_b64_tr_b16 a[152:153], v2 offset:61440
  ds_read_b64_tr_b16 a[154:155], v2 offset:61952
  v_cvt_pk_bf16_f32 v84, v72, v73
  v_exp_f32_e64 v67, v67
  v_fma_f32 v72, v66, 0.5, 1.0
  s_mov_b64 exec, 1
  buffer_load_dword v30, v31, s[60:63], 0 offen sc1
  s_mov_b64 exec, -1
  s_add_u32 m0, s32, 32768
  s_add_u32 s74, s6, 590208
  s_addc_u32 s75, s7, 0
  global_load_lds_dwordx4 v4, s[74:75]
  s_waitcnt lgkmcnt(2)
  v_mfma_f32_32x32x16_bf16 v[32:47], a[148:151], a[116:119], v[32:47]
  ds_read_b64_tr_b16 a[156:157], v2 offset:63488
  ds_read_b64_tr_b16 a[158:159], v2 offset:64000
  v_fma_f32 v71, v65, v71, 1.0
  v_rcp_f32_e64 v70, v70
  v_fma_f32 v75, -v59, v75, v59
  ds_read_b128 v[56:59], v11 offset:832
  s_waitcnt lgkmcnt(3)
  v_mfma_f32_32x32x16_bf16 v[32:47], a[152:155], a[120:123], v[32:47]
  ds_read_b64_tr_b16 a[144:145], v7 offset:0
  ds_read_b64_tr_b16 a[146:147], v7 offset:512
  v_fma_f32 v73, v67, 0.5, 1.0
  v_fma_f32 v72, v66, v72, 1.0
  v_rcp_f32_e64 v71, v71
  s_waitcnt lgkmcnt(3)
  v_mfma_f32_32x32x16_bf16 v[32:47], a[156:159], a[124:127], v[32:47]
  ds_read_b64_tr_b16 a[148:149], v7 offset:2048
  ds_read_b64_tr_b16 a[150:151], v7 offset:2560
  v_fma_f32 v70, -v60, v70, v60
  v_cvt_pk_bf16_f32 v85, v74, v75
  v_fma_f32 v73, v67, v73, 1.0
  v_rcp_f32_e64 v72, v72
  s_waitcnt lgkmcnt(2)
  v_mfma_f32_32x32x16_bf16 v[32:47], a[144:147], a[128:131], v[32:47]
  ds_read_b64_tr_b16 a[152:153], v7 offset:4096
  ds_read_b64_tr_b16 a[154:155], v7 offset:4608
  v_fma_f32 v71, -v61, v71, v61
  v_rcp_f32_e64 v73, v73
  v_fma_f32 v72, -v62, v72, v62
  s_add_u32 m0, s32, 40960
  s_add_u32 s74, s6, 1180032
  s_addc_u32 s75, s7, 0
  global_load_lds_dwordx4 v4, s[74:75]
  s_waitcnt lgkmcnt(2)
  v_mfma_f32_32x32x16_bf16 v[32:47], a[148:151], a[132:135], v[32:47]
  ds_read_b64_tr_b16 a[156:157], v7 offset:6144
  ds_read_b64_tr_b16 a[158:159], v7 offset:6656
  v_cvt_pk_bf16_f32 v86, v70, v71
  v_fma_f32 v73, -v63, v73, v63
  ds_read_b128 v[60:63], v11 offset:864
  v_cvt_pk_bf16_f32 v87, v72, v73
  ds_write_b128 v10, v[84:87] offset:17408
  s_waitcnt vmcnt(4) lgkmcnt(4)
  v_mfma_f32_32x32x16_bf16 v[32:47], a[152:155], a[136:139], v[32:47]
  s_barrier
  ds_read_b64_tr_b16 a[144:145], v2 offset:0
  ds_read_b64_tr_b16 a[146:147], v2 offset:512
  s_waitcnt lgkmcnt(4)
  v_mfma_f32_32x32x16_bf16 v[32:47], a[156:159], a[140:143], v[32:47]
  ds_read_b64_tr_b16 a[148:149], v2 offset:2048
  ds_read_b64_tr_b16 a[150:151], v2 offset:2560
  s_waitcnt lgkmcnt(2)
  v_mfma_f32_32x32x16_bf16 v[48:63], a[144:147], a[0:3], v[48:63]
  ds_read_b64_tr_b16 a[152:153], v2 offset:4096
  ds_read_b64_tr_b16 a[154:155], v2 offset:4608
  s_add_u32 m0, s32, 49152
  s_add_u32 s74, s26, 384
  s_addc_u32 s75, s27, 0
  global_load_lds_dwordx4 v4, s[74:75]
  s_waitcnt lgkmcnt(2)
  v_mfma_f32_32x32x16_bf16 v[48:63], a[148:151], a[4:7], v[48:63]
  ds_read_b64_tr_b16 a[156:157], v2 offset:6144
  ds_read_b64_tr_b16 a[158:159], v2 offset:6656
  v_mul_f32_e64 v64, v32, s34
  v_mul_f32_e64 v65, v33, s34
  v_exp_f32_e64 v64, v64
  v_mul_f32_e64 v66, v34, s34
  s_waitcnt lgkmcnt(2)
  v_mfma_f32_32x32x16_bf16 v[48:63], a[152:155], a[8:11], v[48:63]
  ds_read_b64_tr_b16 a[144:145], v2 offset:8192
  ds_read_b64_tr_b16 a[146:147], v2 offset:8704
  v_exp_f32_e64 v65, v65
  v_fma_f32 v70, v64, 0.5, 1.0
  v_mul_f32_e64 v67, v35, s34
  s_waitcnt lgkmcnt(2)
  v_mfma_f32_32x32x16_bf16 v[48:63], a[156:159], a[12:15], v[48:63]
  ds_read_b64_tr_b16 a[148:149], v2 offset:10240
  ds_read_b64_tr_b16 a[150:151], v2 offset:10752
  v_exp_f32_e64 v66, v66
  v_fma_f32 v71, v65, 0.5, 1.0
  v_fma_f32 v70, v64, v70, 1.0
  s_waitcnt lgkmcnt(2)
  v_mfma_f32_32x32x16_bf16 v[48:63], a[144:147], a[16:19], v[48:63]
  ds_read_b64_tr_b16 a[152:153], v2 offset:12288
  ds_read_b64_tr_b16 a[154:155], v2 offset:12800
  v_mul_f32_e64 v68, v36, s34
  v_exp_f32_e64 v67, v67
  v_fma_f32 v72, v66, 0.5, 1.0
  s_add_u32 m0, s32, 57344
  s_add_u32 s74, s26, 590208
  s_addc_u32 s75, s27, 0
  global_load_lds_dwordx4 v4, s[74:75]
  s_waitcnt lgkmcnt(2)
  v_mfma_f32_32x32x16_bf16 v[48:63], a[148:151], a[20:23], v[48:63]
  ds_read_b64_tr_b16 a[156:157], v2 offset:14336
  ds_read_b64_tr_b16 a[158:159], v2 offset:14848
  v_fma_f32 v71, v65, v71, 1.0
  v_rcp_f32_e64 v70, v70
  v_mul_f32_e64 v69, v37, s34
  s_waitcnt lgkmcnt(2)
  v_mfma_f32_32x32x16_bf16 v[48:63], a[152:155], a[24:27], v[48:63]
  ds_read_b64_tr_b16 a[144:145], v2 offset:16384
  ds_read_b64_tr_b16 a[146:147], v2 offset:16896
  v_exp_f32_e64 v68, v68
  v_fma_f32 v73, v67, 0.5, 1.0
  v_fma_f32 v72, v66, v72, 1.0
  s_waitcnt lgkmcnt(2)
  v_mfma_f32_32x32x16_bf16 v[48:63], a[156:159], a[28:31], v[48:63]
  ds_read_b64_tr_b16 a[148:149], v2 offset:18432
  ds_read_b64_tr_b16 a[150:151], v2 offset:18944
  v_rcp_f32_e64 v71, v71
  v_fma_f32 v70, -v32, v70, v32
  v_mul_f32_e64 v64, v38, s34
  v_exp_f32_e64 v69, v69
  s_waitcnt lgkmcnt(2)
  v_mfma_f32_32x32x16_bf16 v[48:63], a[144:147], a[32:35], v[48:63]
  ds_read_b64_tr_b16 a[152:153], v2 offset:20480
  ds_read_b64_tr_b16 a[154:155], v2 offset:20992
  v_fma_f32 v74, v68, 0.5, 1.0
  v_fma_f32 v73, v67, v73, 1.0
  v_rcp_f32_e64 v72, v72
  s_add_u32 m0, s32, 65536
  s_add_u32 s74, s26, 1180032
  s_addc_u32 s75, s27, 0
  global_load_lds_dwordx4 v4, s[74:75]
  s_waitcnt lgkmcnt(2)
  v_mfma_f32_32x32x16_bf16 v[48:63], a[148:151], a[36:39], v[48:63]
  ds_read_b64_tr_b16 a[156:157], v2 offset:22528
  ds_read_b64_tr_b16 a[158:159], v2 offset:23040
  v_fma_f32 v71, -v33, v71, v33
  v_mul_f32_e64 v65, v39, s34
  v_exp_f32_e64 v64, v64
  s_waitcnt vmcnt(3) lgkmcnt(2)
  v_mfma_f32_32x32x16_bf16 v[48:63], a[152:155], a[40:43], v[48:63]
  s_barrier
  ds_read_b64_tr_b16 a[144:145], v2 offset:24576
  ds_read_b64_tr_b16 a[146:147], v2 offset:25088
  v_fma_f32 v75, v69, 0.5, 1.0
  v_fma_f32 v74, v68, v74, 1.0
  v_rcp_f32_e64 v73, v73
  s_waitcnt lgkmcnt(2)
  v_mfma_f32_32x32x16_bf16 v[48:63], a[156:159], a[44:47], v[48:63]
  ds_read_b64_tr_b16 a[148:149], v2 offset:26624
  ds_read_b64_tr_b16 a[150:151], v2 offset:27136
  v_fma_f32 v72, -v34, v72, v34
  v_cvt_pk_bf16_f32 v80, v70, v71
  v_mul_f32_e64 v66, v40, s34
  s_waitcnt lgkmcnt(2)
  v_mfma_f32_32x32x16_bf16 v[48:63], a[144:147], a[48:51], v[48:63]
  ds_read_b64_tr_b16 a[152:153], v2 offset:28672
  ds_read_b64_tr_b16 a[154:155], v2 offset:29184
  v_exp_f32_e64 v65, v65
  v_fma_f32 v70, v64, 0.5, 1.0
  v_fma_f32 v75, v69, v75, 1.0
  s_add_u32 m0, s32, 0
  s_add_u32 s74, s76, 512
  s_addc_u32 s75, s77, 0
  global_load_lds_dwordx4 v4, s[74:75]
  s_waitcnt lgkmcnt(2)
  v_mfma_f32_32x32x16_bf16 v[48:63], a[148:151], a[52:55], v[48:63]
  ds_read_b64_tr_b16 a[156:157], v2 offset:30720
  ds_read_b64_tr_b16 a[158:159], v2 offset:31232
  v_rcp_f32_e64 v74, v74
  v_fma_f32 v73, -v35, v73, v35
  ds_read_b128 v[32:35], v11 offset:1024
  v_mul_f32_e64 v67, v41, s34
  s_waitcnt lgkmcnt(3)
  v_mfma_f32_32x32x16_bf16 v[48:63], a[152:155], a[56:59], v[48:63]
  ds_read_b64_tr_b16 a[144:145], v2 offset:32768
  ds_read_b64_tr_b16 a[146:147], v2 offset:33280
  v_exp_f32_e64 v66, v66
  v_fma_f32 v71, v65, 0.5, 1.0
  v_fma_f32 v70, v64, v70, 1.0
  v_rcp_f32_e64 v75, v75
  s_waitcnt lgkmcnt(3)
  v_mfma_f32_32x32x16_bf16 v[48:63], a[156:159], a[60:63], v[48:63]
  ds_read_b64_tr_b16 a[148:149], v2 offset:34816
  ds_read_b64_tr_b16 a[150:151], v2 offset:35328
  v_fma_f32 v74, -v36, v74, v36
  v_cvt_pk_bf16_f32 v81, v72, v73
  v_mul_f32_e64 v68, v42, s34
  s_waitcnt lgkmcnt(2)
  v_mfma_f32_32x32x16_bf16 v[48:63], a[144:147], a[64:67], v[48:63]
  ds_read_b64_tr_b16 a[152:153], v2 offset:36864
  ds_read_b64_tr_b16 a[154:155], v2 offset:37376
  v_exp_f32_e64 v67, v67
  v_fma_f32 v72, v66, 0.5, 1.0
  v_fma_f32 v71, v65, v71, 1.0
  s_add_u32 m0, s32, 8192
  s_add_u32 s74, s76, 590336
  s_addc_u32 s75, s77, 0
  global_load_lds_dwordx4 v4, s[74:75]
  s_waitcnt lgkmcnt(2)
  v_mfma_f32_32x32x16_bf16 v[48:63], a[148:151], a[68:71], v[48:63]
  ds_read_b64_tr_b16 a[156:157], v2 offset:38912
  ds_read_b64_tr_b16 a[158:159], v2 offset:39424
  v_rcp_f32_e64 v70, v70
  v_fma_f32 v75, -v37, v75, v37
  v_mul_f32_e64 v69, v43, s34
  s_waitcnt lgkmcnt(2)
  v_mfma_f32_32x32x16_bf16 v[48:63], a[152:155], a[72:75], v[48:63]
  ds_read_b64_tr_b16 a[144:145], v2 offset:40960
  ds_read_b64_tr_b16 a[146:147], v2 offset:41472
  v_exp_f32_e64 v68, v68
  v_fma_f32 v73, v67, 0.5, 1.0
  v_fma_f32 v72, v66, v72, 1.0
  s_waitcnt lgkmcnt(2)
  v_mfma_f32_32x32x16_bf16 v[48:63], a[156:159], a[76:79], v[48:63]
  ds_read_b64_tr_b16 a[148:149], v2 offset:43008
  ds_read_b64_tr_b16 a[150:151], v2 offset:43520
  v_rcp_f32_e64 v71, v71
  v_fma_f32 v70, -v38, v70, v38
  v_cvt_pk_bf16_f32 v82, v74, v75
  s_waitcnt lgkmcnt(2)
  v_mfma_f32_32x32x16_bf16 v[48:63], a[144:147], a[80:83], v[48:63]
  ds_read_b64_tr_b16 a[152:153], v2 offset:45056
  ds_read_b64_tr_b16 a[154:155], v2 offset:45568
  v_mul_f32_e64 v64, v44, s34
  v_exp_f32_e64 v69, v69
  v_fma_f32 v74, v68, 0.5, 1.0
  v_fma_f32 v73, v67, v73, 1.0
  s_add_u32 m0, s32, 16384
  s_add_u32 s74, s76, 1180160
  s_addc_u32 s75, s77, 0
  global_load_lds_dwordx4 v4, s[74:75]
  s_waitcnt lgkmcnt(2)
  v_mfma_f32_32x32x16_bf16 v[48:63], a[148:151], a[84:87], v[48:63]
  ds_read_b64_tr_b16 a[156:157], v2 offset:47104
  ds_read_b64_tr_b16 a[158:159], v2 offset:47616
  v_rcp_f32_e64 v72, v72
  v_fma_f32 v71, -v39, v71, v39
  ds_read_b128 v[36:39], v11 offset:1056
  s_waitcnt vmcnt(3) lgkmcnt(3)
  v_mfma_f32_32x32x16_bf16 v[48:63], a[152:155], a[88:91], v[48:63]
  s_barrier
  ds_read_b64_tr_b16 a[144:145], v2 offset:49152
  ds_read_b64_tr_b16 a[146:147], v2 offset:49664
  v_mul_f32_e64 v65, v45, s34
  v_exp_f32_e64 v64, v64
  v_fma_f32 v75, v69, 0.5, 1.0
  v_fma_f32 v74, v68, v74, 1.0
  v_readfirstlane_b32 s59, v30
  s_nop 3
  s_cmp_eq_u32 s59, 0
  s_cbranch_scc1 L_sn0
L_rn0:
  s_waitcnt lgkmcnt(3)
  v_mfma_f32_32x32x16_bf16 v[48:63], a[156:159], a[92:95], v[48:63]
  ds_read_b64_tr_b16 a[148:149], v2 offset:51200
  ds_read_b64_tr_b16 a[150:151], v2 offset:51712
  v_rcp_f32_e64 v73, v73
  v_fma_f32 v72, -v40, v72, v40
  v_cvt_pk_bf16_f32 v83, v70, v71
  s_waitcnt lgkmcnt(2)
  v_mfma_f32_32x32x16_bf16 v[48:63], a[144:147], a[96:99], v[48:63]
  ds_read_b64_tr_b16 a[152:153], v2 offset:53248
  ds_read_b64_tr_b16 a[154:155], v2 offset:53760
  ds_write_b128 v10, v[80:83] offset:32768
  v_mul_f32_e64 v66, v46, s34
  v_exp_f32_e64 v65, v65
  v_fma_f32 v70, v64, 0.5, 1.0
  s_add_u32 m0, s32, 24576
  s_add_u32 s74, s6, 512
  s_addc_u32 s75, s7, 0
  global_load_lds_dwordx4 v4, s[74:75]
  s_waitcnt lgkmcnt(3)
  v_mfma_f32_32x32x16_bf16 v[48:63], a[148:151], a[100:103], v[48:63]
  ds_read_b64_tr_b16 a[156:157], v2 offset:55296
  ds_read_b64_tr_b16 a[158:159], v2 offset:55808
  v_fma_f32 v75, v69, v75, 1.0
  v_rcp_f32_e64 v74, v74
  v_fma_f32 v73, -v41, v73, v41
  s_waitcnt lgkmcnt(3)
  v_mfma_f32_32x32x16_bf16 v[48:63], a[152:155], a[104:107], v[48:63]
  ds_read_b64_tr_b16 a[144:145], v2 offset:57344
  ds_read_b64_tr_b16 a[146:147], v2 offset:57856
  v_mul_f32_e64 v67, v47, s34
  v_exp_f32_e64 v66, v66
  v_fma_f32 v71, v65, 0.5, 1.0
  s_waitcnt lgkmcnt(2)
  v_mfma_f32_32x32x16_bf16 v[48:63], a[156:159], a[108:111], v[48:63]
  ds_read_b64_tr_b16 a[148:149], v2 offset:59392
  ds_read_b64_tr_b16 a[150:151], v2 offset:59904
  v_fma_f32 v70, v64, v70, 1.0
  v_rcp_f32_e64 v75, v75
  v_fma_f32 v74, -v42, v74, v42
  s_waitcnt lgkmcnt(2)
  v_mfma_f32_32x32x16_bf16 v[48:63], a[144:147], a[112:115], v[48:63]
  ds_read_b64_tr_b16 a[152:153], v2 offset:61440
  ds_read_b64_tr_b16 a[154:155], v2 offset:61952
  v_cvt_pk_bf16_f32 v84, v72, v73
  v_exp_f32_e64 v67, v67
  v_fma_f32 v72, v66, 0.5, 1.0
  s_add_u32 m0, s32, 32768
  s_add_u32 s74, s6, 590336
  s_addc_u32 s75, s7, 0
  global_load_lds_dwordx4 v4, s[74:75]
  s_waitcnt lgkmcnt(2)
  v_mfma_f32_32x32x16_bf16 v[48:63], a[148:151], a[116:119], v[48:63]
  ds_read_b64_tr_b16 a[156:157], v2 offset:63488
  ds_read_b64_tr_b16 a[158:159], v2 offset:64000
  v_fma_f32 v71, v65, v71, 1.0
  v_rcp_f32_e64 v70, v70
  v_fma_f32 v75, -v43, v75, v43
  ds_read_b128 v[40:43], v11 offset:1088
  s_waitcnt lgkmcnt(3)
  v_mfma_f32_32x32x16_bf16 v[48:63], a[152:155], a[120:123], v[48:63]
  ds_read_b64_tr_b16 a[144:145], v7 offset:0
  ds_read_b64_tr_b16 a[146:147], v7 offset:512
  v_fma_f32 v73, v67, 0.5, 1.0
  v_fma_f32 v72, v66, v72, 1.0
  v_rcp_f32_e64 v71, v71
  s_waitcnt lgkmcnt(3)
  v_mfma_f32_32x32x16_bf16 v[48:63], a[156:159], a[124:127], v[48:63]
  ds_read_b64_tr_b16 a[148:149], v7 offset:2048
  ds_read_b64_tr_b16 a[150:151], v7 offset:2560
  v_fma_f32 v70, -v44, v70, v44
  v_cvt_pk_bf16_f32 v85, v74, v75
  v_fma_f32 v73, v67, v73, 1.0
  v_rcp_f32_e64 v72, v72
  s_waitcnt lgkmcnt(2)
  v_mfma_f32_32x32x16_bf16 v[48:63], a[144:147], a[128:131], v[48:63]
  ds_read_b64_tr_b16 a[152:153], v7 offset:4096
  ds_read_b64_tr_b16 a[154:155], v7 offset:4608
  v_fma_f32 v71, -v45, v71, v45
  v_rcp_f32_e64 v73, v73
  v_fma_f32 v72, -v46, v72, v46
  s_add_u32 m0, s32, 40960
  s_add_u32 s74, s6, 1180160
  s_addc_u32 s75, s7, 0
  global_load_lds_dwordx4 v4, s[74:75]
  s_waitcnt lgkmcnt(2)
  v_mfma_f32_32x32x16_bf16 v[48:63], a[148:151], a[132:135], v[48:63]
  ds_read_b64_tr_b16 a[156:157], v7 offset:6144
  ds_read_b64_tr_b16 a[158:159], v7 offset:6656
  v_cvt_pk_bf16_f32 v86, v70, v71
  v_fma_f32 v73, -v47, v73, v47
  ds_read_b128 v[44:47], v11 offset:1120
  v_cvt_pk_bf16_f32 v87, v72, v73
  ds_write_b128 v10, v[84:87] offset:33792
  s_waitcnt vmcnt(3) lgkmcnt(4)
  v_mfma_f32_32x32x16_bf16 v[48:63], a[152:155], a[136:139], v[48:63]
  s_barrier
  ds_read_b64_tr_b16 a[144:145], v2 offset:0
  ds_read_b64_tr_b16 a[146:147], v2 offset:512
  s_waitcnt lgkmcnt(4)
  v_mfma_f32_32x32x16_bf16 v[48:63], a[156:159], a[140:143], v[48:63]
  ds_read_b64_tr_b16 a[148:149], v2 offset:2048
  ds_read_b64_tr_b16 a[150:151], v2 offset:2560
  s_waitcnt lgkmcnt(2)
  v_mfma_f32_32x32x16_bf16 v[32:47], a[144:147], a[0:3], v[32:47]
  ds_read_b64_tr_b16 a[152:153], v2 offset:4096
  ds_read_b64_tr_b16 a[154:155], v2 offset:4608
  s_add_u32 m0, s32, 49152
  s_add_u32 s74, s26, 512
  s_addc_u32 s75, s27, 0
  global_load_lds_dwordx4 v4, s[74:75]
  s_waitcnt lgkmcnt(2)
  v_mfma_f32_32x32x16_bf16 v[32:47], a[148:151], a[4:7], v[32:47]
  ds_read_b64_tr_b16 a[156:157], v2 offset:6144
  ds_read_b64_tr_b16 a[158:159], v2 offset:6656
  v_mul_f32_e64 v64, v48, s34
  v_mul_f32_e64 v65, v49, s34
  v_exp_f32_e64 v64, v64
  v_mul_f32_e64 v66, v50, s34
  s_waitcnt lgkmcnt(2)
  v_mfma_f32_32x32x16_bf16 v[32:47], a[152:155], a[8:11], v[32:47]
  ds_read_b64_tr_b16 a[144:145], v2 offset:8192
  ds_read_b64_tr_b16 a[146:147], v2 offset:8704
  v_exp_f32_e64 v65, v65
  v_fma_f32 v70, v64, 0.5, 1.0
  v_mul_f32_e64 v67, v51, s34
  s_waitcnt lgkmcnt(2)
  v_mfma_f32_32x32x16_bf16 v[32:47], a[156:159], a[12:15], v[32:47]
  ds_read_b64_tr_b16 a[148:149], v2 offset:10240
  ds_read_b64_tr_b16 a[150:151], v2 offset:10752
  v_exp_f32_e64 v66, v66
  v_fma_f32 v71, v65, 0.5, 1.0
  v_fma_f32 v70, v64, v70, 1.0
  s_waitcnt lgkmcnt(2)
  v_mfma_f32_32x32x16_bf16 v[32:47], a[144:147], a[16:19], v[32:47]
  ds_read_b64_tr_b16 a[152:153], v2 offset:12288
  ds_read_b64_tr_b16 a[154:155], v2 offset:12800
  v_mul_f32_e64 v68, v52, s34
  v_exp_f32_e64 v67, v67
  v_fma_f32 v72, v66, 0.5, 1.0
  s_add_u32 m0, s32, 57344
  s_add_u32 s74, s26, 590336
  s_addc_u32 s75, s27, 0
  global_load_lds_dwordx4 v4, s[74:75]
  s_waitcnt lgkmcnt(2)
  v_mfma_f32_32x32x16_bf16 v[32:47], a[148:151], a[20:23], v[32:47]
  ds_read_b64_tr_b16 a[156:157], v2 offset:14336
  ds_read_b64_tr_b16 a[158:159], v2 offset:14848
  v_fma_f32 v71, v65, v71, 1.0
  v_rcp_f32_e64 v70, v70
  v_mul_f32_e64 v69, v53, s34
  s_waitcnt lgkmcnt(2)
  v_mfma_f32_32x32x16_bf16 v[32:47], a[152:155], a[24:27], v[32:47]
  ds_read_b64_tr_b16 a[144:145], v2 offset:16384
  ds_read_b64_tr_b16 a[146:147], v2 offset:16896
  v_exp_f32_e64 v68, v68
  v_fma_f32 v73, v67, 0.5, 1.0
  v_fma_f32 v72, v66, v72, 1.0
  s_waitcnt lgkmcnt(2)
  v_mfma_f32_32x32x16_bf16 v[32:47], a[156:159], a[28:31], v[32:47]
  ds_read_b64_tr_b16 a[148:149], v2 offset:18432
  ds_read_b64_tr_b16 a[150:151], v2 offset:18944
  v_rcp_f32_e64 v71, v71
  v_fma_f32 v70, -v48, v70, v48
  v_mul_f32_e64 v64, v54, s34
  v_exp_f32_e64 v69, v69
  s_waitcnt lgkmcnt(2)
  v_mfma_f32_32x32x16_bf16 v[32:47], a[144:147], a[32:35], v[32:47]
  ds_read_b64_tr_b16 a[152:153], v2 offset:20480
  ds_read_b64_tr_b16 a[154:155], v2 offset:20992
  v_fma_f32 v74, v68, 0.5, 1.0
  v_fma_f32 v73, v67, v73, 1.0
  v_rcp_f32_e64 v72, v72
  s_add_u32 m0, s32, 65536
  s_add_u32 s74, s26, 1180160
  s_addc_u32 s75, s27, 0
  global_load_lds_dwordx4 v4, s[74:75]
  s_waitcnt lgkmcnt(2)
  v_mfma_f32_32x32x16_bf16 v[32:47], a[148:151], a[36:39], v[32:47]
  ds_read_b64_tr_b16 a[156:157], v2 offset:22528
  ds_read_b64_tr_b16 a[158:159], v2 offset:23040
  v_fma_f32 v71, -v49, v71, v49
  v_mul_f32_e64 v65, v55, s34
  v_exp_f32_e64 v64, v64
  s_waitcnt vmcnt(3) lgkmcnt(2)
  v_mfma_f32_32x32x16_bf16 v[32:47], a[152:155], a[40:43], v[32:47]
  s_barrier
  ds_read_b64_tr_b16 a[144:145], v2 offset:24576
  ds_read_b64_tr_b16 a[146:147], v2 offset:25088
  v_fma_f32 v75, v69, 0.5, 1.0
  v_fma_f32 v74, v68, v74, 1.0
  v_rcp_f32_e64 v73, v73
  s_waitcnt lgkmcnt(2)
  v_mfma_f32_32x32x16_bf16 v[32:47], a[156:159], a[44:47], v[32:47]
  ds_read_b64_tr_b16 a[148:149], v2 offset:26624
  ds_read_b64_tr_b16 a[150:151], v2 offset:27136
  v_fma_f32 v72, -v50, v72, v50
  v_cvt_pk_bf16_f32 v80, v70, v71
  v_mul_f32_e64 v66, v56, s34
  s_waitcnt lgkmcnt(2)
  v_mfma_f32_32x32x16_bf16 v[32:47], a[144:147], a[48:51], v[32:47]
  ds_read_b64_tr_b16 a[152:153], v2 offset:28672
  ds_read_b64_tr_b16 a[154:155], v2 offset:29184
  v_exp_f32_e64 v65, v65
  v_fma_f32 v70, v64, 0.5, 1.0
  v_fma_f32 v75, v69, v75, 1.0
  s_add_u32 m0, s32, 0
  s_add_u32 s74, s76, 640
  s_addc_u32 s75, s77, 0
  global_load_lds_dwordx4 v4, s[74:75]
  s_waitcnt lgkmcnt(2)
  v_mfma_f32_32x32x16_bf16 v[32:47], a[148:151], a[52:55], v[32:47]
  ds_read_b64_tr_b16 a[156:157], v2 offset:30720
  ds_read_b64_tr_b16 a[158:159], v2 offset:31232
  v_rcp_f32_e64 v74, v74
  v_fma_f32 v73, -v51, v73, v51
  ds_read_b128 v[48:51], v11 offset:1280
  v_mul_f32_e64 v67, v57, s34
  s_waitcnt lgkmcnt(3)
  v_mfma_f32_32x32x16_bf16 v[32:47], a[152:155], a[56:59], v[32:47]
  ds_read_b64_tr_b16 a[144:145], v2 offset:32768
  ds_read_b64_tr_b16 a[146:147], v2 offset:33280
  v_exp_f32_e64 v66, v66
  v_fma_f32 v71, v65, 0.5, 1.0
  v_fma_f32 v70, v64, v70, 1.0
  v_rcp_f32_e64 v75, v75
  s_waitcnt lgkmcnt(3)
  v_mfma_f32_32x32x16_bf16 v[32:47], a[156:159], a[60:63], v[32:47]
  ds_read_b64_tr_b16 a[148:149], v2 offset:34816
  ds_read_b64_tr_b16 a[150:151], v2 offset:35328
  v_fma_f32 v74, -v52, v74, v52
  v_cvt_pk_bf16_f32 v81, v72, v73
  v_mul_f32_e64 v68, v58, s34
  s_waitcnt lgkmcnt(2)
  v_mfma_f32_32x32x16_bf16 v[32:47], a[144:147], a[64:67], v[32:47]
  ds_read_b64_tr_b16 a[152:153], v2 offset:36864
  ds_read_b64_tr_b16 a[154:155], v2 offset:37376
  v_exp_f32_e64 v67, v67
  v_fma_f32 v72, v66, 0.5, 1.0
  v_fma_f32 v71, v65, v71, 1.0
  s_add_u32 m0, s32, 8192
  s_add_u32 s74, s76, 590464
  s_addc_u32 s75, s77, 0
  global_load_lds_dwordx4 v4, s[74:75]
  s_waitcnt lgkmcnt(2)
  v_mfma_f32_32x32x16_bf16 v[32:47], a[148:151], a[68:71], v[32:47]
  ds_read_b64_tr_b16 a[156:157], v2 offset:38912
  ds_read_b64_tr_b16 a[158:159], v2 offset:39424
  v_rcp_f32_e64 v70, v70
  v_fma_f32 v75, -v53, v75, v53
  v_mul_f32_e64 v69, v59, s34
  s_waitcnt lgkmcnt(2)
  v_mfma_f32_32x32x16_bf16 v[32:47], a[152:155], a[72:75], v[32:47]
  ds_read_b64_tr_b16 a[144:145], v2 offset:40960
  ds_read_b64_tr_b16 a[146:147], v2 offset:41472
  v_exp_f32_e64 v68, v68
  v_fma_f32 v73, v67, 0.5, 1.0
  v_fma_f32 v72, v66, v72, 1.0
  s_waitcnt lgkmcnt(2)
  v_mfma_f32_32x32x16_bf16 v[32:47], a[156:159], a[76:79], v[32:47]
  ds_read_b64_tr_b16 a[148:149], v2 offset:43008
  ds_read_b64_tr_b16 a[150:151], v2 offset:43520
  v_rcp_f32_e64 v71, v71
  v_fma_f32 v70, -v54, v70, v54
  v_cvt_pk_bf16_f32 v82, v74, v75
  s_waitcnt lgkmcnt(2)
  v_mfma_f32_32x32x16_bf16 v[32:47], a[144:147], a[80:83], v[32:47]
  ds_read_b64_tr_b16 a[152:153], v2 offset:45056
  ds_read_b64_tr_b16 a[154:155], v2 offset:45568
  v_mul_f32_e64 v64, v60, s34
  v_exp_f32_e64 v69, v69
  v_fma_f32 v74, v68, 0.5, 1.0
  v_fma_f32 v73, v67, v73, 1.0
  s_add_u32 m0, s32, 16384
  s_add_u32 s74, s76, 1180288
  s_addc_u32 s75, s77, 0
  global_load_lds_dwordx4 v4, s[74:75]
  s_waitcnt lgkmcnt(2)
  v_mfma_f32_32x32x16_bf16 v[32:47], a[148:151], a[84:87], v[32:47]
  ds_read_b64_tr_b16 a[156:157], v2 offset:47104
  ds_read_b64_tr_b16 a[158:159], v2 offset:47616
  v_rcp_f32_e64 v72, v72
  v_fma_f32 v71, -v55, v71, v55
  ds_read_b128 v[52:55], v11 offset:1312
  s_waitcnt vmcnt(3) lgkmcnt(3)
  v_mfma_f32_32x32x16_bf16 v[32:47], a[152:155], a[88:91], v[32:47]
  s_barrier
  ds_read_b64_tr_b16 a[144:145], v2 offset:49152
  ds_read_b64_tr_b16 a[146:147], v2 offset:49664
  v_mul_f32_e64 v65, v61, s34
  v_exp_f32_e64 v64, v64
  v_fma_f32 v75, v69, 0.5, 1.0
  v_fma_f32 v74, v68, v74, 1.0
  s_waitcnt lgkmcnt(3)
  v_mfma_f32_32x32x16_bf16 v[32:47], a[156:159], a[92:95], v[32:47]
  ds_read_b64_tr_b16 a[148:149], v2 offset:51200
  ds_read_b64_tr_b16 a[150:151], v2 offset:51712
  v_rcp_f32_e64 v73, v73
  v_fma_f32 v72, -v56, v72, v56
  v_cvt_pk_bf16_f32 v83, v70, v71
  s_waitcnt lgkmcnt(2)
  v_mfma_f32_32x32x16_bf16 v[32:47], a[144:147], a[96:99], v[32:47]
  ds_read_b64_tr_b16 a[152:153], v2 offset:53248
  ds_read_b64_tr_b16 a[154:155], v2 offset:53760
  ds_write_b128 v10, v[80:83] offset:49152
  v_mul_f32_e64 v66, v62, s34
  v_exp_f32_e64 v65, v65
  v_fma_f32 v70, v64, 0.5, 1.0
  s_add_u32 m0, s32, 24576
  s_add_u32 s74, s6, 640
  s_addc_u32 s75, s7, 0
  global_load_lds_dwordx4 v4, s[74:75]
  s_waitcnt lgkmcnt(3)
  v_mfma_f32_32x32x16_bf16 v[32:47], a[148:151], a[100:103], v[32:47]
  ds_read_b64_tr_b16 a[156:157], v2 offset:55296
  ds_read_b64_tr_b16 a[158:159], v2 offset:55808
  v_fma_f32 v75, v69, v75, 1.0
  v_rcp_f32_e64 v74, v74
  v_fma_f32 v73, -v57, v73, v57
  s_waitcnt lgkmcnt(3)
  v_mfma_f32_32x32x16_bf16 v[32:47], a[152:155], a[104:107], v[32:47]
  ds_read_b64_tr_b16 a[144:145], v2 offset:57344
  ds_read_b64_tr_b16 a[146:147], v2 offset:57856
  v_mul_f32_e64 v67, v63, s34
  v_exp_f32_e64 v66, v66
  v_fma_f32 v71, v65, 0.5, 1.0
  s_waitcnt lgkmcnt(2)
  v_mfma_f32_32x32x16_bf16 v[32:47], a[156:159], a[108:111], v[32:47]
  ds_read_b64_tr_b16 a[148:149], v2 offset:59392
  ds_read_b64_tr_b16 a[150:151], v2 offset:59904
  v_fma_f32 v70, v64, v70, 1.0
  v_rcp_f32_e64 v75, v75
  v_fma_f32 v74, -v58, v74, v58
  s_waitcnt lgkmcnt(2)
  v_mfma_f32_32x32x16_bf16 v[32:47], a[144:147], a[112:115], v[32:47]
  ds_read_b64_tr_b16 a[152:153], v2 offset:61440
  ds_read_b64_tr_b16 a[154:155], v2 offset:61952
  v_cvt_pk_bf16_f32 v84, v72, v73
  v_exp_f32_e64 v67, v67
  v_fma_f32 v72, v66, 0.5, 1.0
  s_add_u32 m0, s32, 32768
  s_add_u32 s74, s6, 590464
  s_addc_u32 s75, s7, 0
  global_load_lds_dwordx4 v4, s[74:75]
  s_waitcnt lgkmcnt(2)
  v_mfma_f32_32x32x16_bf16 v[32:47], a[148:151], a[116:119], v[32:47]
  ds_read_b64_tr_b16 a[156:157], v2 offset:63488
  ds_read_b64_tr_b16 a[158:159], v2 offset:64000
  v_fma_f32 v71, v65, v71, 1.0
  v_rcp_f32_e64 v70, v70
  v_fma_f32 v75, -v59, v75, v59
  ds_read_b128 v[56:59], v11 offset:1344
  s_waitcnt lgkmcnt(3)
  v_mfma_f32_32x32x16_bf16 v[32:47], a[152:155], a[120:123], v[32:47]
  ds_read_b64_tr_b16 a[144:145], v7 offset:0
  ds_read_b64_tr_b16 a[146:147], v7 offset:512
  v_fma_f32 v73, v67, 0.5, 1.0
  v_fma_f32 v72, v66, v72, 1.0
  v_rcp_f32_e64 v71, v71
  s_waitcnt lgkmcnt(3)
  v_mfma_f32_32x32x16_bf16 v[32:47], a[156:159], a[124:127], v[32:47]
  ds_read_b64_tr_b16 a[148:149], v7 offset:2048
  ds_read_b64_tr_b16 a[150:151], v7 offset:2560
  v_fma_f32 v70, -v60, v70, v60
  v_cvt_pk_bf16_f32 v85, v74, v75
  v_fma_f32 v73, v67, v73, 1.0
  v_rcp_f32_e64 v72, v72
  s_waitcnt lgkmcnt(2)
  v_mfma_f32_32x32x16_bf16 v[32:47], a[144:147], a[128:131], v[32:47]
  ds_read_b64_tr_b16 a[152:153], v7 offset:4096
  ds_read_b64_tr_b16 a[154:155], v7 offset:4608
  v_fma_f32 v71, -v61, v71, v61
  v_rcp_f32_e64 v73, v73
  v_fma_f32 v72, -v62, v72, v62
  s_add_u32 m0, s32, 40960
  s_add_u32 s74, s6, 1180288
  s_addc_u32 s75, s7, 0
  global_load_lds_dwordx4 v4, s[74:75]
  s_waitcnt lgkmcnt(2)
  v_mfma_f32_32x32x16_bf16 v[32:47], a[148:151], a[132:135], v[32:47]
  ds_read_b64_tr_b16 a[156:157], v7 offset:6144
  ds_read_b64_tr_b16 a[158:159], v7 offset:6656
  v_cvt_pk_bf16_f32 v86, v70, v71
  v_fma_f32 v73, -v63, v73, v63
  ds_read_b128 v[60:63], v11 offset:1376
  v_cvt_pk_bf16_f32 v87, v72, v73
  ds_write_b128 v10, v[84:87] offset:50176
  s_waitcnt vmcnt(3) lgkmcnt(4)
  v_mfma_f32_32x32x16_bf16 v[32:47], a[152:155], a[136:139], v[32:47]
  s_barrier
  ds_read_b64_tr_b16 a[144:145], v2 offset:0
  ds_read_b64_tr_b16 a[146:147], v2 offset:512
  s_waitcnt lgkmcnt(4)
  v_mfma_f32_32x32x16_bf16 v[32:47], a[156:159], a[140:143], v[32:47]
  ds_read_b64_tr_b16 a[148:149], v2 offset:2048
  ds_read_b64_tr_b16 a[150:151], v2 offset:2560
  s_waitcnt lgkmcnt(2)
  v_mfma_f32_32x32x16_bf16 v[48:63], a[144:147], a[0:3], v[48:63]
  ds_read_b64_tr_b16 a[152:153], v2 offset:4096
  ds_read_b64_tr_b16 a[154:155], v2 offset:4608
  s_add_u32 m0, s32, 49152
  s_add_u32 s74, s26, 640
  s_addc_u32 s75, s27, 0
  global_load_lds_dwordx4 v4, s[74:75]
  s_waitcnt lgkmcnt(2)
  v_mfma_f32_32x32x16_bf16 v[48:63], a[148:151], a[4:7], v[48:63]
  ds_read_b64_tr_b16 a[156:157], v2 offset:6144
  ds_read_b64_tr_b16 a[158:159], v2 offset:6656
  v_mul_f32_e64 v64, v32, s34
  v_mul_f32_e64 v65, v33, s34
  v_exp_f32_e64 v64, v64
  v_mul_f32_e64 v66, v34, s34
  s_waitcnt lgkmcnt(2)
  v_mfma_f32_32x32x16_bf16 v[48:63], a[152:155], a[8:11], v[48:63]
  ds_read_b64_tr_b16 a[144:145], v2 offset:8192
  ds_read_b64_tr_b16 a[146:147], v2 offset:8704
  v_exp_f32_e64 v65, v65
  v_fma_f32 v70, v64, 0.5, 1.0
  v_mul_f32_e64 v67, v35, s34
  s_waitcnt lgkmcnt(2)
  v_mfma_f32_32x32x16_bf16 v[48:63], a[156:159], a[12:15], v[48:63]
  ds_read_b64_tr_b16 a[148:149], v2 offset:10240
  ds_read_b64_tr_b16 a[150:151], v2 offset:10752
  v_exp_f32_e64 v66, v66
  v_fma_f32 v71, v65, 0.5, 1.0
  v_fma_f32 v70, v64, v70, 1.0
  s_waitcnt lgkmcnt(2)
  v_mfma_f32_32x32x16_bf16 v[48:63], a[144:147], a[16:19], v[48:63]
  ds_read_b64_tr_b16 a[152:153], v2 offset:12288
  ds_read_b64_tr_b16 a[154:155], v2 offset:12800
  v_mul_f32_e64 v68, v36, s34
  v_exp_f32_e64 v67, v67
  v_fma_f32 v72, v66, 0.5, 1.0
  s_add_u32 m0, s32, 57344
  s_add_u32 s74, s26, 590464
  s_addc_u32 s75, s27, 0
  global_load_lds_dwordx4 v4, s[74:75]
  s_waitcnt lgkmcnt(2)
  v_mfma_f32_32x32x16_bf16 v[48:63], a[148:151], a[20:23], v[48:63]
  ds_read_b64_tr_b16 a[156:157], v2 offset:14336
  ds_read_b64_tr_b16 a[158:159], v2 offset:14848
  v_fma_f32 v71, v65, v71, 1.0
  v_rcp_f32_e64 v70, v70
  v_mul_f32_e64 v69, v37, s34
  s_waitcnt lgkmcnt(2)
  v_mfma_f32_32x32x16_bf16 v[48:63], a[152:155], a[24:27], v[48:63]
  ds_read_b64_tr_b16 a[144:145], v2 offset:16384
  ds_read_b64_tr_b16 a[146:147], v2 offset:16896
  v_exp_f32_e64 v68, v68
  v_fma_f32 v73, v67, 0.5, 1.0
  v_fma_f32 v72, v66, v72, 1.0
  s_waitcnt lgkmcnt(2)
  v_mfma_f32_32x32x16_bf16 v[48:63], a[156:159], a[28:31], v[48:63]
  ds_read_b64_tr_b16 a[148:149], v2 offset:18432
  ds_read_b64_tr_b16 a[150:151], v2 offset:18944
  v_rcp_f32_e64 v71, v71
  v_fma_f32 v70, -v32, v70, v32
  v_mul_f32_e64 v64, v38, s34
  s_waitcnt lgkmcnt(2)
  v_mfma_f32_32x32x16_bf16 v[48:63], a[144:147], a[32:35], v[48:63]
  ds_read_b64_tr_b16 a[152:153], v2 offset:20480
  ds_read_b64_tr_b16 a[154:155], v2 offset:20992
  v_exp_f32_e64 v69, v69
  v_fma_f32 v74, v68, 0.5, 1.0
  v_fma_f32 v73, v67, v73, 1.0
  v_rcp_f32_e64 v72, v72
  s_add_u32 m0, s32, 65536
  s_add_u32 s74, s26, 1180288
  s_addc_u32 s75, s27, 0
  global_load_lds_dwordx4 v4, s[74:75]
  s_waitcnt lgkmcnt(2)
  v_mfma_f32_32x32x16_bf16 v[48:63], a[148:151], a[36:39], v[48:63]
  ds_read_b64_tr_b16 a[156:157], v2 offset:22528
  ds_read_b64_tr_b16 a[158:159], v2 offset:23040
  v_fma_f32 v71, -v33, v71, v33
  v_mul_f32_e64 v65, v39, s34
  v_exp_f32_e64 v64, v64
  s_waitcnt vmcnt(3) lgkmcnt(2)
  v_mfma_f32_32x32x16_bf16 v[48:63], a[152:155], a[40:43], v[48:63]
  s_barrier
  ds_read_b64_tr_b16 a[144:145], v2 offset:24576
  ds_read_b64_tr_b16 a[146:147], v2 offset:25088
  v_fma_f32 v75, v69, 0.5, 1.0
  v_fma_f32 v74, v68, v74, 1.0
  v_rcp_f32_e64 v73, v73
  s_waitcnt lgkmcnt(2)
  v_mfma_f32_32x32x16_bf16 v[48:63], a[156:159], a[44:47], v[48:63]
  ds_read_b64_tr_b16 a[148:149], v2 offset:26624
  ds_read_b64_tr_b16 a[150:151], v2 offset:27136
  v_fma_f32 v72, -v34, v72, v34
  v_cvt_pk_bf16_f32 v80, v70, v71
  v_mul_f32_e64 v66, v40, s34
  s_waitcnt lgkmcnt(2)
  v_mfma_f32_32x32x16_bf16 v[48:63], a[144:147], a[48:51], v[48:63]
  ds_read_b64_tr_b16 a[152:153], v2 offset:28672
  ds_read_b64_tr_b16 a[154:155], v2 offset:29184
  v_exp_f32_e64 v65, v65
  v_fma_f32 v70, v64, 0.5, 1.0
  v_fma_f32 v75, v69, v75, 1.0
  ds_read_b128 a[0:3], v9 offset:0
  s_add_u32 m0, s32, 0
  s_add_u32 s74, s78, 0
  s_addc_u32 s75, s79, 0
  global_load_lds_dwordx4 v5, s[74:75]
  s_waitcnt lgkmcnt(3)
  v_mfma_f32_32x32x16_bf16 v[48:63], a[148:151], a[52:55], v[48:63]
  ds_read_b64_tr_b16 a[156:157], v2 offset:30720
  ds_read_b64_tr_b16 a[158:159], v2 offset:31232
  v_rcp_f32_e64 v74, v74
  v_fma_f32 v73, -v35, v73, v35
  v_mul_f32_e64 v67, v41, s34
  ds_read_b128 a[4:7], v9 offset:1024
  s_waitcnt lgkmcnt(4)
  v_mfma_f32_32x32x16_bf16 v[48:63], a[152:155], a[56:59], v[48:63]
  ds_read_b64_tr_b16 a[144:145], v2 offset:32768
  ds_read_b64_tr_b16 a[146:147], v2 offset:33280
  v_exp_f32_e64 v66, v66
  v_fma_f32 v71, v65, 0.5, 1.0
  v_fma_f32 v70, v64, v70, 1.0
  ds_read_b128 a[8:11], v9 offset:2048
  s_waitcnt lgkmcnt(4)
  v_mfma_f32_32x32x16_bf16 v[48:63], a[156:159], a[60:63], v[48:63]
  ds_read_b64_tr_b16 a[148:149], v2 offset:34816
  ds_read_b64_tr_b16 a[150:151], v2 offset:35328
  v_rcp_f32_e64 v75, v75
  v_fma_f32 v74, -v36, v74, v36
  v_cvt_pk_bf16_f32 v81, v72, v73
  v_mul_f32_e64 v68, v42, s34
  ds_read_b128 a[12:15], v9 offset:3072
  s_waitcnt lgkmcnt(4)
  v_mfma_f32_32x32x16_bf16 v[48:63], a[144:147], a[64:67], v[48:63]
  ds_read_b64_tr_b16 a[152:153], v2 offset:36864
  ds_read_b64_tr_b16 a[154:155], v2 offset:37376
  v_exp_f32_e64 v67, v67
  v_fma_f32 v72, v66, 0.5, 1.0
  v_fma_f32 v71, v65, v71, 1.0
  ds_read_b128 a[16:19], v9 offset:16384
  s_add_u32 m0, s32, 8192
  s_add_u32 s74, s78, 73728
  s_addc_u32 s75, s79, 0
  global_load_lds_dwordx4 v5, s[74:75]
  s_waitcnt lgkmcnt(4)
  v_mfma_f32_32x32x16_bf16 v[48:63], a[148:151], a[68:71], v[48:63]
  ds_read_b64_tr_b16 a[156:157], v2 offset:38912
  ds_read_b64_tr_b16 a[158:159], v2 offset:39424
  v_rcp_f32_e64 v70, v70
  v_fma_f32 v75, -v37, v75, v37
  v_mul_f32_e64 v69, v43, s34
  ds_read_b128 a[20:23], v9 offset:17408
  s_waitcnt lgkmcnt(4)
  v_mfma_f32_32x32x16_bf16 v[48:63], a[152:155], a[72:75], v[48:63]
  ds_read_b64_tr_b16 a[144:145], v2 offset:40960
  ds_read_b64_tr_b16 a[146:147], v2 offset:41472
  v_exp_f32_e64 v68, v68
  v_fma_f32 v73, v67, 0.5, 1.0
  v_fma_f32 v72, v66, v72, 1.0
  ds_read_b128 a[24:27], v9 offset:18432
  s_waitcnt lgkmcnt(4)
  v_mfma_f32_32x32x16_bf16 v[48:63], a[156:159], a[76:79], v[48:63]
  ds_read_b64_tr_b16 a[148:149], v2 offset:43008
  ds_read_b64_tr_b16 a[150:151], v2 offset:43520
  v_rcp_f32_e64 v71, v71
  v_fma_f32 v70, -v38, v70, v38
  v_cvt_pk_bf16_f32 v82, v74, v75
  ds_read_b128 a[28:31], v9 offset:19456
  s_waitcnt lgkmcnt(4)
  v_mfma_f32_32x32x16_bf16 v[48:63], a[144:147], a[80:83], v[48:63]
  ds_read_b64_tr_b16 a[152:153], v2 offset:45056
  ds_read_b64_tr_b16 a[154:155], v2 offset:45568
  v_mul_f32_e64 v64, v44, s34
  v_exp_f32_e64 v69, v69
  v_fma_f32 v74, v68, 0.5, 1.0
  ds_read_b128 a[32:35], v9 offset:32768
  s_add_u32 m0, s32, 16384
  s_add_u32 s74, s78, 147456
  s_addc_u32 s75, s79, 0
  global_load_lds_dwordx4 v5, s[74:75]
  s_waitcnt lgkmcnt(4)
  v_mfma_f32_32x32x16_bf16 v[48:63], a[148:151], a[84:87], v[48:63]
  ds_read_b64_tr_b16 a[156:157], v2 offset:47104
  ds_read_b64_tr_b16 a[158:159], v2 offset:47616
  v_fma_f32 v73, v67, v73, 1.0
  v_rcp_f32_e64 v72, v72
  v_fma_f32 v71, -v39, v71, v39
  ds_read_b128 a[36:39], v9 offset:33792
  s_waitcnt vmcnt(3) lgkmcnt(4)
  v_mfma_f32_32x32x16_bf16 v[48:63], a[152:155], a[88:91], v[48:63]
  s_barrier
  ds_read_b64_tr_b16 a[144:145], v2 offset:49152
  ds_read_b64_tr_b16 a[146:147], v2 offset:49664
  v_mul_f32_e64 v65, v45, s34
  v_exp_f32_e64 v64, v64
  v_fma_f32 v75, v69, 0.5, 1.0
  ds_read_b128 a[40:43], v9 offset:34816
  s_waitcnt lgkmcnt(4)
  v_mfma_f32_32x32x16_bf16 v[48:63], a[156:159], a[92:95], v[48:63]
  ds_read_b64_tr_b16 a[148:149], v2 offset:51200
  ds_read_b64_tr_b16 a[150:151], v2 offset:51712
  v_fma_f32 v74, v68, v74, 1.0
  v_rcp_f32_e64 v73, v73
  v_fma_f32 v72, -v40, v72, v40
  v_cvt_pk_bf16_f32 v83, v70, v71
  ds_read_b128 a[44:47], v9 offset:35840
  s_waitcnt lgkmcnt(4)
  v_mfma_f32_32x32x16_bf16 v[48:63], a[144:147], a[96:99], v[48:63]
  ds_read_b64_tr_b16 a[152:153], v2 offset:53248
  ds_read_b64_tr_b16 a[154:155], v2 offset:53760
  ds_write_b128 v26, v[80:83] offset:0
  v_mul_f32_e64 v66, v46, s34
  v_exp_f32_e64 v65, v65
  v_fma_f32 v70, v64, 0.5, 1.0
  ds_read_b128 a[48:51], v9 offset:49152
  s_add_u32 m0, s32, 24576
  s_add_u32 s74, s78, 221184
  s_addc_u32 s75, s79, 0
  global_load_lds_dwordx4 v5, s[74:75]
  s_waitcnt lgkmcnt(5)
  v_mfma_f32_32x32x16_bf16 v[48:63], a[148:151], a[100:103], v[48:63]
  ds_read_b64_tr_b16 a[156:157], v2 offset:55296
  ds_read_b64_tr_b16 a[158:159], v2 offset:55808
  v_fma_f32 v75, v69, v75, 1.0
  v_rcp_f32_e64 v74, v74
  v_fma_f32 v73, -v41, v73, v41
  ds_read_b128 a[52:55], v9 offset:50176
  s_waitcnt lgkmcnt(5)
  v_mfma_f32_32x32x16_bf16 v[48:63], a[152:155], a[104:107], v[48:63]
  ds_read_b64_tr_b16 a[144:145], v2 offset:57344
  ds_read_b64_tr_b16 a[146:147], v2 offset:57856
  v_mul_f32_e64 v67, v47, s34
  v_exp_f32_e64 v66, v66
  v_fma_f32 v71, v65, 0.5, 1.0
  ds_read_b128 a[56:59], v9 offset:51200
  s_waitcnt lgkmcnt(4)
  v_mfma_f32_32x32x16_bf16 v[48:63], a[156:159], a[108:111], v[48:63]
  ds_read_b64_tr_b16 a[148:149], v2 offset:59392
  ds_read_b64_tr_b16 a[150:151], v2 offset:59904
  v_fma_f32 v70, v64, v70, 1.0
  v_rcp_f32_e64 v75, v75
  v_fma_f32 v74, -v42, v74, v42
  ds_read_b128 a[60:63], v9 offset:52224
  s_waitcnt lgkmcnt(4)
  v_mfma_f32_32x32x16_bf16 v[48:63], a[144:147], a[112:115], v[48:63]
  ds_read_b64_tr_b16 a[152:153], v2 offset:61440
  ds_read_b64_tr_b16 a[154:155], v2 offset:61952
  v_cvt_pk_bf16_f32 v84, v72, v73
  v_exp_f32_e64 v67, v67
  v_fma_f32 v72, v66, 0.5, 1.0
  s_add_u32 m0, s32, 32768
  s_add_u32 s74, s78, 294912
  s_addc_u32 s75, s79, 0
  global_load_lds_dwordx4 v5, s[74:75]
  s_waitcnt lgkmcnt(3)
  v_mfma_f32_32x32x16_bf16 v[48:63], a[148:151], a[116:119], v[48:63]
  ds_read_b64_tr_b16 a[156:157], v2 offset:63488
  ds_read_b64_tr_b16 a[158:159], v2 offset:64000
  v_fma_f32 v71, v65, v71, 1.0
  v_rcp_f32_e64 v70, v70
  v_fma_f32 v75, -v43, v75, v43
  s_waitcnt lgkmcnt(2)
  v_mfma_f32_32x32x16_bf16 v[48:63], a[152:155], a[120:123], v[48:63]
  ds_read_b64_tr_b16 a[144:145], v7 offset:0
  ds_read_b64_tr_b16 a[146:147], v7 offset:512
  v_fma_f32 v73, v67, 0.5, 1.0
  v_fma_f32 v72, v66, v72, 1.0
  v_rcp_f32_e64 v71, v71
  s_waitcnt lgkmcnt(2)
  v_mfma_f32_32x32x16_bf16 v[48:63], a[156:159], a[124:127], v[48:63]
  ds_read_b64_tr_b16 a[148:149], v7 offset:2048
  ds_read_b64_tr_b16 a[150:151], v7 offset:2560
  v_fma_f32 v70, -v44, v70, v44
  v_cvt_pk_bf16_f32 v85, v74, v75
  v_fma_f32 v73, v67, v73, 1.0
  v_rcp_f32_e64 v72, v72
  s_waitcnt lgkmcnt(2)
  v_mfma_f32_32x32x16_bf16 v[48:63], a[144:147], a[128:131], v[48:63]
  ds_read_b64_tr_b16 a[152:153], v7 offset:4096
  ds_read_b64_tr_b16 a[154:155], v7 offset:4608
  v_fma_f32 v71, -v45, v71, v45
  v_rcp_f32_e64 v73, v73
  v_fma_f32 v72, -v46, v72, v46
  s_add_u32 m0, s32, 40960
  s_add_u32 s74, s78, 368640
  s_addc_u32 s75, s79, 0
  global_load_lds_dwordx4 v5, s[74:75]
  s_waitcnt lgkmcnt(2)
  v_mfma_f32_32x32x16_bf16 v[48:63], a[148:151], a[132:135], v[48:63]
  ds_read_b64_tr_b16 a[156:157], v7 offset:6144
  ds_read_b64_tr_b16 a[158:159], v7 offset:6656
  v_cvt_pk_bf16_f32 v86, v70, v71
  v_fma_f32 v73, -v47, v73, v47
  v_cvt_pk_bf16_f32 v87, v72, v73
  ds_write_b128 v26, v[84:87] offset:1024
  s_waitcnt vmcnt(4) lgkmcnt(0)
  v_mfma_f32_32x32x16_bf16 v[48:63], a[152:155], a[136:139], v[48:63]
  s_barrier
  ds_read_b64_tr_b16 a[144:145], v3 offset:0
  ds_read_b64_tr_b16 a[146:147], v3 offset:1024
  v_mfma_f32_32x32x16_bf16 v[48:63], a[156:159], a[140:143], v[48:63]
  ds_read_b64_tr_b16 a[148:149], v3 offset:2048
  ds_read_b64_tr_b16 a[150:151], v3 offset:3072
  s_add_u32 m0, s32, 73728
  s_add_u32 s74, s78, 128
  s_addc_u32 s75, s79, 0
  global_load_lds_dwordx4 v5, s[74:75]
  s_waitcnt lgkmcnt(2)
  v_mfma_f32_32x32x16_bf16 v[32:47], a[144:147], a[0:3], 0
  ds_read_b64_tr_b16 a[152:153], v3 offset:4096
  ds_read_b64_tr_b16 a[154:155], v3 offset:5120
  s_add_u32 m0, s32, 81920
  s_add_u32 s74, s78, 73856
  s_addc_u32 s75, s79, 0
  global_load_lds_dwordx4 v5, s[74:75]
  s_waitcnt lgkmcnt(2)
  v_mfma_f32_32x32x16_bf16 v[32:47], a[148:151], a[4:7], v[32:47]
  ds_read_b64_tr_b16 a[156:157], v3 offset:6144
  ds_read_b64_tr_b16 a[158:159], v3 offset:7168
  v_mul_f32_e64 v64, v48, s34
  v_mul_f32_e64 v65, v49, s34
  v_exp_f32_e64 v64, v64
  v_mul_f32_e64 v66, v50, s34
  v_exp_f32_e64 v65, v65
  v_fma_f32 v70, v64, 0.5, 1.0
  v_mul_f32_e64 v67, v51, s34
  v_exp_f32_e64 v66, v66
  v_fma_f32 v71, v65, 0.5, 1.0
  s_add_u32 m0, s32, 90112
  s_add_u32 s74, s78, 147584
  s_addc_u32 s75, s79, 0
  global_load_lds_dwordx4 v5, s[74:75]
  s_waitcnt lgkmcnt(2)
  v_mfma_f32_32x32x16_bf16 v[32:47], a[152:155], a[8:11], v[32:47]
  ds_read_b64_tr_b16 a[144:145], v3 offset:8192
  ds_read_b64_tr_b16 a[146:147], v3 offset:9216
  v_fma_f32 v70, v64, v70, 1.0
  v_mul_f32_e64 v68, v52, s34
  v_exp_f32_e64 v67, v67
  v_fma_f32 v72, v66, 0.5, 1.0
  v_fma_f32 v71, v65, v71, 1.0
  v_rcp_f32_e64 v70, v70
  v_mul_f32_e64 v69, v53, s34
  v_exp_f32_e64 v68, v68
  ds_read_b128 a[64:67], v25 offset:0
  s_add_u32 m0, s32, 98304
  s_add_u32 s74, s78, 221312
  s_addc_u32 s75, s79, 0
  global_load_lds_dwordx4 v5, s[74:75]
  s_waitcnt lgkmcnt(3)
  v_mfma_f32_32x32x16_bf16 v[32:47], a[156:159], a[12:15], v[32:47]
  ds_read_b64_tr_b16 a[148:149], v3 offset:10240
  ds_read_b64_tr_b16 a[150:151], v3 offset:11264
  v_fma_f32 v73, v67, 0.5, 1.0
  v_fma_f32 v72, v66, v72, 1.0
  v_rcp_f32_e64 v71, v71
  v_fma_f32 v70, -v48, v70, v48
  v_mul_f32_e64 v64, v54, s34
  v_exp_f32_e64 v69, v69
  v_fma_f32 v74, v68, 0.5, 1.0
  v_fma_f32 v73, v67, v73, 1.0
  v_rcp_f32_e64 v72, v72
  ds_read_b128 a[68:71], v25 offset:1024
  s_add_u32 m0, s32, 106496
  s_add_u32 s74, s78, 295040
  s_addc_u32 s75, s79, 0
  global_load_lds_dwordx4 v5, s[74:75]
  s_waitcnt lgkmcnt(4)
  v_mfma_f32_32x32x16_bf16 v[32:47], a[144:147], a[16:19], v[32:47]
  ds_read_b64_tr_b16 a[152:153], v3 offset:12288
  ds_read_b64_tr_b16 a[154:155], v3 offset:13312
  v_fma_f32 v71, -v49, v71, v49
  v_mul_f32_e64 v65, v55, s34
  v_exp_f32_e64 v64, v64
  v_fma_f32 v75, v69, 0.5, 1.0
  v_fma_f32 v74, v68, v74, 1.0
  v_rcp_f32_e64 v73, v73
  v_fma_f32 v72, -v50, v72, v50
  v_cvt_pk_bf16_f32 v80, v70, v71
  v_mul_f32_e64 v66, v56, s34
  ds_read_b128 a[72:75], v25 offset:2048
  s_add_u32 m0, s32, 114688
  s_add_u32 s74, s78, 368768
  s_addc_u32 s75, s79, 0
  global_load_lds_dwordx4 v5, s[74:75]
  s_waitcnt lgkmcnt(4)
  v_mfma_f32_32x32x16_bf16 v[32:47], a[148:151], a[20:23], v[32:47]
  ds_read_b64_tr_b16 a[156:157], v3 offset:14336
  ds_read_b64_tr_b16 a[158:159], v3 offset:15360
  v_exp_f32_e64 v65, v65
  v_fma_f32 v70, v64, 0.5, 1.0
  v_fma_f32 v75, v69, v75, 1.0
  v_rcp_f32_e64 v74, v74
  v_fma_f32 v73, -v51, v73, v51
  v_mul_f32_e64 v67, v57, s34
  v_exp_f32_e64 v66, v66
  v_fma_f32 v71, v65, 0.5, 1.0
  ds_read_b128 a[76:79], v25 offset:3072
  s_waitcnt vmcnt(8) lgkmcnt(4)
  v_mfma_f32_32x32x16_bf16 v[32:47], a[152:155], a[24:27], v[32:47]
  s_barrier
  ds_read_b64_tr_b16 a[144:145], v3 offset:16384
  ds_read_b64_tr_b16 a[146:147], v3 offset:17408
  v_fma_f32 v70, v64, v70, 1.0
  v_rcp_f32_e64 v75, v75
  v_fma_f32 v74, -v52, v74, v52
  v_cvt_pk_bf16_f32 v81, v72, v73
  v_mul_f32_e64 v68, v58, s34
  v_exp_f32_e64 v67, v67
  v_fma_f32 v72, v66, 0.5, 1.0
  v_fma_f32 v71, v65, v71, 1.0
  v_rcp_f32_e64 v70, v70
  s_waitcnt lgkmcnt(3)
  v_mfma_f32_32x32x16_bf16 v[32:47], a[156:159], a[28:31], v[32:47]
  ds_read_b64_tr_b16 a[148:149], v3 offset:18432
  ds_read_b64_tr_b16 a[150:151], v3 offset:19456
  v_fma_f32 v75, -v53, v75, v53
  v_mul_f32_e64 v69, v59, s34
  v_exp_f32_e64 v68, v68
  v_fma_f32 v73, v67, 0.5, 1.0
  v_fma_f32 v72, v66, v72, 1.0
  v_rcp_f32_e64 v71, v71
  v_fma_f32 v70, -v54, v70, v54
  v_cvt_pk_bf16_f32 v82, v74, v75
  v_mul_f32_e64 v64, v60, s34
  s_waitcnt lgkmcnt(2)
  v_mfma_f32_32x32x16_bf16 v[32:47], a[144:147], a[32:35], v[32:47]
  ds_read_b64_tr_b16 a[152:153], v3 offset:20480
  ds_read_b64_tr_b16 a[154:155], v3 offset:21504
  v_exp_f32_e64 v69, v69
  v_fma_f32 v74, v68, 0.5, 1.0
  v_fma_f32 v73, v67, v73, 1.0
  v_rcp_f32_e64 v72, v72
  v_fma_f32 v71, -v55, v71, v55
  v_mul_f32_e64 v65, v61, s34
  v_exp_f32_e64 v64, v64
  v_fma_f32 v75, v69, 0.5, 1.0
  s_add_u32 m0, s32, 0
  s_add_u32 s74, s78, 256
  s_addc_u32 s75, s79, 0
  global_load_lds_dwordx4 v5, s[74:75]
  s_waitcnt lgkmcnt(2)
  v_mfma_f32_32x32x16_bf16 v[32:47], a[148:151], a[36:39], v[32:47]
  ds_read_b64_tr_b16 a[156:157], v3 offset:22528
  ds_read_b64_tr_b16 a[158:159], v3 offset:23552
  v_fma_f32 v74, v68, v74, 1.0
  v_rcp_f32_e64 v73, v73
  v_fma_f32 v72, -v56, v72, v56
  v_cvt_pk_bf16_f32 v83, v70, v71
  ds_write_b128 v27, v[80:83] offset:49152
  v_mul_f32_e64 v66, v62, s34
  v_exp_f32_e64 v65, v65
  v_fma_f32 v70, v64, 0.5, 1.0
  v_fma_f32 v75, v69, v75, 1.0
  v_rcp_f32_e64 v74, v74
  s_waitcnt lgkmcnt(3)
  v_mfma_f32_32x32x16_bf16 v[32:47], a[152:155], a[40:43], v[32:47]
  ds_read_b64_tr_b16 a[144:145], v3 offset:24576
  ds_read_b64_tr_b16 a[146:147], v3 offset:25600
  v_fma_f32 v73, -v57, v73, v57
  v_mul_f32_e64 v67, v63, s34
  v_exp_f32_e64 v66, v66
  v_fma_f32 v71, v65, 0.5, 1.0
  v_fma_f32 v70, v64, v70, 1.0
  v_rcp_f32_e64 v75, v75
  v_fma_f32 v74, -v58, v74, v58
  v_cvt_pk_bf16_f32 v84, v72, v73
  v_exp_f32_e64 v67, v67
  s_waitcnt lgkmcnt(3)
  v_mfma_f32_32x32x16_bf16 v[32:47], a[156:159], a[44:47], v[32:47]
  ds_read_b64_tr_b16 a[148:149], v3 offset:26624
  ds_read_b64_tr_b16 a[150:151], v3 offset:27648
  v_fma_f32 v72, v66, 0.5, 1.0
  v_fma_f32 v71, v65, v71, 1.0
  v_rcp_f32_e64 v70, v70
  v_fma_f32 v75, -v59, v75, v59
  v_fma_f32 v73, v67, 0.5, 1.0
  v_fma_f32 v72, v66, v72, 1.0
  v_rcp_f32_e64 v71, v71
  v_fma_f32 v70, -v60, v70, v60
  s_waitcnt lgkmcnt(2)
  v_mfma_f32_32x32x16_bf16 v[32:47], a[144:147], a[48:51], v[32:47]
  ds_read_b64_tr_b16 a[152:153], v3 offset:28672
  ds_read_b64_tr_b16 a[154:155], v3 offset:29696
  v_cvt_pk_bf16_f32 v85, v74, v75
  v_fma_f32 v73, v67, v73, 1.0
  v_rcp_f32_e64 v72, v72
  v_fma_f32 v71, -v61, v71, v61
  v_rcp_f32_e64 v73, v73
  v_fma_f32 v72, -v62, v72, v62
  v_cvt_pk_bf16_f32 v86, v70, v71
  v_fma_f32 v73, -v63, v73, v63
  v_cvt_pk_bf16_f32 v87, v72, v73
  ds_write_b128 v27, v[84:87] offset:50176
  s_add_u32 m0, s32, 8192
  s_add_u32 s74, s78, 73984
  s_addc_u32 s75, s79, 0
  global_load_lds_dwordx4 v5, s[74:75]
  s_waitcnt lgkmcnt(3)
  v_mfma_f32_32x32x16_bf16 v[32:47], a[148:151], a[52:55], v[32:47]
  ds_read_b64_tr_b16 a[156:157], v3 offset:30720
  ds_read_b64_tr_b16 a[158:159], v3 offset:31744
  s_waitcnt vmcnt(8) lgkmcnt(2)
  v_mfma_f32_32x32x16_bf16 v[32:47], a[152:155], a[56:59], v[32:47]
  s_barrier
  ds_read_b64_tr_b16 a[144:145], v3 offset:32768
  ds_read_b64_tr_b16 a[146:147], v3 offset:33792
  s_waitcnt lgkmcnt(2)
  v_mfma_f32_32x32x16_bf16 v[32:47], a[156:159], a[60:63], v[32:47]
  ds_read_b64_tr_b16 a[148:149], v3 offset:34816
  ds_read_b64_tr_b16 a[150:151], v3 offset:35840
  ds_read_b128 a[80:83], v8 offset:49152
  ds_read_b128 a[84:87], v8 offset:50176
  s_add_u32 m0, s32, 16384
  s_add_u32 s74, s78, 147712
  s_addc_u32 s75, s79, 0
  s_waitcnt lgkmcnt(4)
  v_mfma_f32_32x32x16_bf16 v[32:47], a[144:147], a[64:67], v[32:47]
  global_load_lds_dwordx4 v5, s[74:75]
  ds_read_b64_tr_b16 a[152:153], v3 offset:36864
  ds_read_b64_tr_b16 a[154:155], v3 offset:37888
  ds_read_b128 a[88:91], v8 offset:51200
  ds_read_b128 a[92:95], v8 offset:52224
  s_waitcnt lgkmcnt(6)
  v_mfma_f32_32x32x16_bf16 v[32:47], a[148:151], a[68:71], v[32:47]
  ds_read_b64_tr_b16 a[156:157], v3 offset:38912
  ds_read_b64_tr_b16 a[158:159], v3 offset:39936
  s_waitcnt lgkmcnt(4)
  v_mfma_f32_32x32x16_bf16 v[32:47], a[152:155], a[72:75], v[32:47]
  ds_read_b64_tr_b16 a[144:145], v3 offset:40960
  ds_read_b64_tr_b16 a[146:147], v3 offset:41984
  s_waitcnt lgkmcnt(2)
  v_mfma_f32_32x32x16_bf16 v[32:47], a[156:159], a[76:79], v[32:47]
  ds_read_b64_tr_b16 a[148:149], v3 offset:43008
  ds_read_b64_tr_b16 a[150:151], v3 offset:44032
  s_add_u32 m0, s32, 24576
  s_add_u32 s74, s78, 221440
  s_addc_u32 s75, s79, 0
  s_waitcnt lgkmcnt(2)
  v_mfma_f32_32x32x16_bf16 v[32:47], a[144:147], a[80:83], v[32:47]
  global_load_lds_dwordx4 v5, s[74:75]
  ds_read_b64_tr_b16 a[152:153], v3 offset:45056
  ds_read_b64_tr_b16 a[154:155], v3 offset:46080
  s_waitcnt lgkmcnt(2)
  v_mfma_f32_32x32x16_bf16 v[32:47], a[148:151], a[84:87], v[32:47]
  ds_read_b64_tr_b16 a[156:157], v3 offset:47104
  ds_read_b64_tr_b16 a[158:159], v3 offset:48128
  s_waitcnt vmcnt(7) lgkmcnt(2)
  v_mfma_f32_32x32x16_bf16 v[32:47], a[152:155], a[88:91], v[32:47]
  s_barrier
  ds_read_b64_tr_b16 a[144:145], v28 offset:8192
  ds_read_b64_tr_b16 a[146:147], v28 offset:9216
  s_waitcnt lgkmcnt(2)
  v_mfma_f32_32x32x16_bf16 v[32:47], a[156:159], a[92:95], v[32:47]
  ds_read_b64_tr_b16 a[148:149], v28 offset:10240
  ds_read_b64_tr_b16 a[150:151], v28 offset:11264
  s_add_u32 m0, s32, 32768
  s_add_u32 s74, s78, 295168
  s_addc_u32 s75, s79, 0
  s_waitcnt lgkmcnt(2)
  v_mfma_f32_32x32x16_bf16 v[48:63], a[144:147], a[0:3], 0
  global_load_lds_dwordx4 v5, s[74:75]
  ds_read_b64_tr_b16 a[152:153], v28 offset:12288
  ds_read_b64_tr_b16 a[154:155], v28 offset:13312
  s_waitcnt lgkmcnt(2)
  v_mfma_f32_32x32x16_bf16 v[48:63], a[148:151], a[4:7], v[48:63]
  ds_read_b64_tr_b16 a[156:157], v28 offset:14336
  ds_read_b64_tr_b16 a[158:159], v28 offset:15360
  v_cvt_pk_bf16_f32 v88, v32, v33
  v_cvt_pk_bf16_f32 v89, v34, v35
  v_cvt_pk_bf16_f32 v90, v36, v37
  v_cvt_pk_bf16_f32 v91, v38, v39
  s_waitcnt lgkmcnt(2)
  v_mfma_f32_32x32x16_bf16 v[48:63], a[152:155], a[8:11], v[48:63]
  ds_read_b64_tr_b16 a[144:145], v28 offset:16384
  ds_read_b64_tr_b16 a[146:147], v28 offset:17408
  v_cvt_pk_bf16_f32 v92, v40, v41
  v_cvt_pk_bf16_f32 v93, v42, v43
  v_cvt_pk_bf16_f32 v94, v44, v45
  v_cvt_pk_bf16_f32 v95, v46, v47
  s_waitcnt lgkmcnt(2)
  v_mfma_f32_32x32x16_bf16 v[48:63], a[156:159], a[12:15], v[48:63]
  ds_read_b64_tr_b16 a[148:149], v28 offset:18432
  ds_read_b64_tr_b16 a[150:151], v28 offset:19456
  s_add_u32 s50, s84, 0
  s_addc_u32 s51, s85, 0
  global_store_dwordx4 v12, v[88:91], s[50:51] offset:0 sc1
  s_add_u32 m0, s32, 40960
  s_add_u32 s74, s78, 368896
  s_addc_u32 s75, s79, 0
  s_waitcnt lgkmcnt(2)
  v_mfma_f32_32x32x16_bf16 v[48:63], a[144:147], a[16:19], v[48:63]
  global_load_lds_dwordx4 v5, s[74:75]
  ds_read_b64_tr_b16 a[152:153], v28 offset:20480
  ds_read_b64_tr_b16 a[154:155], v28 offset:21504
  s_add_u32 s50, s84, 0
  s_addc_u32 s51, s85, 0
  global_store_dwordx4 v12, v[92:95], s[50:51] offset:1024 sc1
  s_waitcnt lgkmcnt(2)
  v_mfma_f32_32x32x16_bf16 v[48:63], a[148:151], a[20:23], v[48:63]
  ds_read_b64_tr_b16 a[156:157], v28 offset:22528
  ds_read_b64_tr_b16 a[158:159], v28 offset:23552
  s_waitcnt lgkmcnt(2)
  v_mfma_f32_32x32x16_bf16 v[48:63], a[152:155], a[24:27], v[48:63]
  ds_read_b64_tr_b16 a[144:145], v28 offset:24576
  ds_read_b64_tr_b16 a[146:147], v28 offset:25600
  s_waitcnt lgkmcnt(2)
  v_mfma_f32_32x32x16_bf16 v[48:63], a[156:159], a[28:31], v[48:63]
  ds_read_b64_tr_b16 a[148:149], v28 offset:26624
  ds_read_b64_tr_b16 a[150:151], v28 offset:27648
  s_waitcnt lgkmcnt(2)
  v_mfma_f32_32x32x16_bf16 v[48:63], a[144:147], a[32:35], v[48:63]
  ds_read_b64_tr_b16 a[152:153], v28 offset:28672
  ds_read_b64_tr_b16 a[154:155], v28 offset:29696
  s_waitcnt lgkmcnt(2)
  v_mfma_f32_32x32x16_bf16 v[48:63], a[148:151], a[36:39], v[48:63]
  ds_read_b64_tr_b16 a[156:157], v28 offset:30720
  ds_read_b64_tr_b16 a[158:159], v28 offset:31744
  s_waitcnt vmcnt(8) lgkmcnt(2)
  v_mfma_f32_32x32x16_bf16 v[48:63], a[152:155], a[40:43], v[48:63]
  s_barrier
  ds_read_b64_tr_b16 a[144:145], v28 offset:32768
  ds_read_b64_tr_b16 a[146:147], v28 offset:33792
  s_waitcnt lgkmcnt(2)
  v_mfma_f32_32x32x16_bf16 v[48:63], a[156:159], a[44:47], v[48:63]
  ds_read_b64_tr_b16 a[148:149], v28 offset:34816
  ds_read_b64_tr_b16 a[150:151], v28 offset:35840
  s_add_u32 m0, s32, 73728
  s_add_u32 s74, s78, 384
  s_addc_u32 s75, s79, 0
  s_waitcnt lgkmcnt(2)
  v_mfma_f32_32x32x16_bf16 v[48:63], a[144:147], a[48:51], v[48:63]
  global_load_lds_dwordx4 v5, s[74:75]
  ds_read_b64_tr_b16 a[152:153], v28 offset:36864
  ds_read_b64_tr_b16 a[154:155], v28 offset:37888
  s_waitcnt lgkmcnt(2)
  v_mfma_f32_32x32x16_bf16 v[48:63], a[148:151], a[52:55], v[48:63]
  ds_read_b64_tr_b16 a[156:157], v28 offset:38912
  ds_read_b64_tr_b16 a[158:159], v28 offset:39936
  s_waitcnt lgkmcnt(2)
  v_mfma_f32_32x32x16_bf16 v[48:63], a[152:155], a[56:59], v[48:63]
  ds_read_b64_tr_b16 a[144:145], v28 offset:40960
  ds_read_b64_tr_b16 a[146:147], v28 offset:41984
  s_waitcnt lgkmcnt(2)
  v_mfma_f32_32x32x16_bf16 v[48:63], a[156:159], a[60:63], v[48:63]
  ds_read_b64_tr_b16 a[148:149], v28 offset:43008
  ds_read_b64_tr_b16 a[150:151], v28 offset:44032
  s_add_u32 m0, s32, 81920
  s_add_u32 s74, s78, 74112
  s_addc_u32 s75, s79, 0
  s_waitcnt lgkmcnt(2)
  v_mfma_f32_32x32x16_bf16 v[48:63], a[144:147], a[64:67], v[48:63]
  global_load_lds_dwordx4 v5, s[74:75]
  ds_read_b64_tr_b16 a[152:153], v28 offset:45056
  ds_read_b64_tr_b16 a[154:155], v28 offset:46080
  s_waitcnt lgkmcnt(2)
  v_mfma_f32_32x32x16_bf16 v[48:63], a[148:151], a[68:71], v[48:63]
  ds_read_b64_tr_b16 a[156:157], v28 offset:47104
  ds_read_b64_tr_b16 a[158:159], v28 offset:48128
  s_waitcnt lgkmcnt(2)
  v_mfma_f32_32x32x16_bf16 v[48:63], a[152:155], a[72:75], v[48:63]
  ds_read_b64_tr_b16 a[144:145], v28 offset:49152
  ds_read_b64_tr_b16 a[146:147], v28 offset:50176
  s_waitcnt lgkmcnt(2)
  v_mfma_f32_32x32x16_bf16 v[48:63], a[156:159], a[76:79], v[48:63]
  ds_read_b64_tr_b16 a[148:149], v28 offset:51200
  ds_read_b64_tr_b16 a[150:151], v28 offset:52224
  s_add_u32 m0, s32, 90112
  s_add_u32 s74, s78, 147840
  s_addc_u32 s75, s79, 0
  s_waitcnt lgkmcnt(2)
  v_mfma_f32_32x32x16_bf16 v[48:63], a[144:147], a[80:83], v[48:63]
  global_load_lds_dwordx4 v5, s[74:75]
  ds_read_b64_tr_b16 a[152:153], v28 offset:53248
  ds_read_b64_tr_b16 a[154:155], v28 offset:54272
  s_waitcnt lgkmcnt(2)
  v_mfma_f32_32x32x16_bf16 v[48:63], a[148:151], a[84:87], v[48:63]
  ds_read_b64_tr_b16 a[156:157], v28 offset:55296
  ds_read_b64_tr_b16 a[158:159], v28 offset:56320
  s_waitcnt vmcnt(3) lgkmcnt(2)
  v_mfma_f32_32x32x16_bf16 v[48:63], a[152:155], a[88:91], v[48:63]
  s_barrier
  ds_read_b64_tr_b16 a[144:145], v3 offset:0
  ds_read_b64_tr_b16 a[146:147], v3 offset:1024
  s_mov_b64 exec, s[70:71]
  buffer_store_dword v30, v31, s[20:23], s57 offen offset:0 sc0 sc1
  s_mov_b64 exec, -1
  s_waitcnt lgkmcnt(2)
  v_mfma_f32_32x32x16_bf16 v[48:63], a[156:159], a[92:95], v[48:63]
  ds_read_b64_tr_b16 a[148:149], v3 offset:2048
  ds_read_b64_tr_b16 a[150:151], v3 offset:3072
  s_add_u32 m0, s32, 98304
  s_add_u32 s74, s78, 221568
  s_addc_u32 s75, s79, 0
  s_waitcnt lgkmcnt(2)
  v_mfma_f32_32x32x16_bf16 v[32:47], a[144:147], a[0:3], 0
  global_load_lds_dwordx4 v5, s[74:75]
  ds_read_b64_tr_b16 a[152:153], v3 offset:4096
  ds_read_b64_tr_b16 a[154:155], v3 offset:5120
  s_waitcnt lgkmcnt(2)
  v_mfma_f32_32x32x16_bf16 v[32:47], a[148:151], a[4:7], v[32:47]
  ds_read_b64_tr_b16 a[156:157], v3 offset:6144
  ds_read_b64_tr_b16 a[158:159], v3 offset:7168
  v_cvt_pk_bf16_f32 v88, v48, v49
  v_cvt_pk_bf16_f32 v89, v50, v51
  v_cvt_pk_bf16_f32 v90, v52, v53
  v_cvt_pk_bf16_f32 v91, v54, v55
  s_waitcnt lgkmcnt(2)
  v_mfma_f32_32x32x16_bf16 v[32:47], a[152:155], a[8:11], v[32:47]
  ds_read_b64_tr_b16 a[144:145], v3 offset:8192
  ds_read_b64_tr_b16 a[146:147], v3 offset:9216
  v_cvt_pk_bf16_f32 v92, v56, v57
  v_cvt_pk_bf16_f32 v93, v58, v59
  v_cvt_pk_bf16_f32 v94, v60, v61
  v_cvt_pk_bf16_f32 v95, v62, v63
  s_waitcnt lgkmcnt(2)
  v_mfma_f32_32x32x16_bf16 v[32:47], a[156:159], a[12:15], v[32:47]
  ds_read_b64_tr_b16 a[148:149], v3 offset:10240
  ds_read_b64_tr_b16 a[150:151], v3 offset:11264
  s_add_u32 s50, s84, 4096
  s_addc_u32 s51, s85, 0
  global_store_dwordx4 v12, v[88:91], s[50:51] offset:0 sc1
  s_add_u32 m0, s32, 106496
  s_add_u32 s74, s78, 295296
  s_addc_u32 s75, s79, 0
  s_waitcnt lgkmcnt(2)
  v_mfma_f32_32x32x16_bf16 v[32:47], a[144:147], a[16:19], v[32:47]
  global_load_lds_dwordx4 v5, s[74:75]
  ds_read_b64_tr_b16 a[152:153], v3 offset:12288
  ds_read_b64_tr_b16 a[154:155], v3 offset:13312
  s_add_u32 s50, s84, 4096
  s_addc_u32 s51, s85, 0
  global_store_dwordx4 v12, v[92:95], s[50:51] offset:1024 sc1
  s_waitcnt lgkmcnt(2)
  v_mfma_f32_32x32x16_bf16 v[32:47], a[148:151], a[20:23], v[32:47]
  ds_read_b64_tr_b16 a[156:157], v3 offset:14336
  ds_read_b64_tr_b16 a[158:159], v3 offset:15360
  s_waitcnt lgkmcnt(2)
  v_mfma_f32_32x32x16_bf16 v[32:47], a[152:155], a[24:27], v[32:47]
  ds_read_b64_tr_b16 a[144:145], v3 offset:16384
  ds_read_b64_tr_b16 a[146:147], v3 offset:17408
  s_waitcnt lgkmcnt(2)
  v_mfma_f32_32x32x16_bf16 v[32:47], a[156:159], a[28:31], v[32:47]
  ds_read_b64_tr_b16 a[148:149], v3 offset:18432
  ds_read_b64_tr_b16 a[150:151], v3 offset:19456
  s_add_u32 m0, s32, 114688
  s_add_u32 s74, s78, 369024
  s_addc_u32 s75, s79, 0
  s_waitcnt lgkmcnt(2)
  v_mfma_f32_32x32x16_bf16 v[32:47], a[144:147], a[32:35], v[32:47]
  global_load_lds_dwordx4 v5, s[74:75]
  ds_read_b64_tr_b16 a[152:153], v3 offset:20480
  ds_read_b64_tr_b16 a[154:155], v3 offset:21504
  s_waitcnt lgkmcnt(2)
  v_mfma_f32_32x32x16_bf16 v[32:47], a[148:151], a[36:39], v[32:47]
  ds_read_b64_tr_b16 a[156:157], v3 offset:22528
  ds_read_b64_tr_b16 a[158:159], v3 offset:23552
  s_waitcnt lgkmcnt(2)
  v_mfma_f32_32x32x16_bf16 v[32:47], a[152:155], a[40:43], v[32:47]
  s_barrier
  ds_read_b64_tr_b16 a[144:145], v3 offset:24576
  ds_read_b64_tr_b16 a[146:147], v3 offset:25600
  s_waitcnt lgkmcnt(2)
  v_mfma_f32_32x32x16_bf16 v[32:47], a[156:159], a[44:47], v[32:47]
  ds_read_b64_tr_b16 a[148:149], v3 offset:26624
  ds_read_b64_tr_b16 a[150:151], v3 offset:27648
  s_add_u32 m0, s32, 0
  s_add_u32 s74, s80, 512
  s_addc_u32 s75, s81, 0
  s_waitcnt lgkmcnt(2)
  v_mfma_f32_32x32x16_bf16 v[32:47], a[144:147], a[48:51], v[32:47]
  global_load_lds_dwordx4 v5, s[74:75]
  ds_read_b64_tr_b16 a[152:153], v3 offset:28672
  ds_read_b64_tr_b16 a[154:155], v3 offset:29696
  s_waitcnt lgkmcnt(2)
  v_mfma_f32_32x32x16_bf16 v[32:47], a[148:151], a[52:55], v[32:47]
  ds_read_b64_tr_b16 a[156:157], v3 offset:30720
  ds_read_b64_tr_b16 a[158:159], v3 offset:31744
  s_waitcnt lgkmcnt(2)
  v_mfma_f32_32x32x16_bf16 v[32:47], a[152:155], a[56:59], v[32:47]
  ds_read_b64_tr_b16 a[144:145], v3 offset:32768
  ds_read_b64_tr_b16 a[146:147], v3 offset:33792
  s_waitcnt lgkmcnt(2)
  v_mfma_f32_32x32x16_bf16 v[32:47], a[156:159], a[60:63], v[32:47]
  ds_read_b64_tr_b16 a[148:149], v3 offset:34816
  ds_read_b64_tr_b16 a[150:151], v3 offset:35840
  s_add_u32 m0, s32, 8192
  s_add_u32 s74, s80, 74240
  s_addc_u32 s75, s81, 0
  s_waitcnt lgkmcnt(2)
  v_mfma_f32_32x32x16_bf16 v[32:47], a[144:147], a[64:67], v[32:47]
  global_load_lds_dwordx4 v5, s[74:75]
  ds_read_b64_tr_b16 a[152:153], v3 offset:36864
  ds_read_b64_tr_b16 a[154:155], v3 offset:37888
  s_waitcnt lgkmcnt(2)
  v_mfma_f32_32x32x16_bf16 v[32:47], a[148:151], a[68:71], v[32:47]
  ds_read_b64_tr_b16 a[156:157], v3 offset:38912
  ds_read_b64_tr_b16 a[158:159], v3 offset:39936
  s_waitcnt lgkmcnt(2)
  v_mfma_f32_32x32x16_bf16 v[32:47], a[152:155], a[72:75], v[32:47]
  ds_read_b64_tr_b16 a[144:145], v3 offset:40960
  ds_read_b64_tr_b16 a[146:147], v3 offset:41984
  s_waitcnt lgkmcnt(2)
  v_mfma_f32_32x32x16_bf16 v[32:47], a[156:159], a[76:79], v[32:47]
  ds_read_b64_tr_b16 a[148:149], v3 offset:43008
  ds_read_b64_tr_b16 a[150:151], v3 offset:44032
  s_add_u32 m0, s32, 16384
  s_add_u32 s74, s80, 147968
  s_addc_u32 s75, s81, 0
  s_waitcnt lgkmcnt(2)
  v_mfma_f32_32x32x16_bf16 v[32:47], a[144:147], a[80:83], v[32:47]
  global_load_lds_dwordx4 v5, s[74:75]
  ds_read_b64_tr_b16 a[152:153], v3 offset:45056
  ds_read_b64_tr_b16 a[154:155], v3 offset:46080
  s_waitcnt lgkmcnt(2)
  v_mfma_f32_32x32x16_bf16 v[32:47], a[148:151], a[84:87], v[32:47]
  ds_read_b64_tr_b16 a[156:157], v3 offset:47104
  ds_read_b64_tr_b16 a[158:159], v3 offset:48128
  s_waitcnt vmcnt(4) lgkmcnt(2)
  v_mfma_f32_32x32x16_bf16 v[32:47], a[152:155], a[88:91], v[32:47]
  s_barrier
  ds_read_b64_tr_b16 a[144:145], v28 offset:8192
  ds_read_b64_tr_b16 a[146:147], v28 offset:9216
  s_mov_b64 exec, s[70:71]
  buffer_store_dword v30, v31, s[20:23], s57 offen offset:4 sc0 sc1
  s_mov_b64 exec, -1
  s_waitcnt lgkmcnt(2)
  v_mfma_f32_32x32x16_bf16 v[32:47], a[156:159], a[92:95], v[32:47]
  ds_read_b64_tr_b16 a[148:149], v28 offset:10240
  ds_read_b64_tr_b16 a[150:151], v28 offset:11264
  s_add_u32 m0, s32, 24576
  s_add_u32 s74, s80, 221696
  s_addc_u32 s75, s81, 0
  s_waitcnt lgkmcnt(2)
  v_mfma_f32_32x32x16_bf16 v[48:63], a[144:147], a[0:3], 0
  global_load_lds_dwordx4 v5, s[74:75]
  ds_read_b64_tr_b16 a[152:153], v28 offset:12288
  ds_read_b64_tr_b16 a[154:155], v28 offset:13312
  s_waitcnt lgkmcnt(2)
  v_mfma_f32_32x32x16_bf16 v[48:63], a[148:151], a[4:7], v[48:63]
  ds_read_b64_tr_b16 a[156:157], v28 offset:14336
  ds_read_b64_tr_b16 a[158:159], v28 offset:15360
  v_cvt_pk_bf16_f32 v88, v32, v33
  v_cvt_pk_bf16_f32 v89, v34, v35
  v_cvt_pk_bf16_f32 v90, v36, v37
  v_cvt_pk_bf16_f32 v91, v38, v39
  s_waitcnt lgkmcnt(2)
  v_mfma_f32_32x32x16_bf16 v[48:63], a[152:155], a[8:11], v[48:63]
  ds_read_b64_tr_b16 a[144:145], v28 offset:16384
  ds_read_b64_tr_b16 a[146:147], v28 offset:17408
  v_cvt_pk_bf16_f32 v92, v40, v41
  v_cvt_pk_bf16_f32 v93, v42, v43
  v_cvt_pk_bf16_f32 v94, v44, v45
  v_cvt_pk_bf16_f32 v95, v46, v47
  s_waitcnt lgkmcnt(2)
  v_mfma_f32_32x32x16_bf16 v[48:63], a[156:159], a[12:15], v[48:63]
  ds_read_b64_tr_b16 a[148:149], v28 offset:18432
  ds_read_b64_tr_b16 a[150:151], v28 offset:19456
  s_add_u32 s50, s84, 8192
  s_addc_u32 s51, s85, 0
  global_store_dwordx4 v12, v[88:91], s[50:51] offset:0 sc1
  s_add_u32 m0, s32, 32768
  s_add_u32 s74, s80, 295424
  s_addc_u32 s75, s81, 0
  s_waitcnt lgkmcnt(2)
  v_mfma_f32_32x32x16_bf16 v[48:63], a[144:147], a[16:19], v[48:63]
  global_load_lds_dwordx4 v5, s[74:75]
  ds_read_b64_tr_b16 a[152:153], v28 offset:20480
  ds_read_b64_tr_b16 a[154:155], v28 offset:21504
  s_add_u32 s50, s84, 8192
  s_addc_u32 s51, s85, 0
  global_store_dwordx4 v12, v[92:95], s[50:51] offset:1024 sc1
  s_waitcnt lgkmcnt(2)
  v_mfma_f32_32x32x16_bf16 v[48:63], a[148:151], a[20:23], v[48:63]
  ds_read_b64_tr_b16 a[156:157], v28 offset:22528
  ds_read_b64_tr_b16 a[158:159], v28 offset:23552
  s_waitcnt lgkmcnt(2)
  v_mfma_f32_32x32x16_bf16 v[48:63], a[152:155], a[24:27], v[48:63]
  ds_read_b64_tr_b16 a[144:145], v28 offset:24576
  ds_read_b64_tr_b16 a[146:147], v28 offset:25600
  s_waitcnt lgkmcnt(2)
  v_mfma_f32_32x32x16_bf16 v[48:63], a[156:159], a[28:31], v[48:63]
  ds_read_b64_tr_b16 a[148:149], v28 offset:26624
  ds_read_b64_tr_b16 a[150:151], v28 offset:27648
  s_add_u32 m0, s32, 40960
  s_add_u32 s74, s80, 369152
  s_addc_u32 s75, s81, 0
  s_waitcnt lgkmcnt(2)
  v_mfma_f32_32x32x16_bf16 v[48:63], a[144:147], a[32:35], v[48:63]
  global_load_lds_dwordx4 v5, s[74:75]
  ds_read_b64_tr_b16 a[152:153], v28 offset:28672
  ds_read_b64_tr_b16 a[154:155], v28 offset:29696
  s_mov_b64 exec, 1
  buffer_load_dword v29, v31, s[20:23], s58 offen offset:0 sc1
  s_mov_b64 exec, -1
  s_waitcnt lgkmcnt(2)
  v_mfma_f32_32x32x16_bf16 v[48:63], a[148:151], a[36:39], v[48:63]
  ds_read_b64_tr_b16 a[156:157], v28 offset:30720
  ds_read_b64_tr_b16 a[158:159], v28 offset:31744
  s_waitcnt vmcnt(10) lgkmcnt(2)
  v_mfma_f32_32x32x16_bf16 v[48:63], a[152:155], a[40:43], v[48:63]
  s_barrier
  ds_read_b64_tr_b16 a[144:145], v28 offset:32768
  ds_read_b64_tr_b16 a[146:147], v28 offset:33792
  s_waitcnt lgkmcnt(2)
  v_mfma_f32_32x32x16_bf16 v[48:63], a[156:159], a[44:47], v[48:63]
  ds_read_b64_tr_b16 a[148:149], v28 offset:34816
  ds_read_b64_tr_b16 a[150:151], v28 offset:35840
  s_add_u32 m0, s32, 73728
  s_add_u32 s74, s82, 640
  s_addc_u32 s75, s83, 0
  s_waitcnt lgkmcnt(2)
  v_mfma_f32_32x32x16_bf16 v[48:63], a[144:147], a[48:51], v[48:63]
  global_load_lds_dwordx4 v5, s[74:75]
  ds_read_b64_tr_b16 a[152:153], v28 offset:36864
  ds_read_b64_tr_b16 a[154:155], v28 offset:37888
  s_waitcnt lgkmcnt(2)
  v_mfma_f32_32x32x16_bf16 v[48:63], a[148:151], a[52:55], v[48:63]
  ds_read_b64_tr_b16 a[156:157], v28 offset:38912
  ds_read_b64_tr_b16 a[158:159], v28 offset:39936
  s_waitcnt lgkmcnt(2)
  v_mfma_f32_32x32x16_bf16 v[48:63], a[152:155], a[56:59], v[48:63]
  ds_read_b64_tr_b16 a[144:145], v28 offset:40960
  ds_read_b64_tr_b16 a[146:147], v28 offset:41984
  s_waitcnt lgkmcnt(2)
  v_mfma_f32_32x32x16_bf16 v[48:63], a[156:159], a[60:63], v[48:63]
  ds_read_b64_tr_b16 a[148:149], v28 offset:43008
  ds_read_b64_tr_b16 a[150:151], v28 offset:44032
  s_add_u32 m0, s32, 81920
  s_add_u32 s74, s82, 74368
  s_addc_u32 s75, s83, 0
  s_waitcnt lgkmcnt(2)
  v_mfma_f32_32x32x16_bf16 v[48:63], a[144:147], a[64:67], v[48:63]
  global_load_lds_dwordx4 v5, s[74:75]
  ds_read_b64_tr_b16 a[152:153], v28 offset:45056
  ds_read_b64_tr_b16 a[154:155], v28 offset:46080
  s_waitcnt lgkmcnt(2)
  v_mfma_f32_32x32x16_bf16 v[48:63], a[148:151], a[68:71], v[48:63]
  ds_read_b64_tr_b16 a[156:157], v28 offset:47104
  ds_read_b64_tr_b16 a[158:159], v28 offset:48128
  s_waitcnt lgkmcnt(2)
  v_mfma_f32_32x32x16_bf16 v[48:63], a[152:155], a[72:75], v[48:63]
  ds_read_b64_tr_b16 a[144:145], v28 offset:49152
  ds_read_b64_tr_b16 a[146:147], v28 offset:50176
  s_waitcnt lgkmcnt(2)
  v_mfma_f32_32x32x16_bf16 v[48:63], a[156:159], a[76:79], v[48:63]
  ds_read_b64_tr_b16 a[148:149], v28 offset:51200
  ds_read_b64_tr_b16 a[150:151], v28 offset:52224
  s_add_u32 m0, s32, 90112
  s_add_u32 s74, s82, 148096
  s_addc_u32 s75, s83, 0
  s_waitcnt lgkmcnt(2)
  v_mfma_f32_32x32x16_bf16 v[48:63], a[144:147], a[80:83], v[48:63]
  global_load_lds_dwordx4 v5, s[74:75]
  ds_read_b64_tr_b16 a[152:153], v28 offset:53248
  ds_read_b64_tr_b16 a[154:155], v28 offset:54272
  s_waitcnt lgkmcnt(2)
  v_mfma_f32_32x32x16_bf16 v[48:63], a[148:151], a[84:87], v[48:63]
  ds_read_b64_tr_b16 a[156:157], v28 offset:55296
  ds_read_b64_tr_b16 a[158:159], v28 offset:56320
  s_waitcnt vmcnt(5) lgkmcnt(2)
  v_mfma_f32_32x32x16_bf16 v[48:63], a[152:155], a[88:91], v[48:63]
  s_barrier
  ds_read_b64_tr_b16 a[144:145], v3 offset:0
  ds_read_b64_tr_b16 a[146:147], v3 offset:1024
  s_mov_b64 exec, s[70:71]
  buffer_store_dword v30, v31, s[20:23], s57 offen offset:8 sc0 sc1
  s_mov_b64 exec, -1
  s_waitcnt lgkmcnt(2)
  v_mfma_f32_32x32x16_bf16 v[48:63], a[156:159], a[92:95], v[48:63]
  ds_read_b64_tr_b16 a[148:149], v3 offset:2048
  ds_read_b64_tr_b16 a[150:151], v3 offset:3072
  s_add_u32 m0, s32, 98304
  s_add_u32 s74, s82, 221824
  s_addc_u32 s75, s83, 0
  s_waitcnt lgkmcnt(2)
  v_mfma_f32_32x32x16_bf16 v[32:47], a[144:147], a[0:3], 0
  global_load_lds_dwordx4 v5, s[74:75]
  ds_read_b64_tr_b16 a[152:153], v3 offset:4096
  ds_read_b64_tr_b16 a[154:155], v3 offset:5120
  s_waitcnt vmcnt(5)
  v_readfirstlane_b32 s33, v29
  s_nop 3
  s_cmp_lg_u32 s33, s59
  s_cbranch_scc1 L_sf0_5
L_rf0_5:
  s_add_u32 s33, s55, 20480
  s_nop 0
  buffer_load_dwordx4 v[64:67], v12, s[20:23], s33 offen sc1
  s_waitcnt lgkmcnt(2)
  v_mfma_f32_32x32x16_bf16 v[32:47], a[148:151], a[4:7], v[32:47]
  ds_read_b64_tr_b16 a[156:157], v3 offset:6144
  ds_read_b64_tr_b16 a[158:159], v3 offset:7168
  v_cvt_pk_bf16_f32 v88, v48, v49
  v_cvt_pk_bf16_f32 v89, v50, v51
  v_cvt_pk_bf16_f32 v90, v52, v53
  v_cvt_pk_bf16_f32 v91, v54, v55
  s_add_u32 s33, s55, 20480
  buffer_load_dwordx4 v[68:71], v12, s[20:23], s33 offen offset:1024 sc1
  s_waitcnt lgkmcnt(2)
  v_mfma_f32_32x32x16_bf16 v[32:47], a[152:155], a[8:11], v[32:47]
  ds_read_b64_tr_b16 a[144:145], v3 offset:8192
  ds_read_b64_tr_b16 a[146:147], v3 offset:9216
  v_cvt_pk_bf16_f32 v92, v56, v57
  v_cvt_pk_bf16_f32 v93, v58, v59
  v_cvt_pk_bf16_f32 v94, v60, v61
  v_cvt_pk_bf16_f32 v95, v62, v63
  s_waitcnt lgkmcnt(2)
  v_mfma_f32_32x32x16_bf16 v[32:47], a[156:159], a[12:15], v[32:47]
  ds_read_b64_tr_b16 a[148:149], v3 offset:10240
  ds_read_b64_tr_b16 a[150:151], v3 offset:11264
  s_add_u32 s50, s84, 12288
  s_addc_u32 s51, s85, 0
  global_store_dwordx4 v12, v[88:91], s[50:51] offset:0 sc1
  s_add_u32 m0, s32, 106496
  s_add_u32 s74, s82, 295552
  s_addc_u32 s75, s83, 0
  s_waitcnt lgkmcnt(2)
  v_mfma_f32_32x32x16_bf16 v[32:47], a[144:147], a[16:19], v[32:47]
  global_load_lds_dwordx4 v5, s[74:75]
  ds_read_b64_tr_b16 a[152:153], v3 offset:12288
  ds_read_b64_tr_b16 a[154:155], v3 offset:13312
  s_add_u32 s50, s84, 12288
  s_addc_u32 s51, s85, 0
  global_store_dwordx4 v12, v[92:95], s[50:51] offset:1024 sc1
  s_waitcnt lgkmcnt(2)
  v_mfma_f32_32x32x16_bf16 v[32:47], a[148:151], a[20:23], v[32:47]
  ds_read_b64_tr_b16 a[156:157], v3 offset:14336
  ds_read_b64_tr_b16 a[158:159], v3 offset:15360
  s_waitcnt lgkmcnt(2)
  v_mfma_f32_32x32x16_bf16 v[32:47], a[152:155], a[24:27], v[32:47]
  ds_read_b64_tr_b16 a[144:145], v3 offset:16384
  ds_read_b64_tr_b16 a[146:147], v3 offset:17408
  s_waitcnt lgkmcnt(2)
  v_mfma_f32_32x32x16_bf16 v[32:47], a[156:159], a[28:31], v[32:47]
  ds_read_b64_tr_b16 a[148:149], v3 offset:18432
  ds_read_b64_tr_b16 a[150:151], v3 offset:19456
  s_add_u32 m0, s32, 114688
  s_add_u32 s74, s82, 369280
  s_addc_u32 s75, s83, 0
  s_waitcnt lgkmcnt(2)
  v_mfma_f32_32x32x16_bf16 v[32:47], a[144:147], a[32:35], v[32:47]
  global_load_lds_dwordx4 v5, s[74:75]
  ds_read_b64_tr_b16 a[152:153], v3 offset:20480
  ds_read_b64_tr_b16 a[154:155], v3 offset:21504
  s_mov_b64 exec, 1
  buffer_load_dword v29, v31, s[20:23], s58 offen offset:4 sc1
  s_mov_b64 exec, -1
  s_waitcnt lgkmcnt(2)
  v_mfma_f32_32x32x16_bf16 v[32:47], a[148:151], a[36:39], v[32:47]
  ds_read_b64_tr_b16 a[156:157], v3 offset:22528
  ds_read_b64_tr_b16 a[158:159], v3 offset:23552
  s_waitcnt lgkmcnt(2)
  v_mfma_f32_32x32x16_bf16 v[32:47], a[152:155], a[40:43], v[32:47]
  s_barrier
  ds_read_b64_tr_b16 a[144:145], v3 offset:24576
  ds_read_b64_tr_b16 a[146:147], v3 offset:25600
  s_waitcnt lgkmcnt(2)
  v_mfma_f32_32x32x16_bf16 v[32:47], a[156:159], a[44:47], v[32:47]
  ds_read_b64_tr_b16 a[148:149], v3 offset:26624
  ds_read_b64_tr_b16 a[150:151], v3 offset:27648
  s_add_u32 m0, s32, 0
  s_add_u32 s74, s82, 768
  s_addc_u32 s75, s83, 0
  s_waitcnt lgkmcnt(2)
  v_mfma_f32_32x32x16_bf16 v[32:47], a[144:147], a[48:51], v[32:47]
  global_load_lds_dwordx4 v5, s[74:75]
  ds_read_b64_tr_b16 a[152:153], v3 offset:28672
  ds_read_b64_tr_b16 a[154:155], v3 offset:29696
  s_waitcnt lgkmcnt(2)
  v_mfma_f32_32x32x16_bf16 v[32:47], a[148:151], a[52:55], v[32:47]
  ds_read_b64_tr_b16 a[156:157], v3 offset:30720
  ds_read_b64_tr_b16 a[158:159], v3 offset:31744
  s_waitcnt lgkmcnt(2)
  v_mfma_f32_32x32x16_bf16 v[32:47], a[152:155], a[56:59], v[32:47]
  ds_read_b64_tr_b16 a[144:145], v3 offset:32768
  ds_read_b64_tr_b16 a[146:147], v3 offset:33792
  s_waitcnt lgkmcnt(2)
  v_mfma_f32_32x32x16_bf16 v[32:47], a[156:159], a[60:63], v[32:47]
  ds_read_b64_tr_b16 a[148:149], v3 offset:34816
  ds_read_b64_tr_b16 a[150:151], v3 offset:35840
  s_add_u32 m0, s32, 8192
  s_add_u32 s74, s82, 74496
  s_addc_u32 s75, s83, 0
  s_waitcnt lgkmcnt(2)
  v_mfma_f32_32x32x16_bf16 v[32:47], a[144:147], a[64:67], v[32:47]
  global_load_lds_dwordx4 v5, s[74:75]
  ds_read_b64_tr_b16 a[152:153], v3 offset:36864
  ds_read_b64_tr_b16 a[154:155], v3 offset:37888
  s_waitcnt lgkmcnt(2)
  v_mfma_f32_32x32x16_bf16 v[32:47], a[148:151], a[68:71], v[32:47]
  ds_read_b64_tr_b16 a[156:157], v3 offset:38912
  ds_read_b64_tr_b16 a[158:159], v3 offset:39936
  s_waitcnt lgkmcnt(2)
  v_mfma_f32_32x32x16_bf16 v[32:47], a[152:155], a[72:75], v[32:47]
  ds_read_b64_tr_b16 a[144:145], v3 offset:40960
  ds_read_b64_tr_b16 a[146:147], v3 offset:41984
  s_waitcnt vmcnt(8)
  v_lshlrev_b32_e64 v48, 16, v64
  v_and_b32_e64 v49, s68, v64
  v_lshlrev_b32_e64 v50, 16, v65
  v_and_b32_e64 v51, s68, v65
  s_waitcnt lgkmcnt(2)
  v_mfma_f32_32x32x16_bf16 v[32:47], a[156:159], a[76:79], v[32:47]
  ds_read_b64_tr_b16 a[148:149], v3 offset:43008
  ds_read_b64_tr_b16 a[150:151], v3 offset:44032
  v_lshlrev_b32_e64 v52, 16, v66
  v_and_b32_e64 v53, s68, v66
  v_lshlrev_b32_e64 v54, 16, v67
  v_and_b32_e64 v55, s68, v67
  s_add_u32 m0, s32, 16384
  s_add_u32 s74, s82, 148224
  s_addc_u32 s75, s83, 0
  s_waitcnt lgkmcnt(2)
  v_mfma_f32_32x32x16_bf16 v[32:47], a[144:147], a[80:83], v[32:47]
  global_load_lds_dwordx4 v5, s[74:75]
  ds_read_b64_tr_b16 a[152:153], v3 offset:45056
  ds_read_b64_tr_b16 a[154:155], v3 offset:46080
  s_waitcnt vmcnt(8)
  v_lshlrev_b32_e64 v56, 16, v68
  v_and_b32_e64 v57, s68, v68
  v_lshlrev_b32_e64 v58, 16, v69
  v_and_b32_e64 v59, s68, v69
  s_waitcnt lgkmcnt(2)
  v_mfma_f32_32x32x16_bf16 v[32:47], a[148:151], a[84:87], v[32:47]
  ds_read_b64_tr_b16 a[156:157], v3 offset:47104
  ds_read_b64_tr_b16 a[158:159], v3 offset:48128
  v_lshlrev_b32_e64 v60, 16, v70
  v_and_b32_e64 v61, s68, v70
  v_lshlrev_b32_e64 v62, 16, v71
  v_and_b32_e64 v63, s68, v71
  s_waitcnt vmcnt(5) lgkmcnt(2)
  v_mfma_f32_32x32x16_bf16 v[32:47], a[152:155], a[88:91], v[32:47]
  s_barrier
  ds_read_b64_tr_b16 a[144:145], v28 offset:8192
  ds_read_b64_tr_b16 a[146:147], v28 offset:9216
  s_mov_b64 exec, s[70:71]
  buffer_store_dword v30, v31, s[20:23], s57 offen offset:12 sc0 sc1
  s_mov_b64 exec, -1
  s_waitcnt lgkmcnt(2)
  v_mfma_f32_32x32x16_bf16 v[32:47], a[156:159], a[92:95], v[32:47]
  ds_read_b64_tr_b16 a[148:149], v28 offset:10240
  ds_read_b64_tr_b16 a[150:151], v28 offset:11264
  s_add_u32 m0, s32, 24576
  s_add_u32 s74, s82, 221952
  s_addc_u32 s75, s83, 0
  s_waitcnt lgkmcnt(2)
  v_mfma_f32_32x32x16_bf16 v[48:63], a[144:147], a[0:3], v[48:63]
  global_load_lds_dwordx4 v5, s[74:75]
  ds_read_b64_tr_b16 a[152:153], v28 offset:12288
  ds_read_b64_tr_b16 a[154:155], v28 offset:13312
  s_waitcnt vmcnt(5)
  v_readfirstlane_b32 s33, v29
  s_nop 3
  s_cmp_lg_u32 s33, s59
  s_cbranch_scc1 L_sf0_6
L_rf0_6:
  s_add_u32 s33, s55, 24576
  s_nop 0
  buffer_load_dwordx4 v[64:67], v12, s[20:23], s33 offen sc1
  s_waitcnt lgkmcnt(2)
  v_mfma_f32_32x32x16_bf16 v[48:63], a[148:151], a[4:7], v[48:63]
  ds_read_b64_tr_b16 a[156:157], v28 offset:14336
  ds_read_b64_tr_b16 a[158:159], v28 offset:15360
  v_cvt_pk_bf16_f32 v88, v32, v33
  v_cvt_pk_bf16_f32 v89, v34, v35
  v_cvt_pk_bf16_f32 v90, v36, v37
  v_cvt_pk_bf16_f32 v91, v38, v39
  s_add_u32 s33, s55, 24576
  buffer_load_dwordx4 v[68:71], v12, s[20:23], s33 offen offset:1024 sc1
  s_waitcnt lgkmcnt(2)
  v_mfma_f32_32x32x16_bf16 v[48:63], a[152:155], a[8:11], v[48:63]
  ds_read_b64_tr_b16 a[144:145], v28 offset:16384
  ds_read_b64_tr_b16 a[146:147], v28 offset:17408
  v_cvt_pk_bf16_f32 v92, v40, v41
  v_cvt_pk_bf16_f32 v93, v42, v43
  v_cvt_pk_bf16_f32 v94, v44, v45
  v_cvt_pk_bf16_f32 v95, v46, v47
  s_waitcnt lgkmcnt(2)
  v_mfma_f32_32x32x16_bf16 v[48:63], a[156:159], a[12:15], v[48:63]
  ds_read_b64_tr_b16 a[148:149], v28 offset:18432
  ds_read_b64_tr_b16 a[150:151], v28 offset:19456
  s_add_u32 s50, s86, 16384
  s_addc_u32 s51, s87, 0
  global_store_dwordx4 v12, v[88:91], s[50:51] offset:0 sc1
  s_add_u32 m0, s32, 32768
  s_add_u32 s74, s82, 295680
  s_addc_u32 s75, s83, 0
  s_waitcnt lgkmcnt(2)
  v_mfma_f32_32x32x16_bf16 v[48:63], a[144:147], a[16:19], v[48:63]
  global_load_lds_dwordx4 v5, s[74:75]
  ds_read_b64_tr_b16 a[152:153], v28 offset:20480
  ds_read_b64_tr_b16 a[154:155], v28 offset:21504
  s_add_u32 s50, s86, 16384
  s_addc_u32 s51, s87, 0
  global_store_dwordx4 v12, v[92:95], s[50:51] offset:1024 sc1
  s_waitcnt lgkmcnt(2)
  v_mfma_f32_32x32x16_bf16 v[48:63], a[148:151], a[20:23], v[48:63]
  ds_read_b64_tr_b16 a[156:157], v28 offset:22528
  ds_read_b64_tr_b16 a[158:159], v28 offset:23552
  s_waitcnt lgkmcnt(2)
  v_mfma_f32_32x32x16_bf16 v[48:63], a[152:155], a[24:27], v[48:63]
  ds_read_b64_tr_b16 a[144:145], v28 offset:24576
  ds_read_b64_tr_b16 a[146:147], v28 offset:25600
  s_waitcnt lgkmcnt(2)
  v_mfma_f32_32x32x16_bf16 v[48:63], a[156:159], a[28:31], v[48:63]
  ds_read_b64_tr_b16 a[148:149], v28 offset:26624
  ds_read_b64_tr_b16 a[150:151], v28 offset:27648
  s_add_u32 m0, s32, 40960
  s_add_u32 s74, s82, 369408
  s_addc_u32 s75, s83, 0
  s_waitcnt lgkmcnt(2)
  v_mfma_f32_32x32x16_bf16 v[48:63], a[144:147], a[32:35], v[48:63]
  global_load_lds_dwordx4 v5, s[74:75]
  ds_read_b64_tr_b16 a[152:153], v28 offset:28672
  ds_read_b64_tr_b16 a[154:155], v28 offset:29696
  s_mov_b64 exec, 1
  buffer_load_dword v29, v31, s[20:23], s58 offen offset:8 sc1
  s_mov_b64 exec, -1
  s_waitcnt lgkmcnt(2)
  v_mfma_f32_32x32x16_bf16 v[48:63], a[148:151], a[36:39], v[48:63]
  ds_read_b64_tr_b16 a[156:157], v28 offset:30720
  ds_read_b64_tr_b16 a[158:159], v28 offset:31744
  s_waitcnt lgkmcnt(2)
  v_mfma_f32_32x32x16_bf16 v[48:63], a[152:155], a[40:43], v[48:63]
  s_barrier
  ds_read_b64_tr_b16 a[144:145], v28 offset:32768
  ds_read_b64_tr_b16 a[146:147], v28 offset:33792
  s_waitcnt lgkmcnt(2)
  v_mfma_f32_32x32x16_bf16 v[48:63], a[156:159], a[44:47], v[48:63]
  ds_read_b64_tr_b16 a[148:149], v28 offset:34816
  ds_read_b64_tr_b16 a[150:151], v28 offset:35840
  s_add_u32 m0, s32, 73728
  s_add_u32 s74, s82, 896
  s_addc_u32 s75, s83, 0
  s_waitcnt lgkmcnt(2)
  v_mfma_f32_32x32x16_bf16 v[48:63], a[144:147], a[48:51], v[48:63]
  global_load_lds_dwordx4 v5, s[74:75]
  ds_read_b64_tr_b16 a[152:153], v28 offset:36864
  ds_read_b64_tr_b16 a[154:155], v28 offset:37888
  s_waitcnt lgkmcnt(2)
  v_mfma_f32_32x32x16_bf16 v[48:63], a[148:151], a[52:55], v[48:63]
  ds_read_b64_tr_b16 a[156:157], v28 offset:38912
  ds_read_b64_tr_b16 a[158:159], v28 offset:39936
  s_waitcnt lgkmcnt(2)
  v_mfma_f32_32x32x16_bf16 v[48:63], a[152:155], a[56:59], v[48:63]
  ds_read_b64_tr_b16 a[144:145], v28 offset:40960
  ds_read_b64_tr_b16 a[146:147], v28 offset:41984
  s_waitcnt lgkmcnt(2)
  v_mfma_f32_32x32x16_bf16 v[48:63], a[156:159], a[60:63], v[48:63]
  ds_read_b64_tr_b16 a[148:149], v28 offset:43008
  ds_read_b64_tr_b16 a[150:151], v28 offset:44032
  s_add_u32 m0, s32, 81920
  s_add_u32 s74, s82, 74624
  s_addc_u32 s75, s83, 0
  s_waitcnt lgkmcnt(2)
  v_mfma_f32_32x32x16_bf16 v[48:63], a[144:147], a[64:67], v[48:63]
  global_load_lds_dwordx4 v5, s[74:75]
  ds_read_b64_tr_b16 a[152:153], v28 offset:45056
  ds_read_b64_tr_b16 a[154:155], v28 offset:46080
  s_waitcnt lgkmcnt(2)
  v_mfma_f32_32x32x16_bf16 v[48:63], a[148:151], a[68:71], v[48:63]
  ds_read_b64_tr_b16 a[156:157], v28 offset:47104
  ds_read_b64_tr_b16 a[158:159], v28 offset:48128
  s_waitcnt lgkmcnt(2)
  v_mfma_f32_32x32x16_bf16 v[48:63], a[152:155], a[72:75], v[48:63]
  ds_read_b64_tr_b16 a[144:145], v28 offset:49152
  ds_read_b64_tr_b16 a[146:147], v28 offset:50176
  s_waitcnt vmcnt(8)
  v_lshlrev_b32_e64 v32, 16, v64
  v_and_b32_e64 v33, s68, v64
  v_lshlrev_b32_e64 v34, 16, v65
  v_and_b32_e64 v35, s68, v65
  s_waitcnt lgkmcnt(2)
  v_mfma_f32_32x32x16_bf16 v[48:63], a[156:159], a[76:79], v[48:63]
  ds_read_b64_tr_b16 a[148:149], v28 offset:51200
  ds_read_b64_tr_b16 a[150:151], v28 offset:52224
  v_lshlrev_b32_e64 v36, 16, v66
  v_and_b32_e64 v37, s68, v66
  v_lshlrev_b32_e64 v38, 16, v67
  v_and_b32_e64 v39, s68, v67
  s_add_u32 m0, s32, 90112
  s_add_u32 s74, s82, 148352
  s_addc_u32 s75, s83, 0
  s_waitcnt lgkmcnt(2)
  v_mfma_f32_32x32x16_bf16 v[48:63], a[144:147], a[80:83], v[48:63]
  global_load_lds_dwordx4 v5, s[74:75]
  ds_read_b64_tr_b16 a[152:153], v28 offset:53248
  ds_read_b64_tr_b16 a[154:155], v28 offset:54272
  s_waitcnt vmcnt(8)
  v_lshlrev_b32_e64 v40, 16, v68
  v_and_b32_e64 v41, s68, v68
  v_lshlrev_b32_e64 v42, 16, v69
  v_and_b32_e64 v43, s68, v69
  s_waitcnt lgkmcnt(2)
  v_mfma_f32_32x32x16_bf16 v[48:63], a[148:151], a[84:87], v[48:63]
  ds_read_b64_tr_b16 a[156:157], v28 offset:55296
  ds_read_b64_tr_b16 a[158:159], v28 offset:56320
  v_lshlrev_b32_e64 v44, 16, v70
  v_and_b32_e64 v45, s68, v70
  v_lshlrev_b32_e64 v46, 16, v71
  v_and_b32_e64 v47, s68, v71
  s_waitcnt lgkmcnt(2)
  v_mfma_f32_32x32x16_bf16 v[48:63], a[152:155], a[88:91], v[48:63]
  s_barrier
  ds_read_b64_tr_b16 a[144:145], v3 offset:0
  ds_read_b64_tr_b16 a[146:147], v3 offset:1024
  s_waitcnt lgkmcnt(2)
  v_mfma_f32_32x32x16_bf16 v[48:63], a[156:159], a[92:95], v[48:63]
  ds_read_b64_tr_b16 a[148:149], v3 offset:2048
  ds_read_b64_tr_b16 a[150:151], v3 offset:3072
  s_add_u32 m0, s32, 98304
  s_add_u32 s74, s82, 222080
  s_addc_u32 s75, s83, 0
  s_waitcnt lgkmcnt(2)
  v_mfma_f32_32x32x16_bf16 v[32:47], a[144:147], a[0:3], v[32:47]
  global_load_lds_dwordx4 v5, s[74:75]
  ds_read_b64_tr_b16 a[152:153], v3 offset:4096
  ds_read_b64_tr_b16 a[154:155], v3 offset:5120
  s_waitcnt vmcnt(4)
  v_readfirstlane_b32 s33, v29
  s_nop 3
  s_cmp_lg_u32 s33, s59
  s_cbranch_scc1 L_sf0_7
L_rf0_7:
  s_add_u32 s33, s55, 28672
  s_nop 0
  buffer_load_dwordx4 v[64:67], v12, s[20:23], s33 offen sc1
  s_waitcnt lgkmcnt(2)
  v_mfma_f32_32x32x16_bf16 v[32:47], a[148:151], a[4:7], v[32:47]
  ds_read_b64_tr_b16 a[156:157], v3 offset:6144
  ds_read_b64_tr_b16 a[158:159], v3 offset:7168
  v_cvt_pk_bf16_f32 v88, v48, v49
  v_cvt_pk_bf16_f32 v89, v50, v51
  v_cvt_pk_bf16_f32 v90, v52, v53
  v_cvt_pk_bf16_f32 v91, v54, v55
  s_add_u32 s33, s55, 28672
  buffer_load_dwordx4 v[68:71], v12, s[20:23], s33 offen offset:1024 sc1
  s_waitcnt lgkmcnt(2)
  v_mfma_f32_32x32x16_bf16 v[32:47], a[152:155], a[8:11], v[32:47]
  ds_read_b64_tr_b16 a[144:145], v3 offset:8192
  ds_read_b64_tr_b16 a[146:147], v3 offset:9216
  v_cvt_pk_bf16_f32 v92, v56, v57
  v_cvt_pk_bf16_f32 v93, v58, v59
  v_cvt_pk_bf16_f32 v94, v60, v61
  v_cvt_pk_bf16_f32 v95, v62, v63
  s_waitcnt lgkmcnt(2)
  v_mfma_f32_32x32x16_bf16 v[32:47], a[156:159], a[12:15], v[32:47]
  ds_read_b64_tr_b16 a[148:149], v3 offset:10240
  ds_read_b64_tr_b16 a[150:151], v3 offset:11264
  s_add_u32 s50, s72, 0
  s_addc_u32 s51, s73, 0
  global_store_dwordx4 v12, v[88:91], s[50:51] offset:0 sc1
  s_add_u32 m0, s32, 106496
  s_add_u32 s74, s82, 295808
  s_addc_u32 s75, s83, 0
  s_waitcnt lgkmcnt(2)
  v_mfma_f32_32x32x16_bf16 v[32:47], a[144:147], a[16:19], v[32:47]
  global_load_lds_dwordx4 v5, s[74:75]
  ds_read_b64_tr_b16 a[152:153], v3 offset:12288
  ds_read_b64_tr_b16 a[154:155], v3 offset:13312
  s_add_u32 s50, s72, 0
  s_addc_u32 s51, s73, 0
  global_store_dwordx4 v12, v[92:95], s[50:51] offset:1024 sc1
  s_waitcnt lgkmcnt(2)
  v_mfma_f32_32x32x16_bf16 v[32:47], a[148:151], a[20:23], v[32:47]
  ds_read_b64_tr_b16 a[156:157], v3 offset:14336
  ds_read_b64_tr_b16 a[158:159], v3 offset:15360
  s_waitcnt lgkmcnt(2)
  v_mfma_f32_32x32x16_bf16 v[32:47], a[152:155], a[24:27], v[32:47]
  ds_read_b64_tr_b16 a[144:145], v3 offset:16384
  ds_read_b64_tr_b16 a[146:147], v3 offset:17408
  s_waitcnt lgkmcnt(2)
  v_mfma_f32_32x32x16_bf16 v[32:47], a[156:159], a[28:31], v[32:47]
  ds_read_b64_tr_b16 a[148:149], v3 offset:18432
  ds_read_b64_tr_b16 a[150:151], v3 offset:19456
  s_add_u32 m0, s32, 114688
  s_add_u32 s74, s82, 369536
  s_addc_u32 s75, s83, 0
  s_waitcnt lgkmcnt(2)
  v_mfma_f32_32x32x16_bf16 v[32:47], a[144:147], a[32:35], v[32:47]
  global_load_lds_dwordx4 v5, s[74:75]
  ds_read_b64_tr_b16 a[152:153], v3 offset:20480
  ds_read_b64_tr_b16 a[154:155], v3 offset:21504
  s_mov_b64 exec, 1
  buffer_load_dword v29, v31, s[20:23], s58 offen offset:12 sc1
  s_mov_b64 exec, -1
  s_waitcnt lgkmcnt(2)
  v_mfma_f32_32x32x16_bf16 v[32:47], a[148:151], a[36:39], v[32:47]
  ds_read_b64_tr_b16 a[156:157], v3 offset:22528
  ds_read_b64_tr_b16 a[158:159], v3 offset:23552
  s_waitcnt lgkmcnt(2)
  v_mfma_f32_32x32x16_bf16 v[32:47], a[152:155], a[40:43], v[32:47]
  s_barrier
  ds_read_b64_tr_b16 a[144:145], v3 offset:24576
  ds_read_b64_tr_b16 a[146:147], v3 offset:25600
  s_waitcnt lgkmcnt(2)
  v_mfma_f32_32x32x16_bf16 v[32:47], a[156:159], a[44:47], v[32:47]
  ds_read_b64_tr_b16 a[148:149], v3 offset:26624
  ds_read_b64_tr_b16 a[150:151], v3 offset:27648
  s_add_u32 m0, s32, 0
  s_add_u32 s74, s82, 1024
  s_addc_u32 s75, s83, 0
  s_waitcnt lgkmcnt(2)
  v_mfma_f32_32x32x16_bf16 v[32:47], a[144:147], a[48:51], v[32:47]
  global_load_lds_dwordx4 v5, s[74:75]
  ds_read_b64_tr_b16 a[152:153], v3 offset:28672
  ds_read_b64_tr_b16 a[154:155], v3 offset:29696
  s_waitcnt lgkmcnt(2)
  v_mfma_f32_32x32x16_bf16 v[32:47], a[148:151], a[52:55], v[32:47]
  ds_read_b64_tr_b16 a[156:157], v3 offset:30720
  ds_read_b64_tr_b16 a[158:159], v3 offset:31744
  s_waitcnt lgkmcnt(2)
  v_mfma_f32_32x32x16_bf16 v[32:47], a[152:155], a[56:59], v[32:47]
  ds_read_b64_tr_b16 a[144:145], v3 offset:32768
  ds_read_b64_tr_b16 a[146:147], v3 offset:33792
  s_waitcnt lgkmcnt(2)
  v_mfma_f32_32x32x16_bf16 v[32:47], a[156:159], a[60:63], v[32:47]
  ds_read_b64_tr_b16 a[148:149], v3 offset:34816
  ds_read_b64_tr_b16 a[150:151], v3 offset:35840
  s_add_u32 m0, s32, 8192
  s_add_u32 s74, s82, 74752
  s_addc_u32 s75, s83, 0
  s_waitcnt lgkmcnt(2)
  v_mfma_f32_32x32x16_bf16 v[32:47], a[144:147], a[64:67], v[32:47]
  global_load_lds_dwordx4 v5, s[74:75]
  ds_read_b64_tr_b16 a[152:153], v3 offset:36864
  ds_read_b64_tr_b16 a[154:155], v3 offset:37888
  s_waitcnt lgkmcnt(2)
  v_mfma_f32_32x32x16_bf16 v[32:47], a[148:151], a[68:71], v[32:47]
  ds_read_b64_tr_b16 a[156:157], v3 offset:38912
  ds_read_b64_tr_b16 a[158:159], v3 offset:39936
  s_waitcnt lgkmcnt(2)
  v_mfma_f32_32x32x16_bf16 v[32:47], a[152:155], a[72:75], v[32:47]
  ds_read_b64_tr_b16 a[144:145], v3 offset:40960
  ds_read_b64_tr_b16 a[146:147], v3 offset:41984
  s_waitcnt vmcnt(8)
  v_lshlrev_b32_e64 v48, 16, v64
  v_and_b32_e64 v49, s68, v64
  v_lshlrev_b32_e64 v50, 16, v65
  v_and_b32_e64 v51, s68, v65
  s_waitcnt lgkmcnt(2)
  v_mfma_f32_32x32x16_bf16 v[32:47], a[156:159], a[76:79], v[32:47]
  ds_read_b64_tr_b16 a[148:149], v3 offset:43008
  ds_read_b64_tr_b16 a[150:151], v3 offset:44032
  v_lshlrev_b32_e64 v52, 16, v66
  v_and_b32_e64 v53, s68, v66
  v_lshlrev_b32_e64 v54, 16, v67
  v_and_b32_e64 v55, s68, v67
  s_add_u32 m0, s32, 16384
  s_add_u32 s74, s82, 148480
  s_addc_u32 s75, s83, 0
  s_waitcnt lgkmcnt(2)
  v_mfma_f32_32x32x16_bf16 v[32:47], a[144:147], a[80:83], v[32:47]
  global_load_lds_dwordx4 v5, s[74:75]
  ds_read_b64_tr_b16 a[152:153], v3 offset:45056
  ds_read_b64_tr_b16 a[154:155], v3 offset:46080
  s_waitcnt vmcnt(8)
  v_lshlrev_b32_e64 v56, 16, v68
  v_and_b32_e64 v57, s68, v68
  v_lshlrev_b32_e64 v58, 16, v69
  v_and_b32_e64 v59, s68, v69
  s_waitcnt lgkmcnt(2)
  v_mfma_f32_32x32x16_bf16 v[32:47], a[148:151], a[84:87], v[32:47]
  ds_read_b64_tr_b16 a[156:157], v3 offset:47104
  ds_read_b64_tr_b16 a[158:159], v3 offset:48128
  v_lshlrev_b32_e64 v60, 16, v70
  v_and_b32_e64 v61, s68, v70
  v_lshlrev_b32_e64 v62, 16, v71
  v_and_b32_e64 v63, s68, v71
  s_waitcnt lgkmcnt(2)
  v_mfma_f32_32x32x16_bf16 v[32:47], a[152:155], a[88:91], v[32:47]
  s_barrier
  ds_read_b64_tr_b16 a[144:145], v28 offset:8192
  ds_read_b64_tr_b16 a[146:147], v28 offset:9216
  s_waitcnt lgkmcnt(2)
  v_mfma_f32_32x32x16_bf16 v[32:47], a[156:159], a[92:95], v[32:47]
  ds_read_b64_tr_b16 a[148:149], v28 offset:10240
  ds_read_b64_tr_b16 a[150:151], v28 offset:11264
  s_add_u32 m0, s32, 24576
  s_add_u32 s74, s82, 222208
  s_addc_u32 s75, s83, 0
  s_waitcnt lgkmcnt(2)
  v_mfma_f32_32x32x16_bf16 v[48:63], a[144:147], a[0:3], v[48:63]
  global_load_lds_dwordx4 v5, s[74:75]
  ds_read_b64_tr_b16 a[152:153], v28 offset:12288
  ds_read_b64_tr_b16 a[154:155], v28 offset:13312
  s_waitcnt vmcnt(4)
  v_readfirstlane_b32 s33, v29
  s_nop 3
  s_cmp_lg_u32 s33, s59
  s_cbranch_scc1 L_sf0_8
L_rf0_8:
  s_add_u32 s33, s55, 32768
  s_nop 0
  buffer_load_dwordx4 v[64:67], v12, s[20:23], s33 offen sc1
  s_waitcnt lgkmcnt(2)
  v_mfma_f32_32x32x16_bf16 v[48:63], a[148:151], a[4:7], v[48:63]
  ds_read_b64_tr_b16 a[156:157], v28 offset:14336
  ds_read_b64_tr_b16 a[158:159], v28 offset:15360
  v_cvt_pk_bf16_f32 v88, v32, v33
  v_cvt_pk_bf16_f32 v89, v34, v35
  v_cvt_pk_bf16_f32 v90, v36, v37
  v_cvt_pk_bf16_f32 v91, v38, v39
  s_add_u32 s33, s55, 32768
  buffer_load_dwordx4 v[68:71], v12, s[20:23], s33 offen offset:1024 sc1
  s_waitcnt lgkmcnt(2)
  v_mfma_f32_32x32x16_bf16 v[48:63], a[152:155], a[8:11], v[48:63]
  ds_read_b64_tr_b16 a[144:145], v28 offset:16384
  ds_read_b64_tr_b16 a[146:147], v28 offset:17408
  v_cvt_pk_bf16_f32 v92, v40, v41
  v_cvt_pk_bf16_f32 v93, v42, v43
  v_cvt_pk_bf16_f32 v94, v44, v45
  v_cvt_pk_bf16_f32 v95, v46, v47
  s_waitcnt lgkmcnt(2)
  v_mfma_f32_32x32x16_bf16 v[48:63], a[156:159], a[12:15], v[48:63]
  ds_read_b64_tr_b16 a[148:149], v28 offset:18432
  ds_read_b64_tr_b16 a[150:151], v28 offset:19456
  s_add_u32 s50, s72, 4096
  s_addc_u32 s51, s73, 0
  global_store_dwordx4 v12, v[88:91], s[50:51] offset:0 sc1
  s_add_u32 m0, s32, 32768
  s_add_u32 s74, s82, 295936
  s_addc_u32 s75, s83, 0
  s_waitcnt lgkmcnt(2)
  v_mfma_f32_32x32x16_bf16 v[48:63], a[144:147], a[16:19], v[48:63]
  global_load_lds_dwordx4 v5, s[74:75]
  ds_read_b64_tr_b16 a[152:153], v28 offset:20480
  ds_read_b64_tr_b16 a[154:155], v28 offset:21504
  s_add_u32 s50, s72, 4096
  s_addc_u32 s51, s73, 0
  global_store_dwordx4 v12, v[92:95], s[50:51] offset:1024 sc1
  s_waitcnt lgkmcnt(2)
  v_mfma_f32_32x32x16_bf16 v[48:63], a[148:151], a[20:23], v[48:63]
  ds_read_b64_tr_b16 a[156:157], v28 offset:22528
  ds_read_b64_tr_b16 a[158:159], v28 offset:23552
  s_waitcnt lgkmcnt(2)
  v_mfma_f32_32x32x16_bf16 v[48:63], a[152:155], a[24:27], v[48:63]
  ds_read_b64_tr_b16 a[144:145], v28 offset:24576
  ds_read_b64_tr_b16 a[146:147], v28 offset:25600
  s_waitcnt lgkmcnt(2)
  v_mfma_f32_32x32x16_bf16 v[48:63], a[156:159], a[28:31], v[48:63]
  ds_read_b64_tr_b16 a[148:149], v28 offset:26624
  ds_read_b64_tr_b16 a[150:151], v28 offset:27648
  s_add_u32 m0, s32, 40960
  s_add_u32 s74, s82, 369664
  s_addc_u32 s75, s83, 0
  s_waitcnt lgkmcnt(2)
  v_mfma_f32_32x32x16_bf16 v[48:63], a[144:147], a[32:35], v[48:63]
  global_load_lds_dwordx4 v5, s[74:75]
  ds_read_b64_tr_b16 a[152:153], v28 offset:28672
  ds_read_b64_tr_b16 a[154:155], v28 offset:29696
  s_waitcnt lgkmcnt(2)
  v_mfma_f32_32x32x16_bf16 v[48:63], a[148:151], a[36:39], v[48:63]
  ds_read_b64_tr_b16 a[156:157], v28 offset:30720
  ds_read_b64_tr_b16 a[158:159], v28 offset:31744
  s_waitcnt lgkmcnt(2)
  v_mfma_f32_32x32x16_bf16 v[48:63], a[152:155], a[40:43], v[48:63]
  s_barrier
  ds_read_b64_tr_b16 a[144:145], v28 offset:32768
  ds_read_b64_tr_b16 a[146:147], v28 offset:33792
  s_waitcnt lgkmcnt(2)
  v_mfma_f32_32x32x16_bf16 v[48:63], a[156:159], a[44:47], v[48:63]
  ds_read_b64_tr_b16 a[148:149], v28 offset:34816
  ds_read_b64_tr_b16 a[150:151], v28 offset:35840
  s_waitcnt lgkmcnt(2)
  v_mfma_f32_32x32x16_bf16 v[48:63], a[144:147], a[48:51], v[48:63]
  ds_read_b64_tr_b16 a[152:153], v28 offset:36864
  ds_read_b64_tr_b16 a[154:155], v28 offset:37888
  s_waitcnt lgkmcnt(2)
  v_mfma_f32_32x32x16_bf16 v[48:63], a[148:151], a[52:55], v[48:63]
  ds_read_b64_tr_b16 a[156:157], v28 offset:38912
  ds_read_b64_tr_b16 a[158:159], v28 offset:39936
  s_waitcnt lgkmcnt(2)
  v_mfma_f32_32x32x16_bf16 v[48:63], a[152:155], a[56:59], v[48:63]
  ds_read_b64_tr_b16 a[144:145], v28 offset:40960
  ds_read_b64_tr_b16 a[146:147], v28 offset:41984
  s_waitcnt lgkmcnt(2)
  v_mfma_f32_32x32x16_bf16 v[48:63], a[156:159], a[60:63], v[48:63]
  ds_read_b64_tr_b16 a[148:149], v28 offset:43008
  ds_read_b64_tr_b16 a[150:151], v28 offset:44032
  s_waitcnt lgkmcnt(2)
  v_mfma_f32_32x32x16_bf16 v[48:63], a[144:147], a[64:67], v[48:63]
  ds_read_b64_tr_b16 a[152:153], v28 offset:45056
  ds_read_b64_tr_b16 a[154:155], v28 offset:46080
  s_waitcnt lgkmcnt(2)
  v_mfma_f32_32x32x16_bf16 v[48:63], a[148:151], a[68:71], v[48:63]
  ds_read_b64_tr_b16 a[156:157], v28 offset:47104
  ds_read_b64_tr_b16 a[158:159], v28 offset:48128
  s_waitcnt lgkmcnt(2)
  v_mfma_f32_32x32x16_bf16 v[48:63], a[152:155], a[72:75], v[48:63]
  ds_read_b64_tr_b16 a[144:145], v28 offset:49152
  ds_read_b64_tr_b16 a[146:147], v28 offset:50176
  s_waitcnt vmcnt(5)
  v_lshlrev_b32_e64 v32, 16, v64
  v_and_b32_e64 v33, s68, v64
  v_lshlrev_b32_e64 v34, 16, v65
  v_and_b32_e64 v35, s68, v65
  s_waitcnt lgkmcnt(2)
  v_mfma_f32_32x32x16_bf16 v[48:63], a[156:159], a[76:79], v[48:63]
  ds_read_b64_tr_b16 a[148:149], v28 offset:51200
  ds_read_b64_tr_b16 a[150:151], v28 offset:52224
  v_lshlrev_b32_e64 v36, 16, v66
  v_and_b32_e64 v37, s68, v66
  v_lshlrev_b32_e64 v38, 16, v67
  v_and_b32_e64 v39, s68, v67
  s_waitcnt lgkmcnt(2)
  v_mfma_f32_32x32x16_bf16 v[48:63], a[144:147], a[80:83], v[48:63]
  ds_read_b64_tr_b16 a[152:153], v28 offset:53248
  ds_read_b64_tr_b16 a[154:155], v28 offset:54272
  s_waitcnt vmcnt(4)
  v_lshlrev_b32_e64 v40, 16, v68
  v_and_b32_e64 v41, s68, v68
  v_lshlrev_b32_e64 v42, 16, v69
  v_and_b32_e64 v43, s68, v69
  s_waitcnt lgkmcnt(2)
  v_mfma_f32_32x32x16_bf16 v[48:63], a[148:151], a[84:87], v[48:63]
  ds_read_b64_tr_b16 a[156:157], v28 offset:55296
  ds_read_b64_tr_b16 a[158:159], v28 offset:56320
  v_lshlrev_b32_e64 v44, 16, v70
  v_and_b32_e64 v45, s68, v70
  v_lshlrev_b32_e64 v46, 16, v71
  v_and_b32_e64 v47, s68, v71
  s_waitcnt lgkmcnt(2)
  v_mfma_f32_32x32x16_bf16 v[48:63], a[152:155], a[88:91], v[48:63]
  s_barrier
  ds_read_b64_tr_b16 a[144:145], v3 offset:0
  ds_read_b64_tr_b16 a[146:147], v3 offset:1024
  s_waitcnt lgkmcnt(2)
  v_mfma_f32_32x32x16_bf16 v[48:63], a[156:159], a[92:95], v[48:63]
  ds_read_b64_tr_b16 a[148:149], v3 offset:2048
  ds_read_b64_tr_b16 a[150:151], v3 offset:3072
  s_waitcnt lgkmcnt(2)
  v_mfma_f32_32x32x16_bf16 v[32:47], a[144:147], a[0:3], v[32:47]
  ds_read_b64_tr_b16 a[152:153], v3 offset:4096
  ds_read_b64_tr_b16 a[154:155], v3 offset:5120
  s_waitcnt lgkmcnt(2)
  v_mfma_f32_32x32x16_bf16 v[32:47], a[148:151], a[4:7], v[32:47]
  ds_read_b64_tr_b16 a[156:157], v3 offset:6144
  ds_read_b64_tr_b16 a[158:159], v3 offset:7168
  s_nop 1
  v_cvt_pk_bf16_f32 v88, v48, v49
  v_cvt_pk_bf16_f32 v89, v50, v51
  v_cvt_pk_bf16_f32 v90, v52, v53
  v_cvt_pk_bf16_f32 v91, v54, v55
  s_waitcnt lgkmcnt(2)
  v_mfma_f32_32x32x16_bf16 v[32:47], a[152:155], a[8:11], v[32:47]
  ds_read_b64_tr_b16 a[144:145], v3 offset:8192
  ds_read_b64_tr_b16 a[146:147], v3 offset:9216
  v_cvt_pk_bf16_f32 v92, v56, v57
  v_cvt_pk_bf16_f32 v93, v58, v59
  v_cvt_pk_bf16_f32 v94, v60, v61
  v_cvt_pk_bf16_f32 v95, v62, v63
  s_waitcnt lgkmcnt(2)
  v_mfma_f32_32x32x16_bf16 v[32:47], a[156:159], a[12:15], v[32:47]
  ds_read_b64_tr_b16 a[148:149], v3 offset:10240
  ds_read_b64_tr_b16 a[150:151], v3 offset:11264
  s_add_u32 s50, s72, 8192
  s_addc_u32 s51, s73, 0
  global_store_dwordx4 v12, v[88:91], s[50:51] offset:0 sc1
  s_waitcnt lgkmcnt(2)
  v_mfma_f32_32x32x16_bf16 v[32:47], a[144:147], a[16:19], v[32:47]
  ds_read_b64_tr_b16 a[152:153], v3 offset:12288
  ds_read_b64_tr_b16 a[154:155], v3 offset:13312
  s_add_u32 s50, s72, 8192
  s_addc_u32 s51, s73, 0
  global_store_dwordx4 v12, v[92:95], s[50:51] offset:1024 sc1
  s_waitcnt lgkmcnt(2)
  v_mfma_f32_32x32x16_bf16 v[32:47], a[148:151], a[20:23], v[32:47]
  ds_read_b64_tr_b16 a[156:157], v3 offset:14336
  ds_read_b64_tr_b16 a[158:159], v3 offset:15360
  s_waitcnt lgkmcnt(2)
  v_mfma_f32_32x32x16_bf16 v[32:47], a[152:155], a[24:27], v[32:47]
  ds_read_b64_tr_b16 a[144:145], v3 offset:16384
  ds_read_b64_tr_b16 a[146:147], v3 offset:17408
  s_waitcnt lgkmcnt(2)
  v_mfma_f32_32x32x16_bf16 v[32:47], a[156:159], a[28:31], v[32:47]
  ds_read_b64_tr_b16 a[148:149], v3 offset:18432
  ds_read_b64_tr_b16 a[150:151], v3 offset:19456
  s_waitcnt lgkmcnt(2)
  v_mfma_f32_32x32x16_bf16 v[32:47], a[144:147], a[32:35], v[32:47]
  ds_read_b64_tr_b16 a[152:153], v3 offset:20480
  ds_read_b64_tr_b16 a[154:155], v3 offset:21504
  s_waitcnt lgkmcnt(2)
  v_mfma_f32_32x32x16_bf16 v[32:47], a[148:151], a[36:39], v[32:47]
  ds_read_b64_tr_b16 a[156:157], v3 offset:22528
  ds_read_b64_tr_b16 a[158:159], v3 offset:23552
  s_waitcnt vmcnt(2) lgkmcnt(2)
  v_mfma_f32_32x32x16_bf16 v[32:47], a[152:155], a[40:43], v[32:47]
  s_barrier
  ds_read_b64_tr_b16 a[144:145], v3 offset:24576
  ds_read_b64_tr_b16 a[146:147], v3 offset:25600
  s_waitcnt lgkmcnt(2)
  v_mfma_f32_32x32x16_bf16 v[32:47], a[156:159], a[44:47], v[32:47]
  ds_read_b64_tr_b16 a[148:149], v3 offset:26624
  ds_read_b64_tr_b16 a[150:151], v3 offset:27648
  s_waitcnt lgkmcnt(2)
  v_mfma_f32_32x32x16_bf16 v[32:47], a[144:147], a[48:51], v[32:47]
  ds_read_b64_tr_b16 a[152:153], v3 offset:28672
  ds_read_b64_tr_b16 a[154:155], v3 offset:29696
  s_waitcnt lgkmcnt(2)
  v_mfma_f32_32x32x16_bf16 v[32:47], a[148:151], a[52:55], v[32:47]
  ds_read_b64_tr_b16 a[156:157], v3 offset:30720
  ds_read_b64_tr_b16 a[158:159], v3 offset:31744
  s_waitcnt lgkmcnt(2)
  v_mfma_f32_32x32x16_bf16 v[32:47], a[152:155], a[56:59], v[32:47]
  ds_read_b64_tr_b16 a[144:145], v3 offset:32768
  ds_read_b64_tr_b16 a[146:147], v3 offset:33792
  s_waitcnt lgkmcnt(2)
  v_mfma_f32_32x32x16_bf16 v[32:47], a[156:159], a[60:63], v[32:47]
  ds_read_b64_tr_b16 a[148:149], v3 offset:34816
  ds_read_b64_tr_b16 a[150:151], v3 offset:35840
  s_waitcnt lgkmcnt(2)
  v_mfma_f32_32x32x16_bf16 v[32:47], a[144:147], a[64:67], v[32:47]
  ds_read_b64_tr_b16 a[152:153], v3 offset:36864
  ds_read_b64_tr_b16 a[154:155], v3 offset:37888
  s_waitcnt lgkmcnt(2)
  v_mfma_f32_32x32x16_bf16 v[32:47], a[148:151], a[68:71], v[32:47]
  ds_read_b64_tr_b16 a[156:157], v3 offset:38912
  ds_read_b64_tr_b16 a[158:159], v3 offset:39936
  s_waitcnt lgkmcnt(2)
  v_mfma_f32_32x32x16_bf16 v[32:47], a[152:155], a[72:75], v[32:47]
  ds_read_b64_tr_b16 a[144:145], v3 offset:40960
  ds_read_b64_tr_b16 a[146:147], v3 offset:41984
  s_waitcnt lgkmcnt(2)
  v_mfma_f32_32x32x16_bf16 v[32:47], a[156:159], a[76:79], v[32:47]
  ds_read_b64_tr_b16 a[148:149], v3 offset:43008
  ds_read_b64_tr_b16 a[150:151], v3 offset:44032
  s_waitcnt lgkmcnt(2)
  v_mfma_f32_32x32x16_bf16 v[32:47], a[144:147], a[80:83], v[32:47]
  ds_read_b64_tr_b16 a[152:153], v3 offset:45056
  ds_read_b64_tr_b16 a[154:155], v3 offset:46080
  s_waitcnt lgkmcnt(2)
  v_mfma_f32_32x32x16_bf16 v[32:47], a[148:151], a[84:87], v[32:47]
  ds_read_b64_tr_b16 a[156:157], v3 offset:47104
  ds_read_b64_tr_b16 a[158:159], v3 offset:48128
  s_waitcnt lgkmcnt(2)
  v_mfma_f32_32x32x16_bf16 v[32:47], a[152:155], a[88:91], v[32:47]
  s_waitcnt lgkmcnt(0)
  v_mfma_f32_32x32x16_bf16 v[32:47], a[156:159], a[92:95], v[32:47]
  s_nop 11
  v_cvt_pk_bf16_f32 v88, v32, v33
  v_cvt_pk_bf16_f32 v89, v34, v35
  v_cvt_pk_bf16_f32 v90, v36, v37
  v_cvt_pk_bf16_f32 v91, v38, v39
  s_add_u32 s50, s72, 12288
  s_addc_u32 s51, s73, 0
  global_store_dwordx4 v12, v[88:91], s[50:51] offset:0 sc1
  v_cvt_pk_bf16_f32 v92, v40, v41
  v_cvt_pk_bf16_f32 v93, v42, v43
  v_cvt_pk_bf16_f32 v94, v44, v45
  v_cvt_pk_bf16_f32 v95, v46, v47
  s_add_u32 s50, s72, 12288
  s_addc_u32 s51, s73, 0
  global_store_dwordx4 v12, v[92:95], s[50:51] offset:1024 sc1
  s_branch L_fin
L_sn0:
  s_sleep 2
  s_add_u32 s24, s24, 1
  s_cmp_ge_u32 s24, 400000
  s_cbranch_scc1 L_rn0
  buffer_load_dword v30, v31, s[60:63], 0 offen sc1
  s_waitcnt vmcnt(0)
  v_readfirstlane_b32 s59, v30
  s_nop 3
  s_cmp_eq_u32 s59, 0
  s_cbranch_scc1 L_sn0
  s_branch L_rn0
L_sf0_5:
  s_sleep 2
  s_add_u32 s24, s24, 1
  s_cmp_ge_u32 s24, 400000
  s_cbranch_scc1 L_rf0_5
  buffer_load_dword v29, v31, s[20:23], s58 offen offset:0 sc1
  s_waitcnt vmcnt(0)
  v_readfirstlane_b32 s33, v29
  s_nop 3
  s_cmp_lg_u32 s33, s59
  s_cbranch_scc1 L_sf0_5
  s_branch L_rf0_5
L_sf0_6:
  s_sleep 2
  s_add_u32 s24, s24, 1
  s_cmp_ge_u32 s24, 400000
  s_cbranch_scc1 L_rf0_6
  buffer_load_dword v29, v31, s[20:23], s58 offen offset:4 sc1
  s_waitcnt vmcnt(0)
  v_readfirstlane_b32 s33, v29
  s_nop 3
  s_cmp_lg_u32 s33, s59
  s_cbranch_scc1 L_sf0_6
  s_branch L_rf0_6
L_sf0_7:
  s_sleep 2
  s_add_u32 s24, s24, 1
  s_cmp_ge_u32 s24, 400000
  s_cbranch_scc1 L_rf0_7
  buffer_load_dword v29, v31, s[20:23], s58 offen offset:8 sc1
  s_waitcnt vmcnt(0)
  v_readfirstlane_b32 s33, v29
  s_nop 3
  s_cmp_lg_u32 s33, s59
  s_cbranch_scc1 L_sf0_7
  s_branch L_rf0_7
L_sf0_8:
  s_sleep 2
  s_add_u32 s24, s24, 1
  s_cmp_ge_u32 s24, 400000
  s_cbranch_scc1 L_rf0_8
  buffer_load_dword v29, v31, s[20:23], s58 offen offset:12 sc1
  s_waitcnt vmcnt(0)
  v_readfirstlane_b32 s33, v29
  s_nop 3
  s_cmp_lg_u32 s33, s59
  s_cbranch_scc1 L_sf0_8
  s_branch L_rf0_8
  s_branch L_fin
L_abr:
  s_load_dwordx4 s[40:43], s[0:1], 0
  s_load_dwordx4 s[44:47], s[0:1], 16
  s_load_dwordx4 s[48:51], s[0:1], 32
  s_load_dwordx2 s[52:53], s[0:1], 48
  s_load_dwordx2 s[54:55], s[0:1], 88
  s_load_dwordx2 s[74:75], s[0:1], 112
  s_load_dwordx2 s[4:5], s[0:1], 64
  s_load_dwordx2 s[6:7], s[0:1], 80
  s_getpc_b64 s[70:71]
L_abr_pc:
  v_lshrrev_b32 v2, 6, v0
  v_and_b32 v1, 63, v0
  s_sub_u32 s67, s2, 192
  s_lshr_b32 s67, s67, 3
  s_and_b32 s36, s2, 7
  s_lshl_b32 s36, s36, 3
  s_add_u32 s36, s36, s67
  s_lshl_b32 s37, s36, 3
  v_readfirstlane_b32 s35, v2
  s_mov_b32 s34, 1069066811
  s_mov_b32 s33, 1042479491
  s_nop 1
  s_cmp_ge_u32 s35, 4
  s_cbranch_scc1 L_cwave
  v_lshlrev_b32 v26, 7, v0
  v_min_u32 v26, L_main_end-L_abr_pc, v26
  global_load_dword v27, v26, s[70:71]
  s_add_u32 s70, s70, L_ktab-L_abr_pc
  s_addc_u32 s71, s71, 0
  v_mul_u32_u24 v3, 24, v1
  global_load_dword v75, v3, s[70:71] offset:20
  s_lshl_b32 s38, s37, 8
  v_lshlrev_b32 v3, 1, v0
  s_lshl_b32 s39, s37, 1
  v_lshrrev_b32 v4, 7, v0
  v_lshlrev_b32 v4, 1, v4
  s_waitcnt lgkmcnt(0)
  s_mov_b32 s12, s42
  s_mov_b32 s13, s43
  s_mov_b32 s14, 147456
  s_mov_b32 s15, 0x20000
  s_mov_b32 s16, s44
  s_mov_b32 s17, s45
  s_mov_b32 s18, 147456
  s_mov_b32 s19, 0x20000
  s_mov_b32 s24, s46
  s_mov_b32 s25, s47
  s_mov_b32 s26, 147456
  s_mov_b32 s27, 0x20000
  s_mov_b32 s28, s48
  s_mov_b32 s29, s49
  s_mov_b32 s30, 147456
  s_mov_b32 s31, 0x20000
  s_mov_b32 s76, s50
  s_mov_b32 s77, s51
  s_mov_b32 s78, 1152
  s_mov_b32 s79, 0x20000
  buffer_load_ushort v28, v3, s[12:15], s38 offen offset:0
  buffer_load_ushort v32, v4, s[76:79], s39 offen offset:0
  buffer_load_ushort v29, v3, s[16:19], s38 offen offset:0
  buffer_load_ushort v30, v3, s[24:27], s38 offen offset:0
  buffer_load_ushort v31, v3, s[28:31], s38 offen offset:0
  buffer_load_ushort v36, v3, s[12:15], s38 offen offset:512
  buffer_load_ushort v40, v4, s[76:79], s39 offen offset:4
  buffer_load_ushort v37, v3, s[16:19], s38 offen offset:512
  buffer_load_ushort v38, v3, s[24:27], s38 offen offset:512
  buffer_load_ushort v39, v3, s[28:31], s38 offen offset:512
  buffer_load_ushort v44, v3, s[12:15], s38 offen offset:1024
  buffer_load_ushort v48, v4, s[76:79], s39 offen offset:8
  buffer_load_ushort v45, v3, s[16:19], s38 offen offset:1024
  buffer_load_ushort v46, v3, s[24:27], s38 offen offset:1024
  buffer_load_ushort v47, v3, s[28:31], s38 offen offset:1024
  buffer_load_ushort v52, v3, s[12:15], s38 offen offset:1536
  buffer_load_ushort v56, v4, s[76:79], s39 offen offset:12
  buffer_load_ushort v53, v3, s[16:19], s38 offen offset:1536
  buffer_load_ushort v54, v3, s[24:27], s38 offen offset:1536
  buffer_load_ushort v55, v3, s[28:31], s38 offen offset:1536
  s_lshl_b32 s38, s36, 8
  s_add_u32 s38, s38, 129024
  s_lshl_b32 s39, s36, 1
  s_add_u32 s39, s39, 1008
  buffer_load_ushort v60, v3, s[12:15], s38 offen offset:2048
  buffer_load_ushort v64, v4, s[76:79], s39 offen offset:16
  buffer_load_ushort v61, v3, s[16:19], s38 offen offset:2048
  buffer_load_ushort v62, v3, s[24:27], s38 offen offset:2048
  buffer_load_ushort v63, v3, s[28:31], s38 offen offset:2048
  s_mov_b32 s80, s52
  s_mov_b32 s81, s53
  s_mov_b32 s82, 1152
  s_mov_b32 s83, 0x20000
  v_add_u32 v94, s37, v1
  s_add_u32 s39, s36, 512
  v_mov_b32 v95, s39
  v_cmp_eq_u32 vcc, 8, v1
  s_nop 1
  v_cndmask_b32 v94, v94, v95, vcc
  v_lshlrev_b32 v94, 1, v94
  buffer_load_ushort v94, v94, s[80:83], 0 offen
  v_cmp_eq_u32 vcc, 144, v0
  s_nop 1
  v_cndmask_b32_e64 v95, 0, 1.0, vcc
  s_mov_b32 s64, 0
  s_and_b32 s58, s2, 7
  s_lshr_b32 s58, s58, 1
  s_mul_i32 s58, s58, 3
  s_lshl_b32 s59, s67, 2
  s_add_u32 s59, s59, s35
  s_mul_i32 s60, s58, 442368
  s_add_u32 s16, s6, s60
  s_addc_u32 s17, s7, 0
  s_mov_b32 s18, 1327104
  s_mov_b32 s19, 0x20000
  s_mov_b32 s12, s4
  s_mov_b32 s13, s5
  s_mov_b32 s14, 5308416
  s_mov_b32 s15, 0x20000
  s_min_u32 s60, s59, 26
  s_mul_i32 s61, s60, 57
  s_lshr_b32 s61, s61, 9
  s_mul_i32 s62, s61, 9
  s_sub_u32 s62, s60, s62
  s_add_u32 s58, s58, s61
  s_mul_i32 s58, s58, 768
  s_mul_i32 s62, s62, 589824
  s_add_u32 s58, s58, s62
  v_mul_u32_u24 v3, 9216, v1
  v_lshlrev_b32 v26, 7, v1
  s_lshl_b32 s59, s59, 13
  s_add_u32 s58, s58, 256
  s_add_u32 s60, s58, 384
  s_mov_b32 s20, s74
  s_mov_b32 s21, s75
  s_mov_b32 s22, 268435456
  s_mov_b32 s23, 0x20000
  s_mov_b32 s8, s40
  s_mov_b32 s9, s41
  s_mov_b32 s10, 2359296
  s_mov_b32 s11, 0x20000
  s_mov_b32 s84, s54
  s_mov_b32 s85, s55
  s_mov_b32 s86, 1152
  s_mov_b32 s87, 0x20000
  v_and_b32 v88, 15, v1
  v_lshrrev_b32 v89, 4, v1
  v_lshlrev_b32 v90, 3, v88
  v_cvt_f32_u32 v4, v90
  s_lshl_b32 s38, s35, 10
  v_lshlrev_b32 v6, 7, v89
  v_add_u32 v6, s38, v6
  v_add_u32 v6, 74752, v6
  v_lshlrev_b32 v8, 4, v0
  v_add_u32 v8, 111616, v8
  s_mul_i32 s38, s35, 3072
  v_lshlrev_b32 v7, 4, v1
  v_add_u32 v7, s38, v7
  v_add_u32 v7, 111616, v7
  s_lshl_b32 s38, s35, 10
  v_lshlrev_b32 v9, 8, v89
  v_lshl_add_u32 v9, v88, 2, v9
  v_add_u32 v9, s38, v9
  v_add_u32 v9, 136192, v9
  v_cmp_eq_u32 s[72:73], 4, v88
  v_mov_b32 v5, 0x3f80
  s_mov_b32 s68, -1
  s_mov_b32 s69, 0
  v_lshlrev_b32 v92, 5, v0
  v_add_u32 v92, 74752, v92
  s_mov_b32 s56, 0x43000000
  s_mov_b32 s57, 0x44800000
  s_waitcnt vmcnt(26)
  v_lshrrev_b32 v2, 16, v75
  v_cvt_f32_u32 v2, v2
  s_waitcnt vmcnt(25)
  v_lshlrev_b32 v28, 16, v28
  s_waitcnt vmcnt(20)
  v_lshlrev_b32 v36, 16, v36
  v_lshlrev_b32 v32, 16, v32
  s_waitcnt vmcnt(19)
  v_lshlrev_b32 v40, 16, v40
  v_mul_f32 v28, s34, v28
  v_mul_f32 v36, s34, v36
  v_mul_f32 v32, s34, v32
  v_mul_f32 v40, s34, v40
  v_exp_f32 v28, v28
  v_exp_f32 v36, v36
  v_exp_f32 v32, v32
  v_exp_f32 v40, v40
  v_lshlrev_b32 v29, 16, v29
  s_waitcnt vmcnt(18)
  v_lshlrev_b32 v37, 16, v37
  v_lshlrev_b32 v30, 16, v30
  s_waitcnt vmcnt(17)
  v_lshlrev_b32 v38, 16, v38
  v_lshlrev_b32 v31, 16, v31
  s_waitcnt vmcnt(16)
  v_lshlrev_b32 v39, 16, v39
  v_cvt_pk_bf16_f32 v33, v28, v32
  v_cvt_pk_bf16_f32 v41, v36, v40
  v_lshlrev_b32 v28, 16, v33
  v_lshlrev_b32 v36, 16, v41
  v_and_b32 v32, 0xffff0000, v33
  v_and_b32 v40, 0xffff0000, v41
  v_mul_f32 v28, v28, v32
  v_mul_f32 v36, v36, v40
  v_mul_f32 v29, v29, v32
  v_mul_f32 v37, v37, v40
  v_mul_f32 v30, v30, v32
  v_mul_f32 v38, v38, v40
  v_mul_f32 v31, v31, v32
  v_mul_f32 v39, v39, v40
  v_mul_f32_e64 v28, -v28, s34
  v_mul_f32_e64 v36, -v36, s34
  v_mul_f32 v29, s33, v29
  v_mul_f32 v37, s33, v37
  v_add_f32 v30, v30, v30
  v_add_f32 v38, v38, v38
  v_add_f32 v31, v31, v31
  v_add_f32 v39, v39, v39
  v_rndne_f32 v68, v29
  v_rndne_f32 v72, v37
  v_sub_f32 v29, v29, v68
  v_sub_f32 v37, v37, v72
  v_mul_f32 v68, s56, v28
  v_mul_f32 v72, s56, v36
  v_mul_f32 v69, s57, v28
  v_mul_f32 v73, s57, v36
  v_mul_f32 v70, s56, v29
  v_mul_f32 v74, s56, v37
  v_mul_f32 v71, s57, v29
  v_mul_f32 v75, s57, v37
  v_exp_f32 v68, v68
  v_exp_f32 v72, v72
  v_exp_f32 v69, v69
  v_exp_f32 v73, v73
  v_fract_f32 v71, v71
  v_fract_f32 v75, v75
  v_cos_f32 v32, v70
  v_cos_f32 v40, v74
  v_sin_f32 v33, v70
  v_sin_f32 v41, v74
  v_cos_f32 v34, v71
  v_cos_f32 v42, v75
  v_sin_f32 v35, v71
  v_sin_f32 v43, v75
  v_mul_f32 v32, v32, v68
  v_mul_f32 v40, v40, v72
  v_mul_f32 v33, v33, v68
  v_mul_f32 v41, v41, v72
  v_mul_f32 v34, v34, v69
  v_mul_f32 v42, v42, v73
  v_mul_f32 v35, v35, v69
  v_mul_f32 v43, v43, v73
  ds_write_b128 v92, v[28:31] offset:0
  ds_write_b128 v92, v[32:35] offset:16
  ds_write_b128 v92, v[36:39] offset:8192
  ds_write_b128 v92, v[40:43] offset:8208
  s_waitcnt vmcnt(15)
  v_lshlrev_b32 v44, 16, v44
  s_waitcnt vmcnt(10)
  v_lshlrev_b32 v52, 16, v52
  v_lshlrev_b32 v48, 16, v48
  s_waitcnt vmcnt(9)
  v_lshlrev_b32 v56, 16, v56
  v_mul_f32 v44, s34, v44
  v_mul_f32 v52, s34, v52
  v_mul_f32 v48, s34, v48
  v_mul_f32 v56, s34, v56
  v_exp_f32 v44, v44
  v_exp_f32 v52, v52
  v_exp_f32 v48, v48
  v_exp_f32 v56, v56
  v_lshlrev_b32 v45, 16, v45
  s_waitcnt vmcnt(8)
  v_lshlrev_b32 v53, 16, v53
  v_lshlrev_b32 v46, 16, v46
  s_waitcnt vmcnt(7)
  v_lshlrev_b32 v54, 16, v54
  v_lshlrev_b32 v47, 16, v47
  s_waitcnt vmcnt(6)
  v_lshlrev_b32 v55, 16, v55
  v_cvt_pk_bf16_f32 v49, v44, v48
  v_cvt_pk_bf16_f32 v57, v52, v56
  v_lshlrev_b32 v44, 16, v49
  v_lshlrev_b32 v52, 16, v57
  v_and_b32 v48, 0xffff0000, v49
  v_and_b32 v56, 0xffff0000, v57
  v_mul_f32 v44, v44, v48
  v_mul_f32 v52, v52, v56
  v_mul_f32 v45, v45, v48
  v_mul_f32 v53, v53, v56
  v_mul_f32 v46, v46, v48
  v_mul_f32 v54, v54, v56
  v_mul_f32 v47, v47, v48
  v_mul_f32 v55, v55, v56
  v_mul_f32_e64 v44, -v44, s34
  v_mul_f32_e64 v52, -v52, s34
  v_mul_f32 v45, s33, v45
  v_mul_f32 v53, s33, v53
  v_add_f32 v46, v46, v46
  v_add_f32 v54, v54, v54
  v_add_f32 v47, v47, v47
  v_add_f32 v55, v55, v55
  v_rndne_f32 v68, v45
  v_rndne_f32 v72, v53
  v_sub_f32 v45, v45, v68
  v_sub_f32 v53, v53, v72
  v_mul_f32 v68, s56, v44
  v_mul_f32 v72, s56, v52
  v_mul_f32 v69, s57, v44
  v_mul_f32 v73, s57, v52
  v_mul_f32 v70, s56, v45
  v_mul_f32 v74, s56, v53
  v_mul_f32 v71, s57, v45
  v_mul_f32 v75, s57, v53
  v_exp_f32 v68, v68
  v_exp_f32 v72, v72
  v_exp_f32 v69, v69
  v_exp_f32 v73, v73
  v_fract_f32 v71, v71
  v_fract_f32 v75, v75
  v_cos_f32 v48, v70
  v_cos_f32 v56, v74
  v_sin_f32 v49, v70
  v_sin_f32 v57, v74
  v_cos_f32 v50, v71
  v_cos_f32 v58, v75
  v_sin_f32 v51, v71
  v_sin_f32 v59, v75
  v_mul_f32 v48, v48, v68
  v_mul_f32 v56, v56, v72
  v_mul_f32 v49, v49, v68
  v_mul_f32 v57, v57, v72
  v_mul_f32 v50, v50, v69
  v_mul_f32 v58, v58, v73
  v_mul_f32 v51, v51, v69
  v_mul_f32 v59, v59, v73
  ds_write_b128 v92, v[44:47] offset:16384
  ds_write_b128 v92, v[48:51] offset:16400
  ds_write_b128 v92, v[52:55] offset:24576
  ds_write_b128 v92, v[56:59] offset:24592
  s_waitcnt vmcnt(5)
  v_lshlrev_b32 v60, 16, v60
  s_waitcnt vmcnt(4)
  v_lshlrev_b32 v64, 16, v64
  v_mul_f32 v60, s34, v60
  v_mul_f32 v64, s34, v64
  v_exp_f32 v60, v60
  v_exp_f32 v64, v64
  s_waitcnt vmcnt(3)
  v_lshlrev_b32 v61, 16, v61
  s_waitcnt vmcnt(2)
  v_lshlrev_b32 v62, 16, v62
  s_waitcnt vmcnt(1)
  v_lshlrev_b32 v63, 16, v63
  v_cvt_pk_bf16_f32 v65, v60, v64
  v_lshlrev_b32 v60, 16, v65
  v_and_b32 v64, 0xffff0000, v65
  v_mul_f32 v60, v60, v64
  v_mul_f32 v61, v61, v64
  v_mul_f32 v62, v62, v64
  v_mul_f32 v63, v63, v64
  v_mul_f32_e64 v60, -v60, s34
  v_mul_f32 v61, s33, v61
  v_add_f32 v62, v62, v62
  v_add_f32 v63, v63, v63
  v_rndne_f32 v68, v61
  v_sub_f32 v61, v61, v68
  v_mul_f32 v68, s56, v60
  v_mul_f32 v69, s57, v60
  v_mul_f32 v70, s56, v61
  v_mul_f32 v71, s57, v61
  v_exp_f32 v68, v68
  v_exp_f32 v69, v69
  v_fract_f32 v71, v71
  v_cos_f32 v64, v70
  v_sin_f32 v65, v70
  v_cos_f32 v66, v71
  v_sin_f32 v67, v71
  v_mul_f32 v64, v64, v68
  v_mul_f32 v65, v65, v68
  v_mul_f32 v66, v66, v69
  v_mul_f32 v67, v67, v69
  v_cmp_gt_u32 vcc, 128, v0
  s_nop 3
  s_and_saveexec_b64 s[38:39], vcc
  ds_write_b128 v92, v[60:63] offset:32768
  ds_write_b128 v92, v[64:67] offset:32784
  s_mov_b64 exec, s[38:39]
  s_waitcnt vmcnt(0)
  v_lshlrev_b32 v94, 16, v94
  s_waitcnt lgkmcnt(0)
  s_barrier
  ds_read_b128 v[28:31], v6 offset:0
  ds_read_b128 v[32:35], v6 offset:16
  ds_read_b128 v[36:39], v6 offset:32
  ds_read_b128 v[40:43], v6 offset:48
  ds_read_b128 v[44:47], v6 offset:64
  ds_read_b128 v[48:51], v6 offset:80
  ds_read_b128 v[52:55], v6 offset:96
  ds_read_b128 v[56:59], v6 offset:112
  s_cmp_lt_u32 s35, 3
  s_cselect_b64 s[78:79], -1, 0
  s_waitcnt lgkmcnt(7)
  v_mul_f32 v76, v28, v2
  v_mul_f32 v80, v28, v4
  s_waitcnt lgkmcnt(5)
  v_mul_f32 v84, v36, v2
  v_mul_f32 v88, v36, v4
  v_mul_f32 v77, v29, v2
  v_mul_f32 v81, v29, v4
  v_mul_f32 v85, v37, v2
  v_mul_f32 v89, v37, v4
  v_exp_f32 v76, v76
  v_exp_f32 v80, v80
  v_exp_f32 v84, v84
  v_exp_f32 v88, v88
  v_fract_f32 v77, v77
  v_cos_f32 v82, v81
  v_fract_f32 v85, v85
  v_cos_f32 v90, v89
  v_cos_f32 v78, v77
  v_sin_f32 v83, v81
  v_cos_f32 v86, v85
  v_sin_f32 v91, v89
  v_sin_f32 v79, v77
  v_mul_f32 v82, v82, v80
  v_sin_f32 v87, v85
  v_mul_f32 v90, v90, v88
  v_mul_f32 v78, v78, v76
  v_mul_f32 v83, v83, v80
  v_mul_f32 v86, v86, v84
  v_mul_f32 v91, v91, v88
  v_mul_f32 v79, v79, v76
  v_mul_f32 v80, v82, v30
  v_mul_f32 v87, v87, v84
  v_mul_f32 v88, v90, v38
  v_cvt_pk_bf16_f32 v60, v78, v79
  v_mul_f32 v81, v82, v31
  v_cvt_pk_bf16_f32 v61, v86, v87
  v_mul_f32 v89, v90, v39
  v_mul_f32 v76, v78, v34
  v_fma_f32 v80, -v83, v31, v80
  s_waitcnt lgkmcnt(4)
  v_mul_f32 v84, v86, v42
  v_fma_f32 v88, -v91, v39, v88
  v_mul_f32 v77, v78, v35
  v_fma_f32 v81, -v83, v30, -v81
  v_mul_f32 v85, v86, v43
  v_fma_f32 v89, -v91, v38, -v89
  v_fma_f32 v76, -v79, v35, v76
  v_cvt_pk_bf16_f32 v68, v80, v81
  v_fma_f32 v84, -v87, v43, v84
  v_cvt_pk_bf16_f32 v69, v88, v89
  v_fmac_f32 v77, v79, v34
  v_mul_f32 v82, v80, v32
  v_fmac_f32 v85, v87, v42
  v_mul_f32 v90, v88, v40
  v_cvt_pk_bf16_f32 v64, v76, v77
  v_mul_f32 v83, v81, v32
  v_cvt_pk_bf16_f32 v65, v84, v85
  v_mul_f32 v91, v89, v40
  v_cndmask_b32 v64, v64, v5, s[72:73]
  v_fmac_f32 v82, v81, v33
  v_cndmask_b32 v65, v65, v5, s[72:73]
  v_fmac_f32 v90, v89, v41
  v_fma_f32 v83, -v80, v33, v83
  v_fma_f32 v91, -v88, v41, v91
  v_cvt_pk_bf16_f32 v72, v82, v83
  v_cvt_pk_bf16_f32 v73, v90, v91
  ds_read_b128 v[28:31], v6 offset:512
  ds_read_b128 v[32:35], v6 offset:528
  ds_read_b128 v[36:39], v6 offset:544
  ds_read_b128 v[40:43], v6 offset:560
  s_waitcnt lgkmcnt(7)
  v_mul_f32 v76, v44, v2
  v_mul_f32 v80, v44, v4
  s_waitcnt lgkmcnt(5)
  v_mul_f32 v84, v52, v2
  v_mul_f32 v88, v52, v4
  v_mul_f32 v77, v45, v2
  v_mul_f32 v81, v45, v4
  v_mul_f32 v85, v53, v2
  v_mul_f32 v89, v53, v4
  v_exp_f32 v76, v76
  v_exp_f32 v80, v80
  v_exp_f32 v84, v84
  v_exp_f32 v88, v88
  v_fract_f32 v77, v77
  v_cos_f32 v82, v81
  v_fract_f32 v85, v85
  v_cos_f32 v90, v89
  v_cos_f32 v78, v77
  v_sin_f32 v83, v81
  v_cos_f32 v86, v85
  v_sin_f32 v91, v89
  v_sin_f32 v79, v77
  v_mul_f32 v82, v82, v80
  v_sin_f32 v87, v85
  v_mul_f32 v90, v90, v88
  v_mul_f32 v78, v78, v76
  v_mul_f32 v83, v83, v80
  v_mul_f32 v86, v86, v84
  v_mul_f32 v91, v91, v88
  v_mul_f32 v79, v79, v76
  v_mul_f32 v80, v82, v46
  v_mul_f32 v87, v87, v84
  v_mul_f32 v88, v90, v54
  v_cvt_pk_bf16_f32 v62, v78, v79
  v_mul_f32 v81, v82, v47
  v_cvt_pk_bf16_f32 v63, v86, v87
  v_mul_f32 v89, v90, v55
  v_mul_f32 v76, v78, v50
  v_fma_f32 v80, -v83, v47, v80
  s_waitcnt lgkmcnt(4)
  v_mul_f32 v84, v86, v58
  v_fma_f32 v88, -v91, v55, v88
  v_mul_f32 v77, v78, v51
  v_fma_f32 v81, -v83, v46, -v81
  v_mul_f32 v85, v86, v59
  v_fma_f32 v89, -v91, v54, -v89
  v_fma_f32 v76, -v79, v51, v76
  v_cvt_pk_bf16_f32 v70, v80, v81
  v_fma_f32 v84, -v87, v59, v84
  v_cvt_pk_bf16_f32 v71, v88, v89
  v_fmac_f32 v77, v79, v50
  v_mul_f32 v82, v80, v48
  v_fmac_f32 v85, v87, v58
  v_mul_f32 v90, v88, v56
  v_cvt_pk_bf16_f32 v66, v76, v77
  v_mul_f32 v83, v81, v48
  v_cvt_pk_bf16_f32 v67, v84, v85
  v_mul_f32 v91, v89, v56
  v_cndmask_b32 v66, v66, v5, s[72:73]
  v_fmac_f32 v82, v81, v49
  v_cndmask_b32 v67, v67, v5, s[72:73]
  v_fmac_f32 v90, v89, v57
  v_fma_f32 v83, -v80, v49, v83
  v_fma_f32 v91, -v88, v57, v91
  v_cvt_pk_bf16_f32 v74, v82, v83
  v_cvt_pk_bf16_f32 v75, v90, v91
  ds_read_b128 v[44:47], v6 offset:576
  ds_read_b128 v[48:51], v6 offset:592
  ds_read_b128 v[52:55], v6 offset:608
  ds_read_b128 v[56:59], v6 offset:624
  v_mfma_f32_16x16x32_bf16 a[0:3], v[60:63], v[68:71], 0
  v_mfma_f32_16x16x32_bf16 a[4:7], v[60:63], v[72:75], 0
  v_mfma_f32_16x16x32_bf16 a[8:11], v[64:67], v[68:71], 0
  v_mfma_f32_16x16x32_bf16 a[12:15], v[64:67], v[72:75], 0
  s_waitcnt lgkmcnt(7)
  v_mul_f32 v76, v28, v2
  v_mul_f32 v80, v28, v4
  s_waitcnt lgkmcnt(5)
  v_mul_f32 v84, v36, v2
  v_mul_f32 v88, v36, v4
  v_mul_f32 v77, v29, v2
  v_mul_f32 v81, v29, v4
  v_mul_f32 v85, v37, v2
  v_mul_f32 v89, v37, v4
  v_exp_f32 v76, v76
  v_exp_f32 v80, v80
  v_exp_f32 v84, v84
  v_exp_f32 v88, v88
  v_fract_f32 v77, v77
  v_cos_f32 v82, v81
  v_fract_f32 v85, v85
  v_cos_f32 v90, v89
  v_cos_f32 v78, v77
  v_sin_f32 v83, v81
  v_cos_f32 v86, v85
  v_sin_f32 v91, v89
  v_sin_f32 v79, v77
  v_mul_f32 v82, v82, v80
  v_sin_f32 v87, v85
  v_mul_f32 v90, v90, v88
  v_mul_f32 v78, v78, v76
  v_mul_f32 v83, v83, v80
  v_mul_f32 v86, v86, v84
  v_mul_f32 v91, v91, v88
  v_mul_f32 v79, v79, v76
  v_mul_f32 v80, v82, v30
  v_mul_f32 v87, v87, v84
  v_mul_f32 v88, v90, v38
  v_cvt_pk_bf16_f32 v60, v78, v79
  v_mul_f32 v81, v82, v31
  v_cvt_pk_bf16_f32 v61, v86, v87
  v_mul_f32 v89, v90, v39
  v_mul_f32 v76, v78, v34
  v_fma_f32 v80, -v83, v31, v80
  s_waitcnt lgkmcnt(4)
  v_mul_f32 v84, v86, v42
  v_fma_f32 v88, -v91, v39, v88
  v_mul_f32 v77, v78, v35
  v_fma_f32 v81, -v83, v30, -v81
  v_mul_f32 v85, v86, v43
  v_fma_f32 v89, -v91, v38, -v89
  v_fma_f32 v76, -v79, v35, v76
  v_cvt_pk_bf16_f32 v68, v80, v81
  v_fma_f32 v84, -v87, v43, v84
  v_cvt_pk_bf16_f32 v69, v88, v89
  v_fmac_f32 v77, v79, v34
  v_mul_f32 v82, v80, v32
  v_fmac_f32 v85, v87, v42
  v_mul_f32 v90, v88, v40
  v_cvt_pk_bf16_f32 v64, v76, v77
  v_mul_f32 v83, v81, v32
  v_cvt_pk_bf16_f32 v65, v84, v85
  v_mul_f32 v91, v89, v40
  v_cndmask_b32 v64, v64, v5, s[72:73]
  v_fmac_f32 v82, v81, v33
  v_cndmask_b32 v65, v65, v5, s[72:73]
  v_fmac_f32 v90, v89, v41
  v_fma_f32 v83, -v80, v33, v83
  v_fma_f32 v91, -v88, v41, v91
  v_cvt_pk_bf16_f32 v72, v82, v83
  v_cvt_pk_bf16_f32 v73, v90, v91
  s_waitcnt lgkmcnt(3)
  v_mul_f32 v76, v44, v2
  v_mul_f32 v80, v44, v4
  s_waitcnt lgkmcnt(1)
  v_mul_f32 v84, v52, v2
  v_mul_f32 v88, v52, v4
  v_mul_f32 v77, v45, v2
  v_mul_f32 v81, v45, v4
  v_mul_f32 v85, v53, v2
  v_mul_f32 v89, v53, v4
  v_exp_f32 v76, v76
  v_exp_f32 v80, v80
  v_exp_f32 v84, v84
  v_exp_f32 v88, v88
  v_fract_f32 v77, v77
  v_cos_f32 v82, v81
  v_fract_f32 v85, v85
  v_cos_f32 v90, v89
  v_cos_f32 v78, v77
  v_sin_f32 v83, v81
  v_cos_f32 v86, v85
  v_sin_f32 v91, v89
  v_sin_f32 v79, v77
  v_mul_f32 v82, v82, v80
  v_sin_f32 v87, v85
  v_mul_f32 v90, v90, v88
  v_mul_f32 v78, v78, v76
  v_mul_f32 v83, v83, v80
  v_mul_f32 v86, v86, v84
  v_mul_f32 v91, v91, v88
  v_mul_f32 v79, v79, v76
  v_mul_f32 v80, v82, v46
  v_mul_f32 v87, v87, v84
  v_mul_f32 v88, v90, v54
  v_cvt_pk_bf16_f32 v62, v78, v79
  v_mul_f32 v81, v82, v47
  v_cvt_pk_bf16_f32 v63, v86, v87
  v_mul_f32 v89, v90, v55
  v_mul_f32 v76, v78, v50
  v_fma_f32 v80, -v83, v47, v80
  s_waitcnt lgkmcnt(0)
  v_mul_f32 v84, v86, v58
  v_fma_f32 v88, -v91, v55, v88
  v_mul_f32 v77, v78, v51
  v_fma_f32 v81, -v83, v46, -v81
  v_mul_f32 v85, v86, v59
  v_fma_f32 v89, -v91, v54, -v89
  v_fma_f32 v76, -v79, v51, v76
  v_cvt_pk_bf16_f32 v70, v80, v81
  v_fma_f32 v84, -v87, v59, v84
  v_cvt_pk_bf16_f32 v71, v88, v89
  v_fmac_f32 v77, v79, v50
  v_mul_f32 v82, v80, v48
  v_fmac_f32 v85, v87, v58
  v_mul_f32 v90, v88, v56
  v_cvt_pk_bf16_f32 v66, v76, v77
  v_mul_f32 v83, v81, v48
  v_cvt_pk_bf16_f32 v67, v84, v85
  v_mul_f32 v91, v89, v56
  v_cndmask_b32 v66, v66, v5, s[72:73]
  v_fmac_f32 v82, v81, v49
  v_cndmask_b32 v67, v67, v5, s[72:73]
  v_fmac_f32 v90, v89, v57
  v_fma_f32 v83, -v80, v49, v83
  v_fma_f32 v91, -v88, v57, v91
  v_cvt_pk_bf16_f32 v74, v82, v83
  v_cvt_pk_bf16_f32 v75, v90, v91
  v_mfma_f32_16x16x32_bf16 a[0:3], v[60:63], v[68:71], a[0:3]
  s_nop 0
  v_mfma_f32_16x16x32_bf16 a[4:7], v[60:63], v[72:75], a[4:7]
  v_mfma_f32_16x16x32_bf16 a[8:11], v[64:67], v[68:71], a[8:11]
  v_mfma_f32_16x16x32_bf16 a[12:15], v[64:67], v[72:75], a[12:15]
  v_add_u32 v6, 4096, v6
  ds_read_b128 v[28:31], v6 offset:0
  ds_read_b128 v[32:35], v6 offset:16
  ds_read_b128 v[36:39], v6 offset:32
  ds_read_b128 v[40:43], v6 offset:48
  ds_read_b128 v[44:47], v6 offset:64
  ds_read_b128 v[48:51], v6 offset:80
  ds_read_b128 v[52:55], v6 offset:96
  ds_read_b128 v[56:59], v6 offset:112
  ds_write_b128 v7, a[0:3] offset:0
  ds_write_b128 v7, a[4:7] offset:1024
  s_mov_b64 exec, s[68:69]
  ds_write_b128 v7, a[8:11] offset:2048
  ds_write_b128 v7, a[12:15] offset:2560
  s_mov_b64 exec, -1
  s_waitcnt lgkmcnt(0)
  s_barrier
  s_mov_b32 s38, 4
  .p2align 3
L_kloop:
  ds_read_b128 v[10:13], v8 offset:0
  ds_read_b128 v[14:17], v8 offset:3072
  ds_read_b128 v[18:21], v8 offset:6144
  ds_read_b128 v[22:25], v8 offset:9216
  v_mul_f32 v76, v28, v2
  v_mul_f32 v80, v28, v4
  v_mul_f32 v84, v36, v2
  v_mul_f32 v88, v36, v4
  v_mul_f32 v77, v29, v2
  v_mul_f32 v81, v29, v4
  v_mul_f32 v85, v37, v2
  v_mul_f32 v89, v37, v4
  v_exp_f32 v76, v76
  v_exp_f32 v80, v80
  v_exp_f32 v84, v84
  v_exp_f32 v88, v88
  v_fract_f32 v77, v77
  v_cos_f32 v82, v81
  v_fract_f32 v85, v85
  v_cos_f32 v90, v89
  v_cos_f32 v78, v77
  v_sin_f32 v83, v81
  v_cos_f32 v86, v85
  v_sin_f32 v91, v89
  v_sin_f32 v79, v77
  v_mul_f32 v82, v82, v80
  v_sin_f32 v87, v85
  v_mul_f32 v90, v90, v88
  v_mul_f32 v78, v78, v76
  v_mul_f32 v83, v83, v80
  v_mul_f32 v86, v86, v84
  v_mul_f32 v91, v91, v88
  v_mul_f32 v79, v79, v76
  v_mul_f32 v80, v82, v30
  v_mul_f32 v87, v87, v84
  v_mul_f32 v88, v90, v38
  v_cvt_pk_bf16_f32 v60, v78, v79
  v_mul_f32 v81, v82, v31
  v_cvt_pk_bf16_f32 v61, v86, v87
  v_mul_f32 v89, v90, v39
  v_mul_f32 v76, v78, v34
  v_fma_f32 v80, -v83, v31, v80
  v_mul_f32 v84, v86, v42
  v_fma_f32 v88, -v91, v39, v88
  v_mul_f32 v77, v78, v35
  v_fma_f32 v81, -v83, v30, -v81
  v_mul_f32 v85, v86, v43
  v_fma_f32 v89, -v91, v38, -v89
  v_fma_f32 v76, -v79, v35, v76
  v_cvt_pk_bf16_f32 v68, v80, v81
  v_fma_f32 v84, -v87, v43, v84
  v_cvt_pk_bf16_f32 v69, v88, v89
  v_fmac_f32 v77, v79, v34
  v_mul_f32 v82, v80, v32
  v_fmac_f32 v85, v87, v42
  v_mul_f32 v90, v88, v40
  v_cvt_pk_bf16_f32 v64, v76, v77
  v_mul_f32 v83, v81, v32
  v_cvt_pk_bf16_f32 v65, v84, v85
  v_mul_f32 v91, v89, v40
  v_cndmask_b32 v64, v64, v5, s[72:73]
  v_fmac_f32 v82, v81, v33
  v_cndmask_b32 v65, v65, v5, s[72:73]
  v_fmac_f32 v90, v89, v41
  v_fma_f32 v83, -v80, v33, v83
  v_fma_f32 v91, -v88, v41, v91
  v_cvt_pk_bf16_f32 v72, v82, v83
  v_cvt_pk_bf16_f32 v73, v90, v91
  ds_read_b128 v[28:31], v6 offset:512
  ds_read_b128 v[32:35], v6 offset:528
  ds_read_b128 v[36:39], v6 offset:544
  ds_read_b128 v[40:43], v6 offset:560
  v_readlane_b32 s66, v94, s64
  s_add_u32 s64, s64, 1
  s_waitcnt lgkmcnt(6)
  v_add_f32 v10, v10, v14
  v_add_f32 v11, v11, v15
  v_add_f32 v12, v12, v16
  v_add_f32 v13, v13, v17
  s_waitcnt lgkmcnt(4)
  v_add_f32 v18, v18, v22
  v_add_f32 v19, v19, v23
  v_add_f32 v20, v20, v24
  v_add_f32 v21, v21, v25
  v_add_f32 v10, v10, v18
  v_add_f32 v11, v11, v19
  v_add_f32 v12, v12, v20
  v_add_f32 v13, v13, v21
  v_fmac_f32 v10, s66, v95
  s_mov_b64 exec, s[78:79]
  ds_write_b32 v9, v10 offset:0
  ds_write_b32 v9, v11 offset:64
  ds_write_b32 v9, v12 offset:128
  ds_write_b32 v9, v13 offset:192
  s_mov_b64 exec, -1
  v_mul_f32 v76, v44, v2
  v_mul_f32 v80, v44, v4
  v_mul_f32 v84, v52, v2
  v_mul_f32 v88, v52, v4
  v_mul_f32 v77, v45, v2
  v_mul_f32 v81, v45, v4
  v_mul_f32 v85, v53, v2
  v_mul_f32 v89, v53, v4
  v_exp_f32 v76, v76
  v_exp_f32 v80, v80
  v_exp_f32 v84, v84
  v_exp_f32 v88, v88
  v_fract_f32 v77, v77
  v_cos_f32 v82, v81
  v_fract_f32 v85, v85
  v_cos_f32 v90, v89
  v_cos_f32 v78, v77
  v_sin_f32 v83, v81
  v_cos_f32 v86, v85
  v_sin_f32 v91, v89
  v_sin_f32 v79, v77
  v_mul_f32 v82, v82, v80
  v_sin_f32 v87, v85
  v_mul_f32 v90, v90, v88
  v_mul_f32 v78, v78, v76
  v_mul_f32 v83, v83, v80
  v_mul_f32 v86, v86, v84
  v_mul_f32 v91, v91, v88
  v_mul_f32 v79, v79, v76
  v_mul_f32 v80, v82, v46
  v_mul_f32 v87, v87, v84
  v_mul_f32 v88, v90, v54
  v_cvt_pk_bf16_f32 v62, v78, v79
  v_mul_f32 v81, v82, v47
  v_cvt_pk_bf16_f32 v63, v86, v87
  v_mul_f32 v89, v90, v55
  v_mul_f32 v76, v78, v50
  v_fma_f32 v80, -v83, v47, v80
  v_mul_f32 v84, v86, v58
  v_fma_f32 v88, -v91, v55, v88
  v_mul_f32 v77, v78, v51
  v_fma_f32 v81, -v83, v46, -v81
  v_mul_f32 v85, v86, v59
  v_fma_f32 v89, -v91, v54, -v89
  v_fma_f32 v76, -v79, v51, v76
  v_cvt_pk_bf16_f32 v70, v80, v81
  v_fma_f32 v84, -v87, v59, v84
  v_cvt_pk_bf16_f32 v71, v88, v89
  v_fmac_f32 v77, v79, v50
  v_mul_f32 v82, v80, v48
  v_fmac_f32 v85, v87, v58
  v_mul_f32 v90, v88, v56
  v_cvt_pk_bf16_f32 v66, v76, v77
  v_mul_f32 v83, v81, v48
  v_cvt_pk_bf16_f32 v67, v84, v85
  v_mul_f32 v91, v89, v56
  v_cndmask_b32 v66, v66, v5, s[72:73]
  v_fmac_f32 v82, v81, v49
  v_cndmask_b32 v67, v67, v5, s[72:73]
  v_fmac_f32 v90, v89, v57
  v_fma_f32 v83, -v80, v49, v83
  v_fma_f32 v91, -v88, v57, v91
  v_cvt_pk_bf16_f32 v74, v82, v83
  v_cvt_pk_bf16_f32 v75, v90, v91
  ds_read_b128 v[44:47], v6 offset:576
  ds_read_b128 v[48:51], v6 offset:592
  ds_read_b128 v[52:55], v6 offset:608
  ds_read_b128 v[56:59], v6 offset:624
  s_cmp_eq_u32 s38, 4
  s_cbranch_scc1 L_nt1
  buffer_load_dword v27, v26, s[16:19], s59 offen
  s_add_u32 s59, s59, 262144
  buffer_load_dword v27, v26, s[16:19], s59 offen
  s_add_u32 s59, s59, 262144
L_nt1:
  v_mfma_f32_16x16x32_bf16 a[0:3], v[60:63], v[68:71], 0
  v_mfma_f32_16x16x32_bf16 a[4:7], v[60:63], v[72:75], 0
  v_mfma_f32_16x16x32_bf16 a[8:11], v[64:67], v[68:71], 0
  v_mfma_f32_16x16x32_bf16 a[12:15], v[64:67], v[72:75], 0
  s_waitcnt lgkmcnt(11)
  v_mul_f32 v76, v28, v2
  v_mul_f32 v80, v28, v4
  s_waitcnt lgkmcnt(9)
  v_mul_f32 v84, v36, v2
  v_mul_f32 v88, v36, v4
  v_mul_f32 v77, v29, v2
  v_mul_f32 v81, v29, v4
  v_mul_f32 v85, v37, v2
  v_mul_f32 v89, v37, v4
  v_exp_f32 v76, v76
  v_exp_f32 v80, v80
  v_exp_f32 v84, v84
  v_exp_f32 v88, v88
  v_fract_f32 v77, v77
  v_cos_f32 v82, v81
  v_fract_f32 v85, v85
  v_cos_f32 v90, v89
  v_cos_f32 v78, v77
  v_sin_f32 v83, v81
  v_cos_f32 v86, v85
  v_sin_f32 v91, v89
  v_sin_f32 v79, v77
  v_mul_f32 v82, v82, v80
  v_sin_f32 v87, v85
  v_mul_f32 v90, v90, v88
  v_mul_f32 v78, v78, v76
  v_mul_f32 v83, v83, v80
  v_mul_f32 v86, v86, v84
  v_mul_f32 v91, v91, v88
  v_mul_f32 v79, v79, v76
  v_mul_f32 v80, v82, v30
  v_mul_f32 v87, v87, v84
  v_mul_f32 v88, v90, v38
  v_cvt_pk_bf16_f32 v60, v78, v79
  v_mul_f32 v81, v82, v31
  v_cvt_pk_bf16_f32 v61, v86, v87
  v_mul_f32 v89, v90, v39
  v_mul_f32 v76, v78, v34
  v_fma_f32 v80, -v83, v31, v80
  s_waitcnt lgkmcnt(8)
  v_mul_f32 v84, v86, v42
  v_fma_f32 v88, -v91, v39, v88
  v_mul_f32 v77, v78, v35
  v_fma_f32 v81, -v83, v30, -v81
  v_mul_f32 v85, v86, v43
  v_fma_f32 v89, -v91, v38, -v89
  v_fma_f32 v76, -v79, v35, v76
  v_cvt_pk_bf16_f32 v68, v80, v81
  v_fma_f32 v84, -v87, v43, v84
  v_cvt_pk_bf16_f32 v69, v88, v89
  v_fmac_f32 v77, v79, v34
  v_mul_f32 v82, v80, v32
  v_fmac_f32 v85, v87, v42
  v_mul_f32 v90, v88, v40
  v_cvt_pk_bf16_f32 v64, v76, v77
  v_mul_f32 v83, v81, v32
  v_cvt_pk_bf16_f32 v65, v84, v85
  v_mul_f32 v91, v89, v40
  v_cndmask_b32 v64, v64, v5, s[72:73]
  v_fmac_f32 v82, v81, v33
  v_cndmask_b32 v65, v65, v5, s[72:73]
  v_fmac_f32 v90, v89, v41
  v_fma_f32 v83, -v80, v33, v83
  v_fma_f32 v91, -v88, v41, v91
  v_cvt_pk_bf16_f32 v72, v82, v83
  v_cvt_pk_bf16_f32 v73, v90, v91
  s_waitcnt lgkmcnt(3)
  v_mul_f32 v76, v44, v2
  v_mul_f32 v80, v44, v4
  s_waitcnt lgkmcnt(1)
  v_mul_f32 v84, v52, v2
  v_mul_f32 v88, v52, v4
  v_mul_f32 v77, v45, v2
  v_mul_f32 v81, v45, v4
  v_mul_f32 v85, v53, v2
  v_mul_f32 v89, v53, v4
  v_exp_f32 v76, v76
  v_exp_f32 v80, v80
  v_exp_f32 v84, v84
  v_exp_f32 v88, v88
  v_fract_f32 v77, v77
  v_cos_f32 v82, v81
  v_fract_f32 v85, v85
  v_cos_f32 v90, v89
  v_cos_f32 v78, v77
  v_sin_f32 v83, v81
  v_cos_f32 v86, v85
  v_sin_f32 v91, v89
  v_sin_f32 v79, v77
  v_mul_f32 v82, v82, v80
  v_sin_f32 v87, v85
  v_mul_f32 v90, v90, v88
  v_mul_f32 v78, v78, v76
  v_mul_f32 v83, v83, v80
  v_mul_f32 v86, v86, v84
  v_mul_f32 v91, v91, v88
  v_mul_f32 v79, v79, v76
  v_mul_f32 v80, v82, v46
  v_mul_f32 v87, v87, v84
  v_mul_f32 v88, v90, v54
  v_cvt_pk_bf16_f32 v62, v78, v79
  v_mul_f32 v81, v82, v47
  v_cvt_pk_bf16_f32 v63, v86, v87
  v_mul_f32 v89, v90, v55
  v_mul_f32 v76, v78, v50
  v_fma_f32 v80, -v83, v47, v80
  s_waitcnt lgkmcnt(0)
  v_mul_f32 v84, v86, v58
  v_fma_f32 v88, -v91, v55, v88
  v_mul_f32 v77, v78, v51
  v_fma_f32 v81, -v83, v46, -v81
  v_mul_f32 v85, v86, v59
  v_fma_f32 v89, -v91, v54, -v89
  v_fma_f32 v76, -v79, v51, v76
  v_cvt_pk_bf16_f32 v70, v80, v81
  v_fma_f32 v84, -v87, v59, v84
  v_cvt_pk_bf16_f32 v71, v88, v89
  v_fmac_f32 v77, v79, v50
  v_mul_f32 v82, v80, v48
  v_fmac_f32 v85, v87, v58
  v_mul_f32 v90, v88, v56
  v_cvt_pk_bf16_f32 v66, v76, v77
  v_mul_f32 v83, v81, v48
  v_cvt_pk_bf16_f32 v67, v84, v85
  v_mul_f32 v91, v89, v56
  v_cndmask_b32 v66, v66, v5, s[72:73]
  v_fmac_f32 v82, v81, v49
  v_cndmask_b32 v67, v67, v5, s[72:73]
  v_fmac_f32 v90, v89, v57
  v_fma_f32 v83, -v80, v49, v83
  v_fma_f32 v91, -v88, v57, v91
  v_cvt_pk_bf16_f32 v74, v82, v83
  v_cvt_pk_bf16_f32 v75, v90, v91
  v_mfma_f32_16x16x32_bf16 a[0:3], v[60:63], v[68:71], a[0:3]
  s_nop 0
  v_mfma_f32_16x16x32_bf16 a[4:7], v[60:63], v[72:75], a[4:7]
  v_mfma_f32_16x16x32_bf16 a[8:11], v[64:67], v[68:71], a[8:11]
  v_mfma_f32_16x16x32_bf16 a[12:15], v[64:67], v[72:75], a[12:15]
  v_add_u32 v6, 4096, v6
  ds_read_b128 v[28:31], v6 offset:0
  ds_read_b128 v[32:35], v6 offset:16
  ds_read_b128 v[36:39], v6 offset:32
  ds_read_b128 v[40:43], v6 offset:48
  ds_read_b128 v[44:47], v6 offset:64
  ds_read_b128 v[48:51], v6 offset:80
  ds_read_b128 v[52:55], v6 offset:96
  ds_read_b128 v[56:59], v6 offset:112
  ds_write_b128 v7, a[0:3] offset:12288
  ds_write_b128 v7, a[4:7] offset:13312
  s_mov_b64 exec, s[68:69]
  ds_write_b128 v7, a[8:11] offset:14336
  ds_write_b128 v7, a[12:15] offset:14848
  s_mov_b64 exec, -1
  s_waitcnt lgkmcnt(0)
  s_barrier
  ds_read_b128 v[10:13], v8 offset:12288
  ds_read_b128 v[14:17], v8 offset:15360
  ds_read_b128 v[18:21], v8 offset:18432
  ds_read_b128 v[22:25], v8 offset:21504
  v_mul_f32 v76, v28, v2
  v_mul_f32 v80, v28, v4
  v_mul_f32 v84, v36, v2
  v_mul_f32 v88, v36, v4
  v_mul_f32 v77, v29, v2
  v_mul_f32 v81, v29, v4
  v_mul_f32 v85, v37, v2
  v_mul_f32 v89, v37, v4
  v_exp_f32 v76, v76
  v_exp_f32 v80, v80
  v_exp_f32 v84, v84
  v_exp_f32 v88, v88
  v_fract_f32 v77, v77
  v_cos_f32 v82, v81
  v_fract_f32 v85, v85
  v_cos_f32 v90, v89
  v_cos_f32 v78, v77
  v_sin_f32 v83, v81
  v_cos_f32 v86, v85
  v_sin_f32 v91, v89
  v_sin_f32 v79, v77
  v_mul_f32 v82, v82, v80
  v_sin_f32 v87, v85
  v_mul_f32 v90, v90, v88
  v_mul_f32 v78, v78, v76
  v_mul_f32 v83, v83, v80
  v_mul_f32 v86, v86, v84
  v_mul_f32 v91, v91, v88
  v_mul_f32 v79, v79, v76
  v_mul_f32 v80, v82, v30
  v_mul_f32 v87, v87, v84
  v_mul_f32 v88, v90, v38
  v_cvt_pk_bf16_f32 v60, v78, v79
  v_mul_f32 v81, v82, v31
  v_cvt_pk_bf16_f32 v61, v86, v87
  v_mul_f32 v89, v90, v39
  v_mul_f32 v76, v78, v34
  v_fma_f32 v80, -v83, v31, v80
  v_mul_f32 v84, v86, v42
  v_fma_f32 v88, -v91, v39, v88
  v_mul_f32 v77, v78, v35
  v_fma_f32 v81, -v83, v30, -v81
  v_mul_f32 v85, v86, v43
  v_fma_f32 v89, -v91, v38, -v89
  v_fma_f32 v76, -v79, v35, v76
  v_cvt_pk_bf16_f32 v68, v80, v81
  v_fma_f32 v84, -v87, v43, v84
  v_cvt_pk_bf16_f32 v69, v88, v89
  v_fmac_f32 v77, v79, v34
  v_mul_f32 v82, v80, v32
  v_fmac_f32 v85, v87, v42
  v_mul_f32 v90, v88, v40
  v_cvt_pk_bf16_f32 v64, v76, v77
  v_mul_f32 v83, v81, v32
  v_cvt_pk_bf16_f32 v65, v84, v85
  v_mul_f32 v91, v89, v40
  v_cndmask_b32 v64, v64, v5, s[72:73]
  v_fmac_f32 v82, v81, v33
  v_cndmask_b32 v65, v65, v5, s[72:73]
  v_fmac_f32 v90, v89, v41
  v_fma_f32 v83, -v80, v33, v83
  v_fma_f32 v91, -v88, v41, v91
  v_cvt_pk_bf16_f32 v72, v82, v83
  v_cvt_pk_bf16_f32 v73, v90, v91
  ds_read_b128 v[28:31], v6 offset:512
  ds_read_b128 v[32:35], v6 offset:528
  ds_read_b128 v[36:39], v6 offset:544
  ds_read_b128 v[40:43], v6 offset:560
  v_readlane_b32 s66, v94, s64
  s_add_u32 s64, s64, 1
  s_waitcnt lgkmcnt(6)
  v_add_f32 v10, v10, v14
  v_add_f32 v11, v11, v15
  v_add_f32 v12, v12, v16
  v_add_f32 v13, v13, v17
  s_waitcnt lgkmcnt(4)
  v_add_f32 v18, v18, v22
  v_add_f32 v19, v19, v23
  v_add_f32 v20, v20, v24
  v_add_f32 v21, v21, v25
  v_add_f32 v10, v10, v18
  v_add_f32 v11, v11, v19
  v_add_f32 v12, v12, v20
  v_add_f32 v13, v13, v21
  v_fmac_f32 v10, s66, v95
  s_mov_b64 exec, s[78:79]
  ds_write_b32 v9, v10 offset:3200
  ds_write_b32 v9, v11 offset:3264
  ds_write_b32 v9, v12 offset:3328
  ds_write_b32 v9, v13 offset:3392
  s_mov_b64 exec, -1
  v_mul_f32 v76, v44, v2
  v_mul_f32 v80, v44, v4
  v_mul_f32 v84, v52, v2
  v_mul_f32 v88, v52, v4
  v_mul_f32 v77, v45, v2
  v_mul_f32 v81, v45, v4
  v_mul_f32 v85, v53, v2
  v_mul_f32 v89, v53, v4
  v_exp_f32 v76, v76
  v_exp_f32 v80, v80
  v_exp_f32 v84, v84
  v_exp_f32 v88, v88
  v_fract_f32 v77, v77
  v_cos_f32 v82, v81
  v_fract_f32 v85, v85
  v_cos_f32 v90, v89
  v_cos_f32 v78, v77
  v_sin_f32 v83, v81
  v_cos_f32 v86, v85
  v_sin_f32 v91, v89
  v_sin_f32 v79, v77
  v_mul_f32 v82, v82, v80
  v_sin_f32 v87, v85
  v_mul_f32 v90, v90, v88
  v_mul_f32 v78, v78, v76
  v_mul_f32 v83, v83, v80
  v_mul_f32 v86, v86, v84
  v_mul_f32 v91, v91, v88
  v_mul_f32 v79, v79, v76
  v_mul_f32 v80, v82, v46
  v_mul_f32 v87, v87, v84
  v_mul_f32 v88, v90, v54
  v_cvt_pk_bf16_f32 v62, v78, v79
  v_mul_f32 v81, v82, v47
  v_cvt_pk_bf16_f32 v63, v86, v87
  v_mul_f32 v89, v90, v55
  v_mul_f32 v76, v78, v50
  v_fma_f32 v80, -v83, v47, v80
  v_mul_f32 v84, v86, v58
  v_fma_f32 v88, -v91, v55, v88
  v_mul_f32 v77, v78, v51
  v_fma_f32 v81, -v83, v46, -v81
  v_mul_f32 v85, v86, v59
  v_fma_f32 v89, -v91, v54, -v89
  v_fma_f32 v76, -v79, v51, v76
  v_cvt_pk_bf16_f32 v70, v80, v81
  v_fma_f32 v84, -v87, v59, v84
  v_cvt_pk_bf16_f32 v71, v88, v89
  v_fmac_f32 v77, v79, v50
  v_mul_f32 v82, v80, v48
  v_fmac_f32 v85, v87, v58
  v_mul_f32 v90, v88, v56
  v_cvt_pk_bf16_f32 v66, v76, v77
  v_mul_f32 v83, v81, v48
  v_cvt_pk_bf16_f32 v67, v84, v85
  v_mul_f32 v91, v89, v56
  v_cndmask_b32 v66, v66, v5, s[72:73]
  v_fmac_f32 v82, v81, v49
  v_cndmask_b32 v67, v67, v5, s[72:73]
  v_fmac_f32 v90, v89, v57
  v_fma_f32 v83, -v80, v49, v83
  v_fma_f32 v91, -v88, v57, v91
  v_cvt_pk_bf16_f32 v74, v82, v83
  v_cvt_pk_bf16_f32 v75, v90, v91
  ds_read_b128 v[44:47], v6 offset:576
  ds_read_b128 v[48:51], v6 offset:592
  ds_read_b128 v[52:55], v6 offset:608
  ds_read_b128 v[56:59], v6 offset:624
  s_cmp_lg_u32 s38, 4
  s_cbranch_scc1 L_nw0
  buffer_load_dword v27, v3, s[12:15], s58 offen offset:0
  buffer_load_dword v27, v3, s[12:15], s58 offen offset:128
  buffer_load_dword v27, v3, s[12:15], s58 offen offset:256
  buffer_load_dword v27, v3, s[12:15], s58 offen offset:384
  s_branch L_nt0
L_nw0:
  buffer_load_dword v27, v26, s[16:19], s59 offen
  s_add_u32 s59, s59, 262144
  buffer_load_dword v27, v26, s[16:19], s59 offen
  s_add_u32 s59, s59, 262144
L_nt0:
  v_mfma_f32_16x16x32_bf16 a[0:3], v[60:63], v[68:71], 0
  v_mfma_f32_16x16x32_bf16 a[4:7], v[60:63], v[72:75], 0
  v_mfma_f32_16x16x32_bf16 a[8:11], v[64:67], v[68:71], 0
  v_mfma_f32_16x16x32_bf16 a[12:15], v[64:67], v[72:75], 0
  s_waitcnt lgkmcnt(11)
  v_mul_f32 v76, v28, v2
  v_mul_f32 v80, v28, v4
  s_waitcnt lgkmcnt(9)
  v_mul_f32 v84, v36, v2
  v_mul_f32 v88, v36, v4
  v_mul_f32 v77, v29, v2
  v_mul_f32 v81, v29, v4
  v_mul_f32 v85, v37, v2
  v_mul_f32 v89, v37, v4
  v_exp_f32 v76, v76
  v_exp_f32 v80, v80
  v_exp_f32 v84, v84
  v_exp_f32 v88, v88
  v_fract_f32 v77, v77
  v_cos_f32 v82, v81
  v_fract_f32 v85, v85
  v_cos_f32 v90, v89
  v_cos_f32 v78, v77
  v_sin_f32 v83, v81
  v_cos_f32 v86, v85
  v_sin_f32 v91, v89
  v_sin_f32 v79, v77
  v_mul_f32 v82, v82, v80
  v_sin_f32 v87, v85
  v_mul_f32 v90, v90, v88
  v_mul_f32 v78, v78, v76
  v_mul_f32 v83, v83, v80
  v_mul_f32 v86, v86, v84
  v_mul_f32 v91, v91, v88
  v_mul_f32 v79, v79, v76
  v_mul_f32 v80, v82, v30
  v_mul_f32 v87, v87, v84
  v_mul_f32 v88, v90, v38
  v_cvt_pk_bf16_f32 v60, v78, v79
  v_mul_f32 v81, v82, v31
  v_cvt_pk_bf16_f32 v61, v86, v87
  v_mul_f32 v89, v90, v39
  v_mul_f32 v76, v78, v34
  v_fma_f32 v80, -v83, v31, v80
  s_waitcnt lgkmcnt(8)
  v_mul_f32 v84, v86, v42
  v_fma_f32 v88, -v91, v39, v88
  v_mul_f32 v77, v78, v35
  v_fma_f32 v81, -v83, v30, -v81
  v_mul_f32 v85, v86, v43
  v_fma_f32 v89, -v91, v38, -v89
  v_fma_f32 v76, -v79, v35, v76
  v_cvt_pk_bf16_f32 v68, v80, v81
  v_fma_f32 v84, -v87, v43, v84
  v_cvt_pk_bf16_f32 v69, v88, v89
  v_fmac_f32 v77, v79, v34
  v_mul_f32 v82, v80, v32
  v_fmac_f32 v85, v87, v42
  v_mul_f32 v90, v88, v40
  v_cvt_pk_bf16_f32 v64, v76, v77
  v_mul_f32 v83, v81, v32
  v_cvt_pk_bf16_f32 v65, v84, v85
  v_mul_f32 v91, v89, v40
  v_cndmask_b32 v64, v64, v5, s[72:73]
  v_fmac_f32 v82, v81, v33
  v_cndmask_b32 v65, v65, v5, s[72:73]
  v_fmac_f32 v90, v89, v41
  v_fma_f32 v83, -v80, v33, v83
  v_fma_f32 v91, -v88, v41, v91
  v_cvt_pk_bf16_f32 v72, v82, v83
  v_cvt_pk_bf16_f32 v73, v90, v91
  s_waitcnt lgkmcnt(3)
  v_mul_f32 v76, v44, v2
  v_mul_f32 v80, v44, v4
  s_waitcnt lgkmcnt(1)
  v_mul_f32 v84, v52, v2
  v_mul_f32 v88, v52, v4
  v_mul_f32 v77, v45, v2
  v_mul_f32 v81, v45, v4
  v_mul_f32 v85, v53, v2
  v_mul_f32 v89, v53, v4
  v_exp_f32 v76, v76
  v_exp_f32 v80, v80
  v_exp_f32 v84, v84
  v_exp_f32 v88, v88
  v_fract_f32 v77, v77
  v_cos_f32 v82, v81
  v_fract_f32 v85, v85
  v_cos_f32 v90, v89
  v_cos_f32 v78, v77
  v_sin_f32 v83, v81
  v_cos_f32 v86, v85
  v_sin_f32 v91, v89
  v_sin_f32 v79, v77
  v_mul_f32 v82, v82, v80
  v_sin_f32 v87, v85
  v_mul_f32 v90, v90, v88
  v_mul_f32 v78, v78, v76
  v_mul_f32 v83, v83, v80
  v_mul_f32 v86, v86, v84
  v_mul_f32 v91, v91, v88
  v_mul_f32 v79, v79, v76
  v_mul_f32 v80, v82, v46
  v_mul_f32 v87, v87, v84
  v_mul_f32 v88, v90, v54
  v_cvt_pk_bf16_f32 v62, v78, v79
  v_mul_f32 v81, v82, v47
  v_cvt_pk_bf16_f32 v63, v86, v87
  v_mul_f32 v89, v90, v55
  v_mul_f32 v76, v78, v50
  v_fma_f32 v80, -v83, v47, v80
  s_waitcnt lgkmcnt(0)
  v_mul_f32 v84, v86, v58
  v_fma_f32 v88, -v91, v55, v88
  v_mul_f32 v77, v78, v51
  v_fma_f32 v81, -v83, v46, -v81
  v_mul_f32 v85, v86, v59
  v_fma_f32 v89, -v91, v54, -v89
  v_fma_f32 v76, -v79, v51, v76
  v_cvt_pk_bf16_f32 v70, v80, v81
  v_fma_f32 v84, -v87, v59, v84
  v_cvt_pk_bf16_f32 v71, v88, v89
  v_fmac_f32 v77, v79, v50
  v_mul_f32 v82, v80, v48
  v_fmac_f32 v85, v87, v58
  v_mul_f32 v90, v88, v56
  v_cvt_pk_bf16_f32 v66, v76, v77
  v_mul_f32 v83, v81, v48
  v_cvt_pk_bf16_f32 v67, v84, v85
  v_mul_f32 v91, v89, v56
  v_cndmask_b32 v66, v66, v5, s[72:73]
  v_fmac_f32 v82, v81, v49
  v_cndmask_b32 v67, v67, v5, s[72:73]
  v_fmac_f32 v90, v89, v57
  v_fma_f32 v83, -v80, v49, v83
  v_fma_f32 v91, -v88, v57, v91
  v_cvt_pk_bf16_f32 v74, v82, v83
  v_cvt_pk_bf16_f32 v75, v90, v91
  v_mfma_f32_16x16x32_bf16 a[0:3], v[60:63], v[68:71], a[0:3]
  s_nop 0
  v_mfma_f32_16x16x32_bf16 a[4:7], v[60:63], v[72:75], a[4:7]
  v_mfma_f32_16x16x32_bf16 a[8:11], v[64:67], v[68:71], a[8:11]
  v_mfma_f32_16x16x32_bf16 a[12:15], v[64:67], v[72:75], a[12:15]
  v_add_u32 v6, 4096, v6
  ds_read_b128 v[28:31], v6 offset:0
  ds_read_b128 v[32:35], v6 offset:16
  ds_read_b128 v[36:39], v6 offset:32
  ds_read_b128 v[40:43], v6 offset:48
  ds_read_b128 v[44:47], v6 offset:64
  ds_read_b128 v[48:51], v6 offset:80
  ds_read_b128 v[52:55], v6 offset:96
  ds_read_b128 v[56:59], v6 offset:112
  ds_write_b128 v7, a[0:3] offset:0
  ds_write_b128 v7, a[4:7] offset:1024
  s_mov_b64 exec, s[68:69]
  ds_write_b128 v7, a[8:11] offset:2048
  ds_write_b128 v7, a[12:15] offset:2560
  s_mov_b64 exec, -1
  s_waitcnt lgkmcnt(0)
  s_barrier
  s_sub_u32 s38, s38, 1
  s_cmp_lg_u32 s38, 0
  s_cbranch_scc1 L_kloop
  ds_read_b128 v[10:13], v8 offset:0
  ds_read_b128 v[14:17], v8 offset:3072
  ds_read_b128 v[18:21], v8 offset:6144
  ds_read_b128 v[22:25], v8 offset:9216
  v_readlane_b32 s66, v94, s64
  s_add_u32 s64, s64, 1
  s_waitcnt lgkmcnt(2)
  v_add_f32 v10, v10, v14
  v_add_f32 v11, v11, v15
  v_add_f32 v12, v12, v16
  v_add_f32 v13, v13, v17
  s_waitcnt lgkmcnt(0)
  v_add_f32 v18, v18, v22
  v_add_f32 v19, v19, v23
  v_add_f32 v20, v20, v24
  v_add_f32 v21, v21, v25
  v_add_f32 v10, v10, v18
  v_add_f32 v11, v11, v19
  v_add_f32 v12, v12, v20
  v_add_f32 v13, v13, v21
  v_fmac_f32 v10, s66, v95
  s_mov_b64 exec, s[78:79]
  ds_write_b32 v9, v10 offset:0
  ds_write_b32 v9, v11 offset:64
  ds_write_b32 v9, v12 offset:128
  ds_write_b32 v9, v13 offset:192
  s_mov_b64 exec, -1
  v_and_b32 v8, 15, v1
  v_lshlrev_b32 v5, 3, v8
  v_lshrrev_b32 v6, 4, v0
  v_lshlrev_b32 v6, 1, v6
  s_lshl_b32 s59, s36, 5
  v_add_u32 v6, s59, v6
  v_mul_u32_u24 v7, 1152, v6
  v_add_u32 v7, v7, v5
  s_waitcnt lgkmcnt(0)
  s_barrier
  s_barrier
  buffer_load_dwordx2 v[28:29], v5, s[84:87], 0 offen offset:0
  buffer_load_dwordx2 v[30:31], v5, s[84:87], 0 offen offset:128
  buffer_load_dwordx2 v[32:33], v5, s[84:87], 0 offen offset:256
  buffer_load_dwordx2 v[34:35], v5, s[84:87], 0 offen offset:384
  buffer_load_dwordx2 v[36:37], v5, s[84:87], 0 offen offset:512
  buffer_load_dwordx2 v[38:39], v5, s[84:87], 0 offen offset:640
  buffer_load_dwordx2 v[40:41], v5, s[84:87], 0 offen offset:768
  buffer_load_dwordx2 v[42:43], v5, s[84:87], 0 offen offset:896
  buffer_load_dwordx2 v[44:45], v5, s[84:87], 0 offen offset:1024
  buffer_load_dwordx2 v[46:47], v7, s[8:11], 0 offen offset:0
  buffer_load_dwordx2 v[48:49], v7, s[8:11], 0 offen offset:128
  buffer_load_dwordx2 v[50:51], v7, s[8:11], 0 offen offset:256
  buffer_load_dwordx2 v[52:53], v7, s[8:11], 0 offen offset:384
  buffer_load_dwordx2 v[54:55], v7, s[8:11], 0 offen offset:512
  buffer_load_dwordx2 v[56:57], v7, s[8:11], 0 offen offset:640
  buffer_load_dwordx2 v[58:59], v7, s[8:11], 0 offen offset:768
  buffer_load_dwordx2 v[60:61], v7, s[8:11], 0 offen offset:896
  buffer_load_dwordx2 v[62:63], v7, s[8:11], 0 offen offset:1024
  buffer_load_dwordx2 v[64:65], v7, s[8:11], 0 offen offset:1152
  buffer_load_dwordx2 v[66:67], v7, s[8:11], 0 offen offset:1280
  buffer_load_dwordx2 v[68:69], v7, s[8:11], 0 offen offset:1408
  buffer_load_dwordx2 v[70:71], v7, s[8:11], 0 offen offset:1536
  buffer_load_dwordx2 v[72:73], v7, s[8:11], 0 offen offset:1664
  buffer_load_dwordx2 v[74:75], v7, s[8:11], 0 offen offset:1792
  buffer_load_dwordx2 v[76:77], v7, s[8:11], 0 offen offset:1920
  buffer_load_dwordx2 v[78:79], v7, s[8:11], 0 offen offset:2048
  buffer_load_dwordx2 v[80:81], v7, s[8:11], 0 offen offset:2176
  s_add_u32 s70, s70, red_kernel-L_ktab
  s_addc_u32 s71, s71, 0
  v_lshlrev_b32 v93, 6, v1
  v_min_u32 v93, L_red_end-red_kernel, v93
  global_load_dword v27, v93, s[70:71]
  s_barrier
  v_mov_b32 v88, 0
  v_mov_b32 v89, 0
  s_waitcnt vmcnt(18)
  v_dot2_f32_bf16 v88, v46, v28, v88
  s_waitcnt vmcnt(9)
  v_dot2_f32_bf16 v89, v64, v28, v89
  v_dot2_f32_bf16 v88, v47, v29, v88
  v_dot2_f32_bf16 v89, v65, v29, v89
  v_dot2_f32_bf16 v88, v48, v30, v88
  s_waitcnt vmcnt(8)
  v_dot2_f32_bf16 v89, v66, v30, v89
  v_dot2_f32_bf16 v88, v49, v31, v88
  v_dot2_f32_bf16 v89, v67, v31, v89
  v_dot2_f32_bf16 v88, v50, v32, v88
  s_waitcnt vmcnt(7)
  v_dot2_f32_bf16 v89, v68, v32, v89
  v_dot2_f32_bf16 v88, v51, v33, v88
  v_dot2_f32_bf16 v89, v69, v33, v89
  v_dot2_f32_bf16 v88, v52, v34, v88
  s_waitcnt vmcnt(6)
  v_dot2_f32_bf16 v89, v70, v34, v89
  v_dot2_f32_bf16 v88, v53, v35, v88
  v_dot2_f32_bf16 v89, v71, v35, v89
  v_dot2_f32_bf16 v88, v54, v36, v88
  s_waitcnt vmcnt(5)
  v_dot2_f32_bf16 v89, v72, v36, v89
  v_dot2_f32_bf16 v88, v55, v37, v88
  v_dot2_f32_bf16 v89, v73, v37, v89
  v_dot2_f32_bf16 v88, v56, v38, v88
  s_waitcnt vmcnt(4)
  v_dot2_f32_bf16 v89, v74, v38, v89
  v_dot2_f32_bf16 v88, v57, v39, v88
  v_dot2_f32_bf16 v89, v75, v39, v89
  v_dot2_f32_bf16 v88, v58, v40, v88
  s_waitcnt vmcnt(3)
  v_dot2_f32_bf16 v89, v76, v40, v89
  v_dot2_f32_bf16 v88, v59, v41, v88
  v_dot2_f32_bf16 v89, v77, v41, v89
  v_dot2_f32_bf16 v88, v60, v42, v88
  s_waitcnt vmcnt(2)
  v_dot2_f32_bf16 v89, v78, v42, v89
  v_dot2_f32_bf16 v88, v61, v43, v88
  v_dot2_f32_bf16 v89, v79, v43, v89
  v_dot2_f32_bf16 v88, v62, v44, v88
  s_waitcnt vmcnt(1)
  v_dot2_f32_bf16 v89, v80, v44, v89
  v_dot2_f32_bf16 v88, v63, v45, v88
  v_dot2_f32_bf16 v89, v81, v45, v89
  s_nop 1
  v_add_f32_dpp v88, v88, v88 row_ror:1 row_mask:0xf bank_mask:0xf
  v_add_f32_dpp v89, v89, v89 row_ror:1 row_mask:0xf bank_mask:0xf
  s_nop 0
  v_add_f32_dpp v88, v88, v88 row_ror:2 row_mask:0xf bank_mask:0xf
  v_add_f32_dpp v89, v89, v89 row_ror:2 row_mask:0xf bank_mask:0xf
  s_nop 0
  v_add_f32_dpp v88, v88, v88 row_ror:4 row_mask:0xf bank_mask:0xf
  v_add_f32_dpp v89, v89, v89 row_ror:4 row_mask:0xf bank_mask:0xf
  s_nop 0
  v_add_f32_dpp v88, v88, v88 row_ror:8 row_mask:0xf bank_mask:0xf
  v_add_f32_dpp v89, v89, v89 row_ror:8 row_mask:0xf bank_mask:0xf
  v_mul_f32_e64 v88, -v88, s34
  v_mul_f32_e64 v89, -v89, s34
  v_exp_f32 v88, v88
  v_exp_f32 v89, v89
  v_add_f32 v88, 1.0, v88
  v_add_f32 v89, 1.0, v89
  v_rcp_f32 v88, v88
  v_rcp_f32 v89, v89
  v_lshlrev_b32 v6, 2, v6
  v_cmp_eq_u32 vcc, 0, v8
  s_nop 3
  s_and_saveexec_b64 s[60:61], vcc
  s_mov_b32 s56, 37748736
  buffer_store_dwordx2 v[88:89], v6, s[20:23], s56 offen sc1
  s_mov_b64 exec, s[60:61]
  s_barrier
  s_branch L_abr_end
L_cwave:
  v_subrev_u32 v2, 256, v0
  s_lshl_b32 s38, s36, 4
  v_mul_u32_u24 v3, 9216, v2
  s_add_u32 s56, s38, 4608
  s_add_u32 s70, s70, L_ktab-L_abr_pc
  s_addc_u32 s71, s71, 0
  v_mul_u32_u24 v4, 24, v2
  global_load_dwordx4 v[68:71], v4, s[70:71]
  global_load_dwordx2 v[72:73], v4, s[70:71] offset:16
  s_waitcnt lgkmcnt(0)
  s_mov_b32 s8, s40
  s_mov_b32 s9, s41
  s_mov_b32 s10, 2359296
  s_mov_b32 s11, 0x20000
  v_mul_u32_u24 v5, 1152, v2
  s_mul_i32 s39, s67, 294912
  s_add_u32 s39, s39, s38
  buffer_load_dword v15, v5, s[8:11], s39 offen
  buffer_load_dwordx4 v[28:31], v3, s[8:11], s38 offen offset:0
  buffer_load_dwordx4 v[32:35], v3, s[8:11], s38 offen offset:1152
  s_barrier
  buffer_load_dwordx4 v[36:39], v3, s[8:11], s38 offen offset:2304
  buffer_load_dwordx4 v[40:43], v3, s[8:11], s38 offen offset:3456
  buffer_load_dwordx4 v[44:47], v3, s[8:11], s56 offen offset:0
  buffer_load_dwordx4 v[48:51], v3, s[8:11], s56 offen offset:1152
  buffer_load_dwordx4 v[52:55], v3, s[8:11], s56 offen offset:2304
  buffer_load_dwordx4 v[56:59], v3, s[8:11], s56 offen offset:3456
  s_mov_b32 s20, s74
  s_mov_b32 s21, s75
  s_mov_b32 s22, 268435456
  s_mov_b32 s23, 0x20000
  s_mov_b32 s57, 0x05040100
  s_mov_b32 s58, 0x07060302
  v_lshlrev_b32 v4, 4, v2
  v_add_u32 v9, 41472, v4
  s_waitcnt vmcnt(10)
  v_and_b32 v17, 0xffff, v68
  v_add_u32 v17, 136192, v17
  v_lshrrev_b32 v18, 16, v68
  v_add_u32 v18, 136192, v18
  v_and_b32 v19, 0xffff, v69
  v_add_u32 v19, 136192, v19
  v_lshrrev_b32 v20, 16, v69
  v_add_u32 v20, 136192, v20
  v_and_b32 v21, 0xffff, v70
  v_add_u32 v21, 136192, v21
  v_lshrrev_b32 v22, 16, v70
  v_add_u32 v22, 136192, v22
  v_and_b32 v23, 0xffff, v71
  v_add_u32 v23, 136192, v23
  v_lshrrev_b32 v24, 16, v71
  v_add_u32 v24, 136192, v24
  s_waitcnt vmcnt(9)
  v_and_b32 v25, 0xffff, v72
  v_add_u32 v25, 136192, v25
  v_lshrrev_b32 v26, 16, v72
  v_add_u32 v26, 136192, v26
  v_and_b32 v27, 0xffff, v73
  v_add_u32 v27, 136192, v27
  v_mov_b32 v88, 0
  v_mov_b32 v89, 0
  v_mov_b32 v90, 0
  v_mov_b32 v91, 0
  v_cmp_gt_u32 vcc, 30, v2
  s_nop 3
  s_and_saveexec_b64 s[60:61], vcc
  ds_write_b128 v4, v[88:91] offset:0
  ds_write_b128 v4, v[88:91] offset:4608
  ds_write_b128 v4, v[88:91] offset:9216
  ds_write_b128 v4, v[88:91] offset:13824
  ds_write_b128 v4, v[88:91] offset:18432
  ds_write_b128 v4, v[88:91] offset:23040
  ds_write_b128 v4, v[88:91] offset:27648
  ds_write_b128 v4, v[88:91] offset:32256
  ds_write_b128 v4, v[88:91] offset:36864
  v_cmp_gt_u32 vcc, 2, v2
  s_nop 3
  s_and_b64 exec, exec, vcc
  v_mov_b32 v5, 139264
  ds_write_b128 v9, v[88:91] offset:4096
  ds_write_b128 v9, v[88:91] offset:8256
  ds_write_b128 v9, v[88:91] offset:12416
  ds_write_b128 v9, v[88:91] offset:16576
  ds_write_b128 v9, v[88:91] offset:20736
  ds_write_b128 v9, v[88:91] offset:24896
  ds_write_b128 v9, v[88:91] offset:29056
  ds_write_b128 v9, v[88:91] offset:33216
  ds_write_b128 v5, v[88:91]
  ds_write_b128 v5, v[88:91] offset:3200
  s_mov_b64 exec, s[60:61]
  v_and_b32 v8, 15, v1
  v_lshrrev_b32 v84, 4, v1
  s_and_b32 s59, s35, 1
  s_lshl_b32 s56, s59, 8
  v_and_b32 v85, 3, v8
  v_mul_u32_u24 v10, 4160, v85
  v_lshrrev_b32 v85, 2, v8
  v_lshlrev_b32 v85, 3, v85
  v_sub_u32 v10, v10, v85
  v_lshl_add_u32 v10, v84, 4, v10
  v_add_u32 v10, 41496, v10
  v_subrev_u32 v10, s56, v10
  v_lshlrev_b32 v11, 5, v8
  v_lshl_add_u32 v11, v84, 4, v11
  v_lshlrev_b32 v12, 5, v8
  v_lshrrev_b32 v85, 1, v84
  v_lshl_add_u32 v12, v85, 4, v12
  v_and_b32 v85, 1, v84
  s_bitcmp0_b32 s35, 1
  s_cselect_b32 s39, 3, 1
  s_lshl_b32 s39, s39, 9
  v_mul_u32_u24 v85, s39, v85
  v_add_u32 v12, v12, v85
  v_add_u32 v11, 256, v11
  v_subrev_u32 v11, s56, v11
  s_bfe_u32 s62, s35, 0x10001
  s_lshl_b32 s56, s62, 12
  v_lshlrev_b32 v14, 4, v1
  v_add_u32 v14, s56, v14
  v_add_u32 v14, 142592, v14
  s_lshl_b32 s63, s37, 12
  s_add_u32 s63, s63, 33554432
  s_mov_b32 s64, 0
  s_lshl_b32 s56, s62, 6
  v_add_u32 v5, s56, v1
  v_mul_u32_u24 v6, 2304, v5
  v_lshlrev_b32 v5, 2, v5
  v_add_u32 v5, 37344, v5
  s_lshl_b32 s65, s36, 1
  s_add_u32 s65, s65, 1024
  buffer_load_ushort v88, v6, s[8:11], s65 offen
  buffer_load_ushort v89, v6, s[8:11], s65 offen offset:1152
  s_waitcnt lgkmcnt(0)
  s_barrier
  s_barrier
  ds_read_b32 v60, v17 offset:0
  ds_read_b32 v61, v18 offset:0
  ds_read_b32 v62, v19 offset:0
  ds_read_b32 v63, v20 offset:0
  ds_read_b32 v64, v21 offset:0
  ds_read_b32 v65, v22 offset:0
  ds_read_b32 v66, v23 offset:0
  ds_read_b32 v67, v24 offset:0
  ds_read_b32 v68, v25 offset:0
  ds_read_b32 v69, v26 offset:0
  ds_read_b32 v70, v27 offset:0
  s_waitcnt lgkmcnt(9)
  v_cvt_pk_bf16_f32 v72, v60, v61
  s_waitcnt lgkmcnt(8)
  v_cvt_pk_bf16_f32 v76, v61, v62
  s_waitcnt lgkmcnt(7)
  v_cvt_pk_bf16_f32 v80, v62, v63
  s_waitcnt lgkmcnt(6)
  v_cvt_pk_bf16_f32 v84, v63, v64
  v_cvt_pk_bf16_f32 v73, v62, v63
  v_cvt_pk_bf16_f32 v77, v63, v64
  s_waitcnt lgkmcnt(5)
  v_cvt_pk_bf16_f32 v81, v64, v65
  s_waitcnt lgkmcnt(4)
  v_cvt_pk_bf16_f32 v85, v65, v66
  v_cvt_pk_bf16_f32 v74, v64, v65
  v_cvt_pk_bf16_f32 v78, v65, v66
  s_waitcnt lgkmcnt(3)
  v_cvt_pk_bf16_f32 v82, v66, v67
  s_waitcnt lgkmcnt(2)
  v_cvt_pk_bf16_f32 v86, v67, v68
  v_cvt_pk_bf16_f32 v75, v66, v67
  v_cvt_pk_bf16_f32 v79, v67, v68
  s_waitcnt lgkmcnt(1)
  v_cvt_pk_bf16_f32 v83, v68, v69
  s_waitcnt lgkmcnt(0)
  v_cvt_pk_bf16_f32 v87, v69, v70
  ds_write_b128 v9, v[72:75] offset:12480
  ds_write_b128 v9, v[76:79] offset:8320
  ds_write_b128 v9, v[80:83] offset:4160
  ds_write_b128 v9, v[84:87] offset:0
  s_waitcnt vmcnt(8)
  v_perm_b32 v60, v32, v28, s57
  s_waitcnt vmcnt(6)
  v_perm_b32 v61, v40, v36, s57
  s_waitcnt vmcnt(4)
  v_perm_b32 v62, v48, v44, s57
  s_waitcnt vmcnt(2)
  v_perm_b32 v63, v56, v52, s57
  ds_write_b128 v4, v[60:63] offset:480
  v_perm_b32 v64, v32, v28, s58
  v_perm_b32 v65, v40, v36, s58
  v_perm_b32 v66, v48, v44, s58
  v_perm_b32 v67, v56, v52, s58
  ds_write_b128 v4, v[64:67] offset:5088
  v_perm_b32 v60, v33, v29, s57
  v_perm_b32 v61, v41, v37, s57
  v_perm_b32 v62, v49, v45, s57
  v_perm_b32 v63, v57, v53, s57
  ds_write_b128 v4, v[60:63] offset:9696
  v_perm_b32 v64, v33, v29, s58
  v_perm_b32 v65, v41, v37, s58
  v_perm_b32 v66, v49, v45, s58
  v_perm_b32 v67, v57, v53, s58
  ds_write_b128 v4, v[64:67] offset:14304
  v_perm_b32 v60, v34, v30, s57
  v_perm_b32 v61, v42, v38, s57
  v_perm_b32 v62, v50, v46, s57
  v_perm_b32 v63, v58, v54, s57
  ds_write_b128 v4, v[60:63] offset:18912
  v_perm_b32 v64, v34, v30, s58
  v_perm_b32 v65, v42, v38, s58
  v_perm_b32 v66, v50, v46, s58
  v_perm_b32 v67, v58, v54, s58
  ds_write_b128 v4, v[64:67] offset:23520
  v_perm_b32 v60, v35, v31, s57
  v_perm_b32 v61, v43, v39, s57
  v_perm_b32 v62, v51, v47, s57
  v_perm_b32 v63, v59, v55, s57
  ds_write_b128 v4, v[60:63] offset:28128
  v_perm_b32 v64, v35, v31, s58
  v_perm_b32 v65, v43, v39, s58
  v_perm_b32 v66, v51, v47, s58
  v_perm_b32 v67, v59, v55, s58
  ds_write_b128 v4, v[64:67] offset:32736
  s_waitcnt lgkmcnt(0)
  s_barrier
  s_mov_b32 s38, 0
  s_cmp_eq_u32 s62, 1
  s_cbranch_scc1 L_cloop1
  .p2align 3
L_cloop0:
  ds_read_b64 a[0:1], v10 offset:4032
  ds_read_b64 a[2:3], v10 offset:4040
  ds_read_b128 a[32:35], v11 offset:192
  ds_read_b64 a[4:5], v10 offset:3520
  ds_read_b64 a[6:7], v10 offset:3528
  ds_read_b128 a[36:39], v11 offset:704
  ds_read_b64 a[8:9], v10 offset:3008
  ds_read_b64 a[10:11], v10 offset:3016
  ds_read_b128 a[40:43], v11 offset:1216
  ds_read_b64 a[12:13], v10 offset:2496
  ds_read_b64 a[14:15], v10 offset:2504
  ds_read_b128 a[44:47], v11 offset:1728
  ds_read_b64 a[16:17], v10 offset:1984
  ds_read_b64 a[18:19], v10 offset:1992
  ds_read_b128 a[48:51], v11 offset:2240
  ds_read_b64 a[20:21], v10 offset:1472
  ds_read_b64 a[22:23], v10 offset:1480
  ds_read_b128 a[52:55], v11 offset:2752
  ds_read_b64 a[24:25], v10 offset:960
  ds_read_b64 a[26:27], v10 offset:968
  ds_read_b128 a[56:59], v11 offset:3264
  ds_read_b64 a[28:29], v10 offset:448
  ds_read_b64 a[30:31], v10 offset:456
  ds_read_b128 a[60:63], v11 offset:3776
  s_cmp_eq_u32 s59, 0
  s_cbranch_scc1 L_f000
  s_cmp_ge_u32 s38, 8
  s_cbranch_scc1 L_fe00
  s_waitcnt vmcnt(0)
  v_perm_b32 v90, v89, v88, s57
  ds_write_b32 v5, v90
  v_add_u32 v5, 512, v5
  s_add_u32 s65, s65, 294912
  buffer_load_ushort v88, v6, s[8:11], s65 offen
  buffer_load_ushort v89, v6, s[8:11], s65 offen offset:1152
  s_branch L_fe00
L_f000:
  s_cmp_eq_u32 s38, 0
  s_cbranch_scc1 L_fe00
  ds_read_b128 v[48:51], v14 offset:8192
  ds_read_b128 v[52:55], v14 offset:9216
  ds_read_b128 v[56:59], v14 offset:10240
  ds_read_b128 v[60:63], v14 offset:11264
  s_waitcnt lgkmcnt(3)
  v_add_f32 v32, v32, v48
  v_add_f32 v33, v33, v49
  v_add_f32 v34, v34, v50
  v_add_f32 v35, v35, v51
  v_cvt_pk_bf16_f32 v48, v32, v33
  v_cvt_pk_bf16_f32 v49, v34, v35
  s_waitcnt lgkmcnt(2)
  v_add_f32 v36, v36, v52
  v_add_f32 v37, v37, v53
  v_add_f32 v38, v38, v54
  v_add_f32 v39, v39, v55
  v_cvt_pk_bf16_f32 v50, v36, v37
  v_cvt_pk_bf16_f32 v51, v38, v39
  s_waitcnt lgkmcnt(1)
  v_add_f32 v40, v40, v56
  v_add_f32 v41, v41, v57
  v_add_f32 v42, v42, v58
  v_add_f32 v43, v43, v59
  v_cvt_pk_bf16_f32 v52, v40, v41
  v_cvt_pk_bf16_f32 v53, v42, v43
  s_waitcnt lgkmcnt(0)
  v_add_f32 v44, v44, v60
  v_add_f32 v45, v45, v61
  v_add_f32 v46, v46, v62
  v_add_f32 v47, v47, v63
  v_cvt_pk_bf16_f32 v54, v44, v45
  v_cvt_pk_bf16_f32 v55, v46, v47
  v_permlane16_swap_b32 v48, v50
  v_permlane16_swap_b32 v49, v51
  buffer_store_dwordx4 v[48:51], v12, s[20:23], s63 offen offset:0 sc1
  v_permlane16_swap_b32 v52, v54
  v_permlane16_swap_b32 v53, v55
  buffer_store_dwordx4 v[52:55], v12, s[20:23], s63 offen offset:2048 sc1
  s_add_u32 s63, s63, 4096
  s_cmp_lg_u32 s38, 8
  s_cbranch_scc1 L_fe00
  s_lshl_b32 s63, s36, 12
  s_add_u32 s63, s63, 35651584
L_fe00:
  s_cmp_ge_u32 s38, 8
  s_cbranch_scc1 L_ne00
  ds_read_b32 v60, v17 offset:3200
  ds_read_b32 v61, v18 offset:3200
  ds_read_b32 v62, v19 offset:3200
  ds_read_b32 v63, v20 offset:3200
  ds_read_b32 v64, v21 offset:3200
  ds_read_b32 v65, v22 offset:3200
  ds_read_b32 v66, v23 offset:3200
  ds_read_b32 v67, v24 offset:3200
  ds_read_b32 v68, v25 offset:3200
  ds_read_b32 v69, v26 offset:3200
  ds_read_b32 v70, v27 offset:3200
  s_waitcnt lgkmcnt(9)
  v_cvt_pk_bf16_f32 v72, v60, v61
  s_waitcnt lgkmcnt(8)
  v_cvt_pk_bf16_f32 v76, v61, v62
  s_waitcnt lgkmcnt(7)
  v_cvt_pk_bf16_f32 v80, v62, v63
  s_waitcnt lgkmcnt(6)
  v_cvt_pk_bf16_f32 v84, v63, v64
  v_cvt_pk_bf16_f32 v73, v62, v63
  v_cvt_pk_bf16_f32 v77, v63, v64
  s_waitcnt lgkmcnt(5)
  v_cvt_pk_bf16_f32 v81, v64, v65
  s_waitcnt lgkmcnt(4)
  v_cvt_pk_bf16_f32 v85, v65, v66
  v_cvt_pk_bf16_f32 v74, v64, v65
  v_cvt_pk_bf16_f32 v78, v65, v66
  s_waitcnt lgkmcnt(3)
  v_cvt_pk_bf16_f32 v82, v66, v67
  s_waitcnt lgkmcnt(2)
  v_cvt_pk_bf16_f32 v86, v67, v68
  v_cvt_pk_bf16_f32 v75, v66, v67
  v_cvt_pk_bf16_f32 v79, v67, v68
  s_waitcnt lgkmcnt(1)
  v_cvt_pk_bf16_f32 v83, v68, v69
  s_waitcnt lgkmcnt(0)
  v_cvt_pk_bf16_f32 v87, v69, v70
  ds_write_b128 v9, v[72:75] offset:29120
  ds_write_b128 v9, v[76:79] offset:24960
  ds_write_b128 v9, v[80:83] offset:20800
  ds_write_b128 v9, v[84:87] offset:16640
L_ne00:
  s_waitcnt lgkmcnt(15)
  v_mfma_f32_16x16x32_bf16 v[32:35], a[0:3], a[32:35], 0
  ds_read_b64 a[64:65], v10 offset:3968
  ds_read_b64 a[66:67], v10 offset:3976
  v_mfma_f32_16x16x32_bf16 v[36:39], a[4:7], a[40:43], 0
  ds_read_b128 a[96:99], v11 offset:128
  v_mfma_f32_16x16x32_bf16 v[36:39], a[8:11], a[36:39], v[36:39]
  ds_read_b64 a[68:69], v10 offset:3456
  v_mfma_f32_16x16x32_bf16 v[40:43], a[8:11], a[40:43], 0
  ds_read_b64 a[70:71], v10 offset:3464
  ds_read_b128 a[100:103], v11 offset:640
  s_waitcnt lgkmcnt(15)
  v_mfma_f32_16x16x32_bf16 v[36:39], a[0:3], a[44:47], v[36:39]
  ds_read_b64 a[72:73], v10 offset:2944
  v_mfma_f32_16x16x32_bf16 v[36:39], a[12:15], a[32:35], v[36:39]
  ds_read_b64 a[74:75], v10 offset:2952
  v_mfma_f32_16x16x32_bf16 v[40:43], a[4:7], a[44:47], v[40:43]
  ds_read_b128 a[104:107], v11 offset:1152
  ds_read_b64 a[76:77], v10 offset:2432
  v_mfma_f32_16x16x32_bf16 v[40:43], a[12:15], a[36:39], v[40:43]
  ds_read_b64 a[78:79], v10 offset:2440
  v_mfma_f32_16x16x32_bf16 v[40:43], a[0:3], a[48:51], v[40:43]
  ds_read_b128 a[108:111], v11 offset:1664
  v_mfma_f32_16x16x32_bf16 v[40:43], a[16:19], a[32:35], v[40:43]
  ds_read_b64 a[80:81], v10 offset:1920
  ds_read_b64 a[82:83], v10 offset:1928
  v_mfma_f32_16x16x32_bf16 v[44:47], a[12:15], a[48:51], 0
  ds_read_b128 a[112:115], v11 offset:2176
  v_mfma_f32_16x16x32_bf16 v[44:47], a[16:19], a[44:47], v[44:47]
  ds_read_b64 a[84:85], v10 offset:1408
  s_waitcnt lgkmcnt(15)
  v_mfma_f32_16x16x32_bf16 v[44:47], a[8:11], a[52:55], v[44:47]
  ds_read_b64 a[86:87], v10 offset:1416
  ds_read_b128 a[116:119], v11 offset:2688
  v_mfma_f32_16x16x32_bf16 v[44:47], a[20:23], a[40:43], v[44:47]
  ds_read_b64 a[88:89], v10 offset:896
  v_mfma_f32_16x16x32_bf16 v[44:47], a[4:7], a[56:59], v[44:47]
  ds_read_b64 a[90:91], v10 offset:904
  v_mfma_f32_16x16x32_bf16 v[44:47], a[24:27], a[36:39], v[44:47]
  ds_read_b128 a[120:123], v11 offset:3200
  ds_read_b64 a[92:93], v10 offset:384
  v_mfma_f32_16x16x32_bf16 v[44:47], a[0:3], a[60:63], v[44:47]
  ds_read_b64 a[94:95], v10 offset:392
  v_mfma_f32_16x16x32_bf16 v[44:47], a[28:31], a[32:35], v[44:47]
  ds_read_b128 a[124:127], v11 offset:3712
  s_waitcnt lgkmcnt(15)
  v_mfma_f32_16x16x32_bf16 v[32:35], a[64:67], a[96:99], v[32:35]
  ds_read_b64 a[0:1], v10 offset:3904
  ds_read_b64 a[2:3], v10 offset:3912
  v_mfma_f32_16x16x32_bf16 v[36:39], a[68:71], a[104:107], v[36:39]
  ds_read_b128 a[32:35], v11 offset:64
  v_mfma_f32_16x16x32_bf16 v[36:39], a[72:75], a[100:103], v[36:39]
  ds_read_b64 a[4:5], v10 offset:3392
  v_mfma_f32_16x16x32_bf16 v[40:43], a[72:75], a[104:107], v[40:43]
  ds_read_b64 a[6:7], v10 offset:3400
  ds_read_b128 a[36:39], v11 offset:576
  s_waitcnt lgkmcnt(15)
  v_mfma_f32_16x16x32_bf16 v[36:39], a[64:67], a[108:111], v[36:39]
  ds_read_b64 a[8:9], v10 offset:2880
  v_mfma_f32_16x16x32_bf16 v[36:39], a[76:79], a[96:99], v[36:39]
  ds_read_b64 a[10:11], v10 offset:2888
  v_mfma_f32_16x16x32_bf16 v[40:43], a[68:71], a[108:111], v[40:43]
  ds_read_b128 a[40:43], v11 offset:1088
  ds_read_b64 a[12:13], v10 offset:2368
  v_mfma_f32_16x16x32_bf16 v[40:43], a[76:79], a[100:103], v[40:43]
  ds_read_b64 a[14:15], v10 offset:2376
  v_mfma_f32_16x16x32_bf16 v[40:43], a[64:67], a[112:115], v[40:43]
  ds_read_b128 a[44:47], v11 offset:1600
  v_mfma_f32_16x16x32_bf16 v[40:43], a[80:83], a[96:99], v[40:43]
  ds_read_b64 a[16:17], v10 offset:1856
  ds_read_b64 a[18:19], v10 offset:1864
  v_mfma_f32_16x16x32_bf16 v[44:47], a[76:79], a[112:115], v[44:47]
  ds_read_b128 a[48:51], v11 offset:2112
  v_mfma_f32_16x16x32_bf16 v[44:47], a[80:83], a[108:111], v[44:47]
  ds_read_b64 a[20:21], v10 offset:1344
  s_waitcnt lgkmcnt(15)
  v_mfma_f32_16x16x32_bf16 v[44:47], a[72:75], a[116:119], v[44:47]
  ds_read_b64 a[22:23], v10 offset:1352
  ds_read_b128 a[52:55], v11 offset:2624
  v_mfma_f32_16x16x32_bf16 v[44:47], a[84:87], a[104:107], v[44:47]
  ds_read_b64 a[24:25], v10 offset:832
  v_mfma_f32_16x16x32_bf16 v[44:47], a[68:71], a[120:123], v[44:47]
  ds_read_b64 a[26:27], v10 offset:840
  v_mfma_f32_16x16x32_bf16 v[44:47], a[88:91], a[100:103], v[44:47]
  ds_read_b128 a[56:59], v11 offset:3136
  ds_read_b64 a[28:29], v10 offset:320
  v_mfma_f32_16x16x32_bf16 v[44:47], a[64:67], a[124:127], v[44:47]
  ds_read_b64 a[30:31], v10 offset:328
  v_mfma_f32_16x16x32_bf16 v[44:47], a[92:95], a[96:99], v[44:47]
  ds_read_b128 a[60:63], v11 offset:3648
  s_waitcnt lgkmcnt(15)
  v_mfma_f32_16x16x32_bf16 v[32:35], a[0:3], a[32:35], v[32:35]
  ds_read_b64 a[64:65], v10 offset:3840
  ds_read_b64 a[66:67], v10 offset:3848
  v_mfma_f32_16x16x32_bf16 v[36:39], a[4:7], a[40:43], v[36:39]
  ds_read_b128 a[96:99], v11 offset:0
  v_mfma_f32_16x16x32_bf16 v[36:39], a[8:11], a[36:39], v[36:39]
  ds_read_b64 a[68:69], v10 offset:3328
  v_mfma_f32_16x16x32_bf16 v[40:43], a[8:11], a[40:43], v[40:43]
  ds_read_b64 a[70:71], v10 offset:3336
  ds_read_b128 a[100:103], v11 offset:512
  s_waitcnt lgkmcnt(15)
  v_mfma_f32_16x16x32_bf16 v[36:39], a[0:3], a[44:47], v[36:39]
  ds_read_b64 a[72:73], v10 offset:2816
  v_mfma_f32_16x16x32_bf16 v[36:39], a[12:15], a[32:35], v[36:39]
  ds_read_b64 a[74:75], v10 offset:2824
  v_mfma_f32_16x16x32_bf16 v[40:43], a[4:7], a[44:47], v[40:43]
  ds_read_b128 a[104:107], v11 offset:1024
  ds_read_b64 a[76:77], v10 offset:2304
  v_mfma_f32_16x16x32_bf16 v[40:43], a[12:15], a[36:39], v[40:43]
  ds_read_b64 a[78:79], v10 offset:2312
  v_mfma_f32_16x16x32_bf16 v[40:43], a[0:3], a[48:51], v[40:43]
  ds_read_b128 a[108:111], v11 offset:1536
  v_mfma_f32_16x16x32_bf16 v[40:43], a[16:19], a[32:35], v[40:43]
  ds_read_b64 a[80:81], v10 offset:1792
  ds_read_b64 a[82:83], v10 offset:1800
  v_mfma_f32_16x16x32_bf16 v[44:47], a[12:15], a[48:51], v[44:47]
  ds_read_b128 a[112:115], v11 offset:2048
  v_mfma_f32_16x16x32_bf16 v[44:47], a[16:19], a[44:47], v[44:47]
  ds_read_b64 a[84:85], v10 offset:1280
  s_waitcnt lgkmcnt(15)
  v_mfma_f32_16x16x32_bf16 v[44:47], a[8:11], a[52:55], v[44:47]
  ds_read_b64 a[86:87], v10 offset:1288
  ds_read_b128 a[116:119], v11 offset:2560
  v_mfma_f32_16x16x32_bf16 v[44:47], a[20:23], a[40:43], v[44:47]
  ds_read_b64 a[88:89], v10 offset:768
  v_mfma_f32_16x16x32_bf16 v[44:47], a[4:7], a[56:59], v[44:47]
  ds_read_b64 a[90:91], v10 offset:776
  v_mfma_f32_16x16x32_bf16 v[44:47], a[24:27], a[36:39], v[44:47]
  ds_read_b128 a[120:123], v11 offset:3072
  ds_read_b64 a[92:93], v10 offset:256
  v_mfma_f32_16x16x32_bf16 v[44:47], a[0:3], a[60:63], v[44:47]
  ds_read_b64 a[94:95], v10 offset:264
  v_mfma_f32_16x16x32_bf16 v[44:47], a[28:31], a[32:35], v[44:47]
  ds_read_b128 a[124:127], v11 offset:3584
  s_waitcnt lgkmcnt(15)
  v_mfma_f32_16x16x32_bf16 v[32:35], a[64:67], a[96:99], v[32:35]
  v_mfma_f32_16x16x32_bf16 v[36:39], a[68:71], a[104:107], v[36:39]
  v_mfma_f32_16x16x32_bf16 v[36:39], a[72:75], a[100:103], v[36:39]
  v_mfma_f32_16x16x32_bf16 v[40:43], a[72:75], a[104:107], v[40:43]
  s_waitcnt lgkmcnt(12)
  v_mfma_f32_16x16x32_bf16 v[36:39], a[64:67], a[108:111], v[36:39]
  v_mfma_f32_16x16x32_bf16 v[36:39], a[76:79], a[96:99], v[36:39]
  v_mfma_f32_16x16x32_bf16 v[40:43], a[68:71], a[108:111], v[40:43]
  v_mfma_f32_16x16x32_bf16 v[40:43], a[76:79], a[100:103], v[40:43]
  s_waitcnt lgkmcnt(9)
  v_mfma_f32_16x16x32_bf16 v[40:43], a[64:67], a[112:115], v[40:43]
  v_mfma_f32_16x16x32_bf16 v[40:43], a[80:83], a[96:99], v[40:43]
  v_mfma_f32_16x16x32_bf16 v[44:47], a[76:79], a[112:115], v[44:47]
  v_mfma_f32_16x16x32_bf16 v[44:47], a[80:83], a[108:111], v[44:47]
  s_waitcnt lgkmcnt(6)
  v_mfma_f32_16x16x32_bf16 v[44:47], a[72:75], a[116:119], v[44:47]
  v_mfma_f32_16x16x32_bf16 v[44:47], a[84:87], a[104:107], v[44:47]
  s_waitcnt lgkmcnt(3)
  v_mfma_f32_16x16x32_bf16 v[44:47], a[68:71], a[120:123], v[44:47]
  v_mfma_f32_16x16x32_bf16 v[44:47], a[88:91], a[100:103], v[44:47]
  s_waitcnt lgkmcnt(0)
  v_mfma_f32_16x16x32_bf16 v[44:47], a[64:67], a[124:127], v[44:47]
  v_mfma_f32_16x16x32_bf16 v[44:47], a[92:95], a[96:99], v[44:47]
  s_cmp_eq_u32 s59, 0
  s_cbranch_scc1 L_x000
  ds_write_b128 v14, v[32:35] offset:0
  ds_write_b128 v14, v[36:39] offset:1024
  ds_write_b128 v14, v[40:43] offset:2048
  s_nop 2
  ds_write_b128 v14, v[44:47] offset:3072
L_x000:
  v_add_u32 v11, 4608, v11
  s_add_u32 s38, s38, 1
  s_waitcnt lgkmcnt(0)
  s_barrier
  s_cmp_eq_u32 s38, 9
  s_cbranch_scc1 L_cend0
  ds_read_b64 a[0:1], v10 offset:20672
  ds_read_b64 a[2:3], v10 offset:20680
  ds_read_b128 a[32:35], v11 offset:192
  ds_read_b64 a[4:5], v10 offset:20160
  ds_read_b64 a[6:7], v10 offset:20168
  ds_read_b128 a[36:39], v11 offset:704
  ds_read_b64 a[8:9], v10 offset:19648
  ds_read_b64 a[10:11], v10 offset:19656
  ds_read_b128 a[40:43], v11 offset:1216
  ds_read_b64 a[12:13], v10 offset:19136
  ds_read_b64 a[14:15], v10 offset:19144
  ds_read_b128 a[44:47], v11 offset:1728
  ds_read_b64 a[16:17], v10 offset:18624
  ds_read_b64 a[18:19], v10 offset:18632
  ds_read_b128 a[48:51], v11 offset:2240
  ds_read_b64 a[20:21], v10 offset:18112
  ds_read_b64 a[22:23], v10 offset:18120
  ds_read_b128 a[52:55], v11 offset:2752
  ds_read_b64 a[24:25], v10 offset:17600
  ds_read_b64 a[26:27], v10 offset:17608
  ds_read_b128 a[56:59], v11 offset:3264
  ds_read_b64 a[28:29], v10 offset:17088
  ds_read_b64 a[30:31], v10 offset:17096
  ds_read_b128 a[60:63], v11 offset:3776
  s_cmp_eq_u32 s59, 0
  s_cbranch_scc1 L_f001
  s_cmp_ge_u32 s38, 8
  s_cbranch_scc1 L_fe01
  s_waitcnt vmcnt(0)
  v_perm_b32 v90, v89, v88, s57
  ds_write_b32 v5, v90
  v_add_u32 v5, 512, v5
  s_add_u32 s65, s65, 294912
  buffer_load_ushort v88, v6, s[8:11], s65 offen
  buffer_load_ushort v89, v6, s[8:11], s65 offen offset:1152
  s_branch L_fe01
L_f001:
  s_cmp_eq_u32 s38, 0
  s_cbranch_scc1 L_fe01
  ds_read_b128 v[48:51], v14 offset:0
  ds_read_b128 v[52:55], v14 offset:1024
  ds_read_b128 v[56:59], v14 offset:2048
  ds_read_b128 v[60:63], v14 offset:3072
  s_waitcnt lgkmcnt(3)
  v_add_f32 v32, v32, v48
  v_add_f32 v33, v33, v49
  v_add_f32 v34, v34, v50
  v_add_f32 v35, v35, v51
  v_cvt_pk_bf16_f32 v48, v32, v33
  v_cvt_pk_bf16_f32 v49, v34, v35
  s_waitcnt lgkmcnt(2)
  v_add_f32 v36, v36, v52
  v_add_f32 v37, v37, v53
  v_add_f32 v38, v38, v54
  v_add_f32 v39, v39, v55
  v_cvt_pk_bf16_f32 v50, v36, v37
  v_cvt_pk_bf16_f32 v51, v38, v39
  s_waitcnt lgkmcnt(1)
  v_add_f32 v40, v40, v56
  v_add_f32 v41, v41, v57
  v_add_f32 v42, v42, v58
  v_add_f32 v43, v43, v59
  v_cvt_pk_bf16_f32 v52, v40, v41
  v_cvt_pk_bf16_f32 v53, v42, v43
  s_waitcnt lgkmcnt(0)
  v_add_f32 v44, v44, v60
  v_add_f32 v45, v45, v61
  v_add_f32 v46, v46, v62
  v_add_f32 v47, v47, v63
  v_cvt_pk_bf16_f32 v54, v44, v45
  v_cvt_pk_bf16_f32 v55, v46, v47
  v_permlane16_swap_b32 v48, v50
  v_permlane16_swap_b32 v49, v51
  buffer_store_dwordx4 v[48:51], v12, s[20:23], s63 offen offset:0 sc1
  v_permlane16_swap_b32 v52, v54
  v_permlane16_swap_b32 v53, v55
  buffer_store_dwordx4 v[52:55], v12, s[20:23], s63 offen offset:2048 sc1
  s_add_u32 s63, s63, 4096
  s_cmp_lg_u32 s38, 8
  s_cbranch_scc1 L_fe01
  s_lshl_b32 s63, s36, 12
  s_add_u32 s63, s63, 35651584
L_fe01:
  s_cmp_lg_u32 s38, 7
  s_cbranch_scc1 L_gb01
  s_barrier
L_gb01:
  s_cmp_ge_u32 s38, 8
  s_cbranch_scc1 L_ne01
  ds_read_b32 v60, v17 offset:0
  ds_read_b32 v61, v18 offset:0
  ds_read_b32 v62, v19 offset:0
  ds_read_b32 v63, v20 offset:0
  ds_read_b32 v64, v21 offset:0
  ds_read_b32 v65, v22 offset:0
  ds_read_b32 v66, v23 offset:0
  ds_read_b32 v67, v24 offset:0
  ds_read_b32 v68, v25 offset:0
  ds_read_b32 v69, v26 offset:0
  ds_read_b32 v70, v27 offset:0
  s_waitcnt lgkmcnt(9)
  v_cvt_pk_bf16_f32 v72, v60, v61
  s_waitcnt lgkmcnt(8)
  v_cvt_pk_bf16_f32 v76, v61, v62
  s_waitcnt lgkmcnt(7)
  v_cvt_pk_bf16_f32 v80, v62, v63
  s_waitcnt lgkmcnt(6)
  v_cvt_pk_bf16_f32 v84, v63, v64
  v_cvt_pk_bf16_f32 v73, v62, v63
  v_cvt_pk_bf16_f32 v77, v63, v64
  s_waitcnt lgkmcnt(5)
  v_cvt_pk_bf16_f32 v81, v64, v65
  s_waitcnt lgkmcnt(4)
  v_cvt_pk_bf16_f32 v85, v65, v66
  v_cvt_pk_bf16_f32 v74, v64, v65
  v_cvt_pk_bf16_f32 v78, v65, v66
  s_waitcnt lgkmcnt(3)
  v_cvt_pk_bf16_f32 v82, v66, v67
  s_waitcnt lgkmcnt(2)
  v_cvt_pk_bf16_f32 v86, v67, v68
  v_cvt_pk_bf16_f32 v75, v66, v67
  v_cvt_pk_bf16_f32 v79, v67, v68
  s_waitcnt lgkmcnt(1)
  v_cvt_pk_bf16_f32 v83, v68, v69
  s_waitcnt lgkmcnt(0)
  v_cvt_pk_bf16_f32 v87, v69, v70
  ds_write_b128 v9, v[72:75] offset:12480
  ds_write_b128 v9, v[76:79] offset:8320
  ds_write_b128 v9, v[80:83] offset:4160
  ds_write_b128 v9, v[84:87] offset:0
L_ne01:
  s_waitcnt lgkmcnt(15)
  v_mfma_f32_16x16x32_bf16 v[32:35], a[0:3], a[32:35], 0
  ds_read_b64 a[64:65], v10 offset:20608
  ds_read_b64 a[66:67], v10 offset:20616
  v_mfma_f32_16x16x32_bf16 v[36:39], a[4:7], a[40:43], 0
  ds_read_b128 a[96:99], v11 offset:128
  v_mfma_f32_16x16x32_bf16 v[36:39], a[8:11], a[36:39], v[36:39]
  ds_read_b64 a[68:69], v10 offset:20096
  v_mfma_f32_16x16x32_bf16 v[40:43], a[8:11], a[40:43], 0
  ds_read_b64 a[70:71], v10 offset:20104
  ds_read_b128 a[100:103], v11 offset:640
  s_waitcnt lgkmcnt(15)
  v_mfma_f32_16x16x32_bf16 v[36:39], a[0:3], a[44:47], v[36:39]
  ds_read_b64 a[72:73], v10 offset:19584
  v_mfma_f32_16x16x32_bf16 v[36:39], a[12:15], a[32:35], v[36:39]
  ds_read_b64 a[74:75], v10 offset:19592
  v_mfma_f32_16x16x32_bf16 v[40:43], a[4:7], a[44:47], v[40:43]
  ds_read_b128 a[104:107], v11 offset:1152
  ds_read_b64 a[76:77], v10 offset:19072
  v_mfma_f32_16x16x32_bf16 v[40:43], a[12:15], a[36:39], v[40:43]
  ds_read_b64 a[78:79], v10 offset:19080
  v_mfma_f32_16x16x32_bf16 v[40:43], a[0:3], a[48:51], v[40:43]
  ds_read_b128 a[108:111], v11 offset:1664
  v_mfma_f32_16x16x32_bf16 v[40:43], a[16:19], a[32:35], v[40:43]
  ds_read_b64 a[80:81], v10 offset:18560
  ds_read_b64 a[82:83], v10 offset:18568
  v_mfma_f32_16x16x32_bf16 v[44:47], a[12:15], a[48:51], 0
  ds_read_b128 a[112:115], v11 offset:2176
  v_mfma_f32_16x16x32_bf16 v[44:47], a[16:19], a[44:47], v[44:47]
  ds_read_b64 a[84:85], v10 offset:18048
  s_waitcnt lgkmcnt(15)
  v_mfma_f32_16x16x32_bf16 v[44:47], a[8:11], a[52:55], v[44:47]
  ds_read_b64 a[86:87], v10 offset:18056
  ds_read_b128 a[116:119], v11 offset:2688
  v_mfma_f32_16x16x32_bf16 v[44:47], a[20:23], a[40:43], v[44:47]
  ds_read_b64 a[88:89], v10 offset:17536
  v_mfma_f32_16x16x32_bf16 v[44:47], a[4:7], a[56:59], v[44:47]
  ds_read_b64 a[90:91], v10 offset:17544
  v_mfma_f32_16x16x32_bf16 v[44:47], a[24:27], a[36:39], v[44:47]
  ds_read_b128 a[120:123], v11 offset:3200
  ds_read_b64 a[92:93], v10 offset:17024
  v_mfma_f32_16x16x32_bf16 v[44:47], a[0:3], a[60:63], v[44:47]
  ds_read_b64 a[94:95], v10 offset:17032
  v_mfma_f32_16x16x32_bf16 v[44:47], a[28:31], a[32:35], v[44:47]
  ds_read_b128 a[124:127], v11 offset:3712
  s_waitcnt lgkmcnt(15)
  v_mfma_f32_16x16x32_bf16 v[32:35], a[64:67], a[96:99], v[32:35]
  ds_read_b64 a[0:1], v10 offset:20544
  ds_read_b64 a[2:3], v10 offset:20552
  v_mfma_f32_16x16x32_bf16 v[36:39], a[68:71], a[104:107], v[36:39]
  ds_read_b128 a[32:35], v11 offset:64
  v_mfma_f32_16x16x32_bf16 v[36:39], a[72:75], a[100:103], v[36:39]
  ds_read_b64 a[4:5], v10 offset:20032
  v_mfma_f32_16x16x32_bf16 v[40:43], a[72:75], a[104:107], v[40:43]
  ds_read_b64 a[6:7], v10 offset:20040
  ds_read_b128 a[36:39], v11 offset:576
  s_waitcnt lgkmcnt(15)
  v_mfma_f32_16x16x32_bf16 v[36:39], a[64:67], a[108:111], v[36:39]
  ds_read_b64 a[8:9], v10 offset:19520
  v_mfma_f32_16x16x32_bf16 v[36:39], a[76:79], a[96:99], v[36:39]
  ds_read_b64 a[10:11], v10 offset:19528
  v_mfma_f32_16x16x32_bf16 v[40:43], a[68:71], a[108:111], v[40:43]
  ds_read_b128 a[40:43], v11 offset:1088
  ds_read_b64 a[12:13], v10 offset:19008
  v_mfma_f32_16x16x32_bf16 v[40:43], a[76:79], a[100:103], v[40:43]
  ds_read_b64 a[14:15], v10 offset:19016
  v_mfma_f32_16x16x32_bf16 v[40:43], a[64:67], a[112:115], v[40:43]
  ds_read_b128 a[44:47], v11 offset:1600
  v_mfma_f32_16x16x32_bf16 v[40:43], a[80:83], a[96:99], v[40:43]
  ds_read_b64 a[16:17], v10 offset:18496
  ds_read_b64 a[18:19], v10 offset:18504
  v_mfma_f32_16x16x32_bf16 v[44:47], a[76:79], a[112:115], v[44:47]
  ds_read_b128 a[48:51], v11 offset:2112
  v_mfma_f32_16x16x32_bf16 v[44:47], a[80:83], a[108:111], v[44:47]
  ds_read_b64 a[20:21], v10 offset:17984
  s_waitcnt lgkmcnt(15)
  v_mfma_f32_16x16x32_bf16 v[44:47], a[72:75], a[116:119], v[44:47]
  ds_read_b64 a[22:23], v10 offset:17992
  ds_read_b128 a[52:55], v11 offset:2624
  v_mfma_f32_16x16x32_bf16 v[44:47], a[84:87], a[104:107], v[44:47]
  ds_read_b64 a[24:25], v10 offset:17472
  v_mfma_f32_16x16x32_bf16 v[44:47], a[68:71], a[120:123], v[44:47]
  ds_read_b64 a[26:27], v10 offset:17480
  v_mfma_f32_16x16x32_bf16 v[44:47], a[88:91], a[100:103], v[44:47]
  ds_read_b128 a[56:59], v11 offset:3136
  ds_read_b64 a[28:29], v10 offset:16960
  v_mfma_f32_16x16x32_bf16 v[44:47], a[64:67], a[124:127], v[44:47]
  ds_read_b64 a[30:31], v10 offset:16968
  v_mfma_f32_16x16x32_bf16 v[44:47], a[92:95], a[96:99], v[44:47]
  ds_read_b128 a[60:63], v11 offset:3648
  s_waitcnt lgkmcnt(15)
  v_mfma_f32_16x16x32_bf16 v[32:35], a[0:3], a[32:35], v[32:35]
  ds_read_b64 a[64:65], v10 offset:20480
  ds_read_b64 a[66:67], v10 offset:20488
  v_mfma_f32_16x16x32_bf16 v[36:39], a[4:7], a[40:43], v[36:39]
  ds_read_b128 a[96:99], v11 offset:0
  v_mfma_f32_16x16x32_bf16 v[36:39], a[8:11], a[36:39], v[36:39]
  ds_read_b64 a[68:69], v10 offset:19968
  v_mfma_f32_16x16x32_bf16 v[40:43], a[8:11], a[40:43], v[40:43]
  ds_read_b64 a[70:71], v10 offset:19976
  ds_read_b128 a[100:103], v11 offset:512
  s_waitcnt lgkmcnt(15)
  v_mfma_f32_16x16x32_bf16 v[36:39], a[0:3], a[44:47], v[36:39]
  ds_read_b64 a[72:73], v10 offset:19456
  v_mfma_f32_16x16x32_bf16 v[36:39], a[12:15], a[32:35], v[36:39]
  ds_read_b64 a[74:75], v10 offset:19464
  v_mfma_f32_16x16x32_bf16 v[40:43], a[4:7], a[44:47], v[40:43]
  ds_read_b128 a[104:107], v11 offset:1024
  ds_read_b64 a[76:77], v10 offset:18944
  v_mfma_f32_16x16x32_bf16 v[40:43], a[12:15], a[36:39], v[40:43]
  ds_read_b64 a[78:79], v10 offset:18952
  v_mfma_f32_16x16x32_bf16 v[40:43], a[0:3], a[48:51], v[40:43]
  ds_read_b128 a[108:111], v11 offset:1536
  v_mfma_f32_16x16x32_bf16 v[40:43], a[16:19], a[32:35], v[40:43]
  ds_read_b64 a[80:81], v10 offset:18432
  ds_read_b64 a[82:83], v10 offset:18440
  v_mfma_f32_16x16x32_bf16 v[44:47], a[12:15], a[48:51], v[44:47]
  ds_read_b128 a[112:115], v11 offset:2048
  v_mfma_f32_16x16x32_bf16 v[44:47], a[16:19], a[44:47], v[44:47]
  ds_read_b64 a[84:85], v10 offset:17920
  s_waitcnt lgkmcnt(15)
  v_mfma_f32_16x16x32_bf16 v[44:47], a[8:11], a[52:55], v[44:47]
  ds_read_b64 a[86:87], v10 offset:17928
  ds_read_b128 a[116:119], v11 offset:2560
  v_mfma_f32_16x16x32_bf16 v[44:47], a[20:23], a[40:43], v[44:47]
  ds_read_b64 a[88:89], v10 offset:17408
  v_mfma_f32_16x16x32_bf16 v[44:47], a[4:7], a[56:59], v[44:47]
  ds_read_b64 a[90:91], v10 offset:17416
  v_mfma_f32_16x16x32_bf16 v[44:47], a[24:27], a[36:39], v[44:47]
  ds_read_b128 a[120:123], v11 offset:3072
  ds_read_b64 a[92:93], v10 offset:16896
  v_mfma_f32_16x16x32_bf16 v[44:47], a[0:3], a[60:63], v[44:47]
  ds_read_b64 a[94:95], v10 offset:16904
  v_mfma_f32_16x16x32_bf16 v[44:47], a[28:31], a[32:35], v[44:47]
  ds_read_b128 a[124:127], v11 offset:3584
  s_waitcnt lgkmcnt(15)
  v_mfma_f32_16x16x32_bf16 v[32:35], a[64:67], a[96:99], v[32:35]
  v_mfma_f32_16x16x32_bf16 v[36:39], a[68:71], a[104:107], v[36:39]
  v_mfma_f32_16x16x32_bf16 v[36:39], a[72:75], a[100:103], v[36:39]
  v_mfma_f32_16x16x32_bf16 v[40:43], a[72:75], a[104:107], v[40:43]
  s_waitcnt lgkmcnt(12)
  v_mfma_f32_16x16x32_bf16 v[36:39], a[64:67], a[108:111], v[36:39]
  v_mfma_f32_16x16x32_bf16 v[36:39], a[76:79], a[96:99], v[36:39]
  v_mfma_f32_16x16x32_bf16 v[40:43], a[68:71], a[108:111], v[40:43]
  v_mfma_f32_16x16x32_bf16 v[40:43], a[76:79], a[100:103], v[40:43]
  s_waitcnt lgkmcnt(9)
  v_mfma_f32_16x16x32_bf16 v[40:43], a[64:67], a[112:115], v[40:43]
  v_mfma_f32_16x16x32_bf16 v[40:43], a[80:83], a[96:99], v[40:43]
  v_mfma_f32_16x16x32_bf16 v[44:47], a[76:79], a[112:115], v[44:47]
  v_mfma_f32_16x16x32_bf16 v[44:47], a[80:83], a[108:111], v[44:47]
  s_waitcnt lgkmcnt(6)
  v_mfma_f32_16x16x32_bf16 v[44:47], a[72:75], a[116:119], v[44:47]
  v_mfma_f32_16x16x32_bf16 v[44:47], a[84:87], a[104:107], v[44:47]
  s_waitcnt lgkmcnt(3)
  v_mfma_f32_16x16x32_bf16 v[44:47], a[68:71], a[120:123], v[44:47]
  v_mfma_f32_16x16x32_bf16 v[44:47], a[88:91], a[100:103], v[44:47]
  s_waitcnt lgkmcnt(0)
  v_mfma_f32_16x16x32_bf16 v[44:47], a[64:67], a[124:127], v[44:47]
  v_mfma_f32_16x16x32_bf16 v[44:47], a[92:95], a[96:99], v[44:47]
  s_cmp_eq_u32 s59, 0
  s_cbranch_scc1 L_x001
  ds_write_b128 v14, v[32:35] offset:8192
  ds_write_b128 v14, v[36:39] offset:9216
  ds_write_b128 v14, v[40:43] offset:10240
  s_nop 2
  ds_write_b128 v14, v[44:47] offset:11264
L_x001:
  v_add_u32 v11, 4608, v11
  s_add_u32 s38, s38, 1
  s_waitcnt lgkmcnt(0)
  s_barrier
  s_branch L_cloop0
L_cend0:
  s_cmp_eq_u32 s59, 0
  s_cbranch_scc1 L_f00e
  s_cmp_ge_u32 s38, 8
  s_cbranch_scc1 L_fe0e
  s_waitcnt vmcnt(0)
  v_perm_b32 v90, v89, v88, s57
  ds_write_b32 v5, v90
  v_add_u32 v5, 512, v5
  s_add_u32 s65, s65, 294912
  buffer_load_ushort v88, v6, s[8:11], s65 offen
  buffer_load_ushort v89, v6, s[8:11], s65 offen offset:1152
  s_branch L_fe0e
L_f00e:
  s_cmp_eq_u32 s38, 0
  s_cbranch_scc1 L_fe0e
  ds_read_b128 v[48:51], v14 offset:0
  ds_read_b128 v[52:55], v14 offset:1024
  ds_read_b128 v[56:59], v14 offset:2048
  ds_read_b128 v[60:63], v14 offset:3072
  s_waitcnt lgkmcnt(3)
  v_add_f32 v32, v32, v48
  v_add_f32 v33, v33, v49
  v_add_f32 v34, v34, v50
  v_add_f32 v35, v35, v51
  v_cvt_pk_bf16_f32 v48, v32, v33
  v_cvt_pk_bf16_f32 v49, v34, v35
  s_waitcnt lgkmcnt(2)
  v_add_f32 v36, v36, v52
  v_add_f32 v37, v37, v53
  v_add_f32 v38, v38, v54
  v_add_f32 v39, v39, v55
  v_cvt_pk_bf16_f32 v50, v36, v37
  v_cvt_pk_bf16_f32 v51, v38, v39
  s_waitcnt lgkmcnt(1)
  v_add_f32 v40, v40, v56
  v_add_f32 v41, v41, v57
  v_add_f32 v42, v42, v58
  v_add_f32 v43, v43, v59
  v_cvt_pk_bf16_f32 v52, v40, v41
  v_cvt_pk_bf16_f32 v53, v42, v43
  s_waitcnt lgkmcnt(0)
  v_add_f32 v44, v44, v60
  v_add_f32 v45, v45, v61
  v_add_f32 v46, v46, v62
  v_add_f32 v47, v47, v63
  v_cvt_pk_bf16_f32 v54, v44, v45
  v_cvt_pk_bf16_f32 v55, v46, v47
  v_permlane16_swap_b32 v48, v50
  v_permlane16_swap_b32 v49, v51
  buffer_store_dwordx4 v[48:51], v12, s[20:23], s63 offen offset:0 sc1
  v_permlane16_swap_b32 v52, v54
  v_permlane16_swap_b32 v53, v55
  buffer_store_dwordx4 v[52:55], v12, s[20:23], s63 offen offset:2048 sc1
  s_add_u32 s63, s63, 4096
  s_cmp_lg_u32 s38, 8
  s_cbranch_scc1 L_fe0e
  s_lshl_b32 s63, s36, 12
  s_add_u32 s63, s63, 35651584
L_fe0e:
  s_branch L_abr_end
  .p2align 3
L_cloop1:
  ds_read_b64 a[0:1], v10 offset:4032
  ds_read_b64 a[2:3], v10 offset:4040
  ds_read_b128 a[32:35], v11 offset:192
  ds_read_b64 a[4:5], v10 offset:3520
  ds_read_b64 a[6:7], v10 offset:3528
  ds_read_b128 a[36:39], v11 offset:704
  ds_read_b64 a[8:9], v10 offset:3008
  ds_read_b64 a[10:11], v10 offset:3016
  ds_read_b128 a[40:43], v11 offset:1216
  ds_read_b64 a[12:13], v10 offset:2496
  ds_read_b64 a[14:15], v10 offset:2504
  ds_read_b128 a[44:47], v11 offset:1728
  ds_read_b64 a[16:17], v10 offset:1984
  ds_read_b64 a[18:19], v10 offset:1992
  ds_read_b128 a[48:51], v11 offset:2240
  ds_read_b64 a[20:21], v10 offset:1472
  ds_read_b64 a[22:23], v10 offset:1480
  ds_read_b128 a[52:55], v11 offset:2752
  ds_read_b64 a[24:25], v10 offset:960
  ds_read_b64 a[26:27], v10 offset:968
  ds_read_b128 a[56:59], v11 offset:3264
  s_cmp_eq_u32 s59, 0
  s_cbranch_scc1 L_f010
  s_cmp_ge_u32 s38, 8
  s_cbranch_scc1 L_fe10
  s_waitcnt vmcnt(0)
  v_perm_b32 v90, v89, v88, s57
  ds_write_b32 v5, v90
  v_add_u32 v5, 512, v5
  s_add_u32 s65, s65, 294912
  buffer_load_ushort v88, v6, s[8:11], s65 offen
  buffer_load_ushort v89, v6, s[8:11], s65 offen offset:1152
  s_branch L_fe10
L_f010:
  s_cmp_eq_u32 s38, 0
  s_cbranch_scc1 L_fe10
  ds_read_b128 v[48:51], v14 offset:8192
  ds_read_b128 v[52:55], v14 offset:9216
  ds_read_b128 v[56:59], v14 offset:10240
  ds_read_b128 v[60:63], v14 offset:11264
  s_waitcnt lgkmcnt(3)
  v_add_f32 v32, v32, v48
  v_add_f32 v33, v33, v49
  v_add_f32 v34, v34, v50
  v_add_f32 v35, v35, v51
  v_cvt_pk_bf16_f32 v48, v32, v33
  v_cvt_pk_bf16_f32 v49, v34, v35
  s_waitcnt lgkmcnt(2)
  v_add_f32 v36, v36, v52
  v_add_f32 v37, v37, v53
  v_add_f32 v38, v38, v54
  v_add_f32 v39, v39, v55
  v_cvt_pk_bf16_f32 v50, v36, v37
  v_cvt_pk_bf16_f32 v51, v38, v39
  s_waitcnt lgkmcnt(1)
  v_add_f32 v40, v40, v56
  v_add_f32 v41, v41, v57
  v_add_f32 v42, v42, v58
  v_add_f32 v43, v43, v59
  v_cvt_pk_bf16_f32 v52, v40, v41
  v_cvt_pk_bf16_f32 v53, v42, v43
  s_waitcnt lgkmcnt(0)
  v_add_f32 v44, v44, v60
  v_add_f32 v45, v45, v61
  v_add_f32 v46, v46, v62
  v_add_f32 v47, v47, v63
  v_cvt_pk_bf16_f32 v54, v44, v45
  v_cvt_pk_bf16_f32 v55, v46, v47
  v_permlane16_swap_b32 v48, v50
  v_permlane16_swap_b32 v49, v51
  buffer_store_dwordx4 v[48:51], v12, s[20:23], s63 offen offset:512 sc1
  v_permlane16_swap_b32 v52, v54
  v_permlane16_swap_b32 v53, v55
  buffer_store_dwordx4 v[52:55], v12, s[20:23], s63 offen offset:2560 sc1
  s_add_u32 s63, s63, 4096
  s_cmp_lg_u32 s38, 8
  s_cbranch_scc1 L_fe10
  s_lshl_b32 s63, s36, 12
  s_add_u32 s63, s63, 35651584
L_fe10:
  s_cmp_ge_u32 s38, 8
  s_cbranch_scc1 L_ne10
  ds_read_b32 v60, v17 offset:3200
  ds_read_b32 v61, v18 offset:3200
  ds_read_b32 v62, v19 offset:3200
  ds_read_b32 v63, v20 offset:3200
  ds_read_b32 v64, v21 offset:3200
  ds_read_b32 v65, v22 offset:3200
  ds_read_b32 v66, v23 offset:3200
  ds_read_b32 v67, v24 offset:3200
  ds_read_b32 v68, v25 offset:3200
  ds_read_b32 v69, v26 offset:3200
  ds_read_b32 v70, v27 offset:3200
  s_waitcnt lgkmcnt(9)
  v_cvt_pk_bf16_f32 v72, v60, v61
  s_waitcnt lgkmcnt(8)
  v_cvt_pk_bf16_f32 v76, v61, v62
  s_waitcnt lgkmcnt(7)
  v_cvt_pk_bf16_f32 v80, v62, v63
  s_waitcnt lgkmcnt(6)
  v_cvt_pk_bf16_f32 v84, v63, v64
  v_cvt_pk_bf16_f32 v73, v62, v63
  v_cvt_pk_bf16_f32 v77, v63, v64
  s_waitcnt lgkmcnt(5)
  v_cvt_pk_bf16_f32 v81, v64, v65
  s_waitcnt lgkmcnt(4)
  v_cvt_pk_bf16_f32 v85, v65, v66
  v_cvt_pk_bf16_f32 v74, v64, v65
  v_cvt_pk_bf16_f32 v78, v65, v66
  s_waitcnt lgkmcnt(3)
  v_cvt_pk_bf16_f32 v82, v66, v67
  s_waitcnt lgkmcnt(2)
  v_cvt_pk_bf16_f32 v86, v67, v68
  v_cvt_pk_bf16_f32 v75, v66, v67
  v_cvt_pk_bf16_f32 v79, v67, v68
  s_waitcnt lgkmcnt(1)
  v_cvt_pk_bf16_f32 v83, v68, v69
  s_waitcnt lgkmcnt(0)
  v_cvt_pk_bf16_f32 v87, v69, v70
  ds_write_b128 v9, v[72:75] offset:29120
  ds_write_b128 v9, v[76:79] offset:24960
  ds_write_b128 v9, v[80:83] offset:20800
  ds_write_b128 v9, v[84:87] offset:16640
L_ne10:
  s_waitcnt lgkmcnt(15)
  v_mfma_f32_16x16x32_bf16 v[32:35], a[0:3], a[36:39], 0
  ds_read_b64 a[64:65], v10 offset:3968
  ds_read_b64 a[66:67], v10 offset:3976
  v_mfma_f32_16x16x32_bf16 v[32:35], a[4:7], a[32:35], v[32:35]
  ds_read_b128 a[96:99], v11 offset:128
  v_mfma_f32_16x16x32_bf16 v[36:39], a[4:7], a[36:39], 0
  ds_read_b64 a[68:69], v10 offset:3456
  s_waitcnt lgkmcnt(15)
  v_mfma_f32_16x16x32_bf16 v[36:39], a[0:3], a[40:43], v[36:39]
  ds_read_b64 a[70:71], v10 offset:3464
  v_mfma_f32_16x16x32_bf16 v[36:39], a[8:11], a[32:35], v[36:39]
  ds_read_b128 a[100:103], v11 offset:640
  s_waitcnt lgkmcnt(15)
  v_mfma_f32_16x16x32_bf16 v[40:43], a[8:11], a[44:47], 0
  ds_read_b64 a[72:73], v10 offset:2944
  v_mfma_f32_16x16x32_bf16 v[40:43], a[12:15], a[40:43], v[40:43]
  ds_read_b64 a[74:75], v10 offset:2952
  ds_read_b128 a[104:107], v11 offset:1152
  v_mfma_f32_16x16x32_bf16 v[44:47], a[12:15], a[44:47], 0
  ds_read_b64 a[76:77], v10 offset:2432
  s_waitcnt lgkmcnt(15)
  v_mfma_f32_16x16x32_bf16 v[40:43], a[4:7], a[48:51], v[40:43]
  ds_read_b64 a[78:79], v10 offset:2440
  v_mfma_f32_16x16x32_bf16 v[40:43], a[16:19], a[36:39], v[40:43]
  ds_read_b128 a[108:111], v11 offset:1664
  v_mfma_f32_16x16x32_bf16 v[44:47], a[8:11], a[48:51], v[44:47]
  ds_read_b64 a[80:81], v10 offset:1920
  v_mfma_f32_16x16x32_bf16 v[44:47], a[16:19], a[40:43], v[44:47]
  ds_read_b64 a[82:83], v10 offset:1928
  s_waitcnt lgkmcnt(15)
  v_mfma_f32_16x16x32_bf16 v[40:43], a[0:3], a[52:55], v[40:43]
  ds_read_b128 a[112:115], v11 offset:2176
  ds_read_b64 a[84:85], v10 offset:1408
  v_mfma_f32_16x16x32_bf16 v[40:43], a[20:23], a[32:35], v[40:43]
  ds_read_b64 a[86:87], v10 offset:1416
  v_mfma_f32_16x16x32_bf16 v[44:47], a[4:7], a[52:55], v[44:47]
  ds_read_b128 a[116:119], v11 offset:2688
  v_mfma_f32_16x16x32_bf16 v[44:47], a[20:23], a[36:39], v[44:47]
  ds_read_b64 a[88:89], v10 offset:896
  s_waitcnt lgkmcnt(15)
  v_mfma_f32_16x16x32_bf16 v[44:47], a[0:3], a[56:59], v[44:47]
  ds_read_b64 a[90:91], v10 offset:904
  v_mfma_f32_16x16x32_bf16 v[44:47], a[24:27], a[32:35], v[44:47]
  ds_read_b128 a[120:123], v11 offset:3200
  s_waitcnt lgkmcnt(15)
  v_mfma_f32_16x16x32_bf16 v[32:35], a[64:67], a[100:103], v[32:35]
  ds_read_b64 a[0:1], v10 offset:3904
  ds_read_b64 a[2:3], v10 offset:3912
  v_mfma_f32_16x16x32_bf16 v[32:35], a[68:71], a[96:99], v[32:35]
  ds_read_b128 a[32:35], v11 offset:64
  v_mfma_f32_16x16x32_bf16 v[36:39], a[68:71], a[100:103], v[36:39]
  ds_read_b64 a[4:5], v10 offset:3392
  s_waitcnt lgkmcnt(15)
  v_mfma_f32_16x16x32_bf16 v[36:39], a[64:67], a[104:107], v[36:39]
  ds_read_b64 a[6:7], v10 offset:3400
  v_mfma_f32_16x16x32_bf16 v[36:39], a[72:75], a[96:99], v[36:39]
  ds_read_b128 a[36:39], v11 offset:576
  s_waitcnt lgkmcnt(15)
  v_mfma_f32_16x16x32_bf16 v[40:43], a[72:75], a[108:111], v[40:43]
  ds_read_b64 a[8:9], v10 offset:2880
  v_mfma_f32_16x16x32_bf16 v[40:43], a[76:79], a[104:107], v[40:43]
  ds_read_b64 a[10:11], v10 offset:2888
  ds_read_b128 a[40:43], v11 offset:1088
  v_mfma_f32_16x16x32_bf16 v[44:47], a[76:79], a[108:111], v[44:47]
  ds_read_b64 a[12:13], v10 offset:2368
  s_waitcnt lgkmcnt(15)
  v_mfma_f32_16x16x32_bf16 v[40:43], a[68:71], a[112:115], v[40:43]
  ds_read_b64 a[14:15], v10 offset:2376
  v_mfma_f32_16x16x32_bf16 v[40:43], a[80:83], a[100:103], v[40:43]
  ds_read_b128 a[44:47], v11 offset:1600
  v_mfma_f32_16x16x32_bf16 v[44:47], a[72:75], a[112:115], v[44:47]
  ds_read_b64 a[16:17], v10 offset:1856
  v_mfma_f32_16x16x32_bf16 v[44:47], a[80:83], a[104:107], v[44:47]
  ds_read_b64 a[18:19], v10 offset:1864
  s_waitcnt lgkmcnt(15)
  v_mfma_f32_16x16x32_bf16 v[40:43], a[64:67], a[116:119], v[40:43]
  ds_read_b128 a[48:51], v11 offset:2112
  ds_read_b64 a[20:21], v10 offset:1344
  v_mfma_f32_16x16x32_bf16 v[40:43], a[84:87], a[96:99], v[40:43]
  ds_read_b64 a[22:23], v10 offset:1352
  v_mfma_f32_16x16x32_bf16 v[44:47], a[68:71], a[116:119], v[44:47]
  ds_read_b128 a[52:55], v11 offset:2624
  v_mfma_f32_16x16x32_bf16 v[44:47], a[84:87], a[100:103], v[44:47]
  ds_read_b64 a[24:25], v10 offset:832
  s_waitcnt lgkmcnt(15)
  v_mfma_f32_16x16x32_bf16 v[44:47], a[64:67], a[120:123], v[44:47]
  ds_read_b64 a[26:27], v10 offset:840
  v_mfma_f32_16x16x32_bf16 v[44:47], a[88:91], a[96:99], v[44:47]
  ds_read_b128 a[56:59], v11 offset:3136
  s_waitcnt lgkmcnt(15)
  v_mfma_f32_16x16x32_bf16 v[32:35], a[0:3], a[36:39], v[32:35]
  ds_read_b64 a[64:65], v10 offset:3840
  ds_read_b64 a[66:67], v10 offset:3848
  v_mfma_f32_16x16x32_bf16 v[32:35], a[4:7], a[32:35], v[32:35]
  ds_read_b128 a[96:99], v11 offset:0
  v_mfma_f32_16x16x32_bf16 v[36:39], a[4:7], a[36:39], v[36:39]
  ds_read_b64 a[68:69], v10 offset:3328
  s_waitcnt lgkmcnt(15)
  v_mfma_f32_16x16x32_bf16 v[36:39], a[0:3], a[40:43], v[36:39]
  ds_read_b64 a[70:71], v10 offset:3336
  v_mfma_f32_16x16x32_bf16 v[36:39], a[8:11], a[32:35], v[36:39]
  ds_read_b128 a[100:103], v11 offset:512
  s_waitcnt lgkmcnt(15)
  v_mfma_f32_16x16x32_bf16 v[40:43], a[8:11], a[44:47], v[40:43]
  ds_read_b64 a[72:73], v10 offset:2816
  v_mfma_f32_16x16x32_bf16 v[40:43], a[12:15], a[40:43], v[40:43]
  ds_read_b64 a[74:75], v10 offset:2824
  ds_read_b128 a[104:107], v11 offset:1024
  v_mfma_f32_16x16x32_bf16 v[44:47], a[12:15], a[44:47], v[44:47]
  ds_read_b64 a[76:77], v10 offset:2304
  s_waitcnt lgkmcnt(15)
  v_mfma_f32_16x16x32_bf16 v[40:43], a[4:7], a[48:51], v[40:43]
  ds_read_b64 a[78:79], v10 offset:2312
  v_mfma_f32_16x16x32_bf16 v[40:43], a[16:19], a[36:39], v[40:43]
  ds_read_b128 a[108:111], v11 offset:1536
  v_mfma_f32_16x16x32_bf16 v[44:47], a[8:11], a[48:51], v[44:47]
  ds_read_b64 a[80:81], v10 offset:1792
  v_mfma_f32_16x16x32_bf16 v[44:47], a[16:19], a[40:43], v[44:47]
  ds_read_b64 a[82:83], v10 offset:1800
  s_waitcnt lgkmcnt(15)
  v_mfma_f32_16x16x32_bf16 v[40:43], a[0:3], a[52:55], v[40:43]
  ds_read_b128 a[112:115], v11 offset:2048
  ds_read_b64 a[84:85], v10 offset:1280
  v_mfma_f32_16x16x32_bf16 v[40:43], a[20:23], a[32:35], v[40:43]
  ds_read_b64 a[86:87], v10 offset:1288
  v_mfma_f32_16x16x32_bf16 v[44:47], a[4:7], a[52:55], v[44:47]
  ds_read_b128 a[116:119], v11 offset:2560
  v_mfma_f32_16x16x32_bf16 v[44:47], a[20:23], a[36:39], v[44:47]
  ds_read_b64 a[88:89], v10 offset:768
  s_waitcnt lgkmcnt(15)
  v_mfma_f32_16x16x32_bf16 v[44:47], a[0:3], a[56:59], v[44:47]
  ds_read_b64 a[90:91], v10 offset:776
  v_mfma_f32_16x16x32_bf16 v[44:47], a[24:27], a[32:35], v[44:47]
  ds_read_b128 a[120:123], v11 offset:3072
  s_waitcnt lgkmcnt(15)
  v_mfma_f32_16x16x32_bf16 v[32:35], a[64:67], a[100:103], v[32:35]
  v_mfma_f32_16x16x32_bf16 v[32:35], a[68:71], a[96:99], v[32:35]
  v_mfma_f32_16x16x32_bf16 v[36:39], a[68:71], a[100:103], v[36:39]
  s_waitcnt lgkmcnt(12)
  v_mfma_f32_16x16x32_bf16 v[36:39], a[64:67], a[104:107], v[36:39]
  v_mfma_f32_16x16x32_bf16 v[36:39], a[72:75], a[96:99], v[36:39]
  s_waitcnt lgkmcnt(9)
  v_mfma_f32_16x16x32_bf16 v[40:43], a[72:75], a[108:111], v[40:43]
  v_mfma_f32_16x16x32_bf16 v[40:43], a[76:79], a[104:107], v[40:43]
  v_mfma_f32_16x16x32_bf16 v[44:47], a[76:79], a[108:111], v[44:47]
  s_waitcnt lgkmcnt(6)
  v_mfma_f32_16x16x32_bf16 v[40:43], a[68:71], a[112:115], v[40:43]
  v_mfma_f32_16x16x32_bf16 v[40:43], a[80:83], a[100:103], v[40:43]
  v_mfma_f32_16x16x32_bf16 v[44:47], a[72:75], a[112:115], v[44:47]
  v_mfma_f32_16x16x32_bf16 v[44:47], a[80:83], a[104:107], v[44:47]
  s_waitcnt lgkmcnt(3)
  v_mfma_f32_16x16x32_bf16 v[40:43], a[64:67], a[116:119], v[40:43]
  v_mfma_f32_16x16x32_bf16 v[40:43], a[84:87], a[96:99], v[40:43]
  v_mfma_f32_16x16x32_bf16 v[44:47], a[68:71], a[116:119], v[44:47]
  v_mfma_f32_16x16x32_bf16 v[44:47], a[84:87], a[100:103], v[44:47]
  s_waitcnt lgkmcnt(0)
  v_mfma_f32_16x16x32_bf16 v[44:47], a[64:67], a[120:123], v[44:47]
  v_mfma_f32_16x16x32_bf16 v[44:47], a[88:91], a[96:99], v[44:47]
  s_cmp_eq_u32 s59, 0
  s_cbranch_scc1 L_x010
  ds_write_b128 v14, v[32:35] offset:0
  ds_write_b128 v14, v[36:39] offset:1024
  ds_write_b128 v14, v[40:43] offset:2048
  s_nop 2
  ds_write_b128 v14, v[44:47] offset:3072
L_x010:
  v_add_u32 v11, 4608, v11
  s_add_u32 s38, s38, 1
  s_waitcnt lgkmcnt(0)
  s_barrier
  s_cmp_eq_u32 s38, 9
  s_cbranch_scc1 L_cend1
  ds_read_b64 a[0:1], v10 offset:20672
  ds_read_b64 a[2:3], v10 offset:20680
  ds_read_b128 a[32:35], v11 offset:192
  ds_read_b64 a[4:5], v10 offset:20160
  ds_read_b64 a[6:7], v10 offset:20168
  ds_read_b128 a[36:39], v11 offset:704
  ds_read_b64 a[8:9], v10 offset:19648
  ds_read_b64 a[10:11], v10 offset:19656
  ds_read_b128 a[40:43], v11 offset:1216
  ds_read_b64 a[12:13], v10 offset:19136
  ds_read_b64 a[14:15], v10 offset:19144
  ds_read_b128 a[44:47], v11 offset:1728
  ds_read_b64 a[16:17], v10 offset:18624
  ds_read_b64 a[18:19], v10 offset:18632
  ds_read_b128 a[48:51], v11 offset:2240
  ds_read_b64 a[20:21], v10 offset:18112
  ds_read_b64 a[22:23], v10 offset:18120
  ds_read_b128 a[52:55], v11 offset:2752
  ds_read_b64 a[24:25], v10 offset:17600
  ds_read_b64 a[26:27], v10 offset:17608
  ds_read_b128 a[56:59], v11 offset:3264
  s_cmp_eq_u32 s59, 0
  s_cbranch_scc1 L_f011
  s_cmp_ge_u32 s38, 8
  s_cbranch_scc1 L_fe11
  s_waitcnt vmcnt(0)
  v_perm_b32 v90, v89, v88, s57
  ds_write_b32 v5, v90
  v_add_u32 v5, 512, v5
  s_add_u32 s65, s65, 294912
  buffer_load_ushort v88, v6, s[8:11], s65 offen
  buffer_load_ushort v89, v6, s[8:11], s65 offen offset:1152
  s_branch L_fe11
L_f011:
  s_cmp_eq_u32 s38, 0
  s_cbranch_scc1 L_fe11
  ds_read_b128 v[48:51], v14 offset:0
  ds_read_b128 v[52:55], v14 offset:1024
  ds_read_b128 v[56:59], v14 offset:2048
  ds_read_b128 v[60:63], v14 offset:3072
  s_waitcnt lgkmcnt(3)
  v_add_f32 v32, v32, v48
  v_add_f32 v33, v33, v49
  v_add_f32 v34, v34, v50
  v_add_f32 v35, v35, v51
  v_cvt_pk_bf16_f32 v48, v32, v33
  v_cvt_pk_bf16_f32 v49, v34, v35
  s_waitcnt lgkmcnt(2)
  v_add_f32 v36, v36, v52
  v_add_f32 v37, v37, v53
  v_add_f32 v38, v38, v54
  v_add_f32 v39, v39, v55
  v_cvt_pk_bf16_f32 v50, v36, v37
  v_cvt_pk_bf16_f32 v51, v38, v39
  s_waitcnt lgkmcnt(1)
  v_add_f32 v40, v40, v56
  v_add_f32 v41, v41, v57
  v_add_f32 v42, v42, v58
  v_add_f32 v43, v43, v59
  v_cvt_pk_bf16_f32 v52, v40, v41
  v_cvt_pk_bf16_f32 v53, v42, v43
  s_waitcnt lgkmcnt(0)
  v_add_f32 v44, v44, v60
  v_add_f32 v45, v45, v61
  v_add_f32 v46, v46, v62
  v_add_f32 v47, v47, v63
  v_cvt_pk_bf16_f32 v54, v44, v45
  v_cvt_pk_bf16_f32 v55, v46, v47
  v_permlane16_swap_b32 v48, v50
  v_permlane16_swap_b32 v49, v51
  buffer_store_dwordx4 v[48:51], v12, s[20:23], s63 offen offset:512 sc1
  v_permlane16_swap_b32 v52, v54
  v_permlane16_swap_b32 v53, v55
  buffer_store_dwordx4 v[52:55], v12, s[20:23], s63 offen offset:2560 sc1
  s_add_u32 s63, s63, 4096
  s_cmp_lg_u32 s38, 8
  s_cbranch_scc1 L_fe11
  s_lshl_b32 s63, s36, 12
  s_add_u32 s63, s63, 35651584
L_fe11:
  s_cmp_lg_u32 s38, 7
  s_cbranch_scc1 L_gb11
  s_barrier
L_gb11:
  s_cmp_ge_u32 s38, 8
  s_cbranch_scc1 L_ne11
  ds_read_b32 v60, v17 offset:0
  ds_read_b32 v61, v18 offset:0
  ds_read_b32 v62, v19 offset:0
  ds_read_b32 v63, v20 offset:0
  ds_read_b32 v64, v21 offset:0
  ds_read_b32 v65, v22 offset:0
  ds_read_b32 v66, v23 offset:0
  ds_read_b32 v67, v24 offset:0
  ds_read_b32 v68, v25 offset:0
  ds_read_b32 v69, v26 offset:0
  ds_read_b32 v70, v27 offset:0
  s_waitcnt lgkmcnt(9)
  v_cvt_pk_bf16_f32 v72, v60, v61
  s_waitcnt lgkmcnt(8)
  v_cvt_pk_bf16_f32 v76, v61, v62
  s_waitcnt lgkmcnt(7)
  v_cvt_pk_bf16_f32 v80, v62, v63
  s_waitcnt lgkmcnt(6)
  v_cvt_pk_bf16_f32 v84, v63, v64
  v_cvt_pk_bf16_f32 v73, v62, v63
  v_cvt_pk_bf16_f32 v77, v63, v64
  s_waitcnt lgkmcnt(5)
  v_cvt_pk_bf16_f32 v81, v64, v65
  s_waitcnt lgkmcnt(4)
  v_cvt_pk_bf16_f32 v85, v65, v66
  v_cvt_pk_bf16_f32 v74, v64, v65
  v_cvt_pk_bf16_f32 v78, v65, v66
  s_waitcnt lgkmcnt(3)
  v_cvt_pk_bf16_f32 v82, v66, v67
  s_waitcnt lgkmcnt(2)
  v_cvt_pk_bf16_f32 v86, v67, v68
  v_cvt_pk_bf16_f32 v75, v66, v67
  v_cvt_pk_bf16_f32 v79, v67, v68
  s_waitcnt lgkmcnt(1)
  v_cvt_pk_bf16_f32 v83, v68, v69
  s_waitcnt lgkmcnt(0)
  v_cvt_pk_bf16_f32 v87, v69, v70
  ds_write_b128 v9, v[72:75] offset:12480
  ds_write_b128 v9, v[76:79] offset:8320
  ds_write_b128 v9, v[80:83] offset:4160
  ds_write_b128 v9, v[84:87] offset:0
L_ne11:
  s_waitcnt lgkmcnt(15)
  v_mfma_f32_16x16x32_bf16 v[32:35], a[0:3], a[36:39], 0
  ds_read_b64 a[64:65], v10 offset:20608
  ds_read_b64 a[66:67], v10 offset:20616
  v_mfma_f32_16x16x32_bf16 v[32:35], a[4:7], a[32:35], v[32:35]
  ds_read_b128 a[96:99], v11 offset:128
  v_mfma_f32_16x16x32_bf16 v[36:39], a[4:7], a[36:39], 0
  ds_read_b64 a[68:69], v10 offset:20096
  s_waitcnt lgkmcnt(15)
  v_mfma_f32_16x16x32_bf16 v[36:39], a[0:3], a[40:43], v[36:39]
  ds_read_b64 a[70:71], v10 offset:20104
  v_mfma_f32_16x16x32_bf16 v[36:39], a[8:11], a[32:35], v[36:39]
  ds_read_b128 a[100:103], v11 offset:640
  s_waitcnt lgkmcnt(15)
  v_mfma_f32_16x16x32_bf16 v[40:43], a[8:11], a[44:47], 0
  ds_read_b64 a[72:73], v10 offset:19584
  v_mfma_f32_16x16x32_bf16 v[40:43], a[12:15], a[40:43], v[40:43]
  ds_read_b64 a[74:75], v10 offset:19592
  ds_read_b128 a[104:107], v11 offset:1152
  v_mfma_f32_16x16x32_bf16 v[44:47], a[12:15], a[44:47], 0
  ds_read_b64 a[76:77], v10 offset:19072
  s_waitcnt lgkmcnt(15)
  v_mfma_f32_16x16x32_bf16 v[40:43], a[4:7], a[48:51], v[40:43]
  ds_read_b64 a[78:79], v10 offset:19080
  v_mfma_f32_16x16x32_bf16 v[40:43], a[16:19], a[36:39], v[40:43]
  ds_read_b128 a[108:111], v11 offset:1664
  v_mfma_f32_16x16x32_bf16 v[44:47], a[8:11], a[48:51], v[44:47]
  ds_read_b64 a[80:81], v10 offset:18560
  v_mfma_f32_16x16x32_bf16 v[44:47], a[16:19], a[40:43], v[44:47]
  ds_read_b64 a[82:83], v10 offset:18568
  s_waitcnt lgkmcnt(15)
  v_mfma_f32_16x16x32_bf16 v[40:43], a[0:3], a[52:55], v[40:43]
  ds_read_b128 a[112:115], v11 offset:2176
  ds_read_b64 a[84:85], v10 offset:18048
  v_mfma_f32_16x16x32_bf16 v[40:43], a[20:23], a[32:35], v[40:43]
  ds_read_b64 a[86:87], v10 offset:18056
  v_mfma_f32_16x16x32_bf16 v[44:47], a[4:7], a[52:55], v[44:47]
  ds_read_b128 a[116:119], v11 offset:2688
  v_mfma_f32_16x16x32_bf16 v[44:47], a[20:23], a[36:39], v[44:47]
  ds_read_b64 a[88:89], v10 offset:17536
  s_waitcnt lgkmcnt(15)
  v_mfma_f32_16x16x32_bf16 v[44:47], a[0:3], a[56:59], v[44:47]
  ds_read_b64 a[90:91], v10 offset:17544
  v_mfma_f32_16x16x32_bf16 v[44:47], a[24:27], a[32:35], v[44:47]
  ds_read_b128 a[120:123], v11 offset:3200
  s_waitcnt lgkmcnt(15)
  v_mfma_f32_16x16x32_bf16 v[32:35], a[64:67], a[100:103], v[32:35]
  ds_read_b64 a[0:1], v10 offset:20544
  ds_read_b64 a[2:3], v10 offset:20552
  v_mfma_f32_16x16x32_bf16 v[32:35], a[68:71], a[96:99], v[32:35]
  ds_read_b128 a[32:35], v11 offset:64
  v_mfma_f32_16x16x32_bf16 v[36:39], a[68:71], a[100:103], v[36:39]
  ds_read_b64 a[4:5], v10 offset:20032
  s_waitcnt lgkmcnt(15)
  v_mfma_f32_16x16x32_bf16 v[36:39], a[64:67], a[104:107], v[36:39]
  ds_read_b64 a[6:7], v10 offset:20040
  v_mfma_f32_16x16x32_bf16 v[36:39], a[72:75], a[96:99], v[36:39]
  ds_read_b128 a[36:39], v11 offset:576
  s_waitcnt lgkmcnt(15)
  v_mfma_f32_16x16x32_bf16 v[40:43], a[72:75], a[108:111], v[40:43]
  ds_read_b64 a[8:9], v10 offset:19520
  v_mfma_f32_16x16x32_bf16 v[40:43], a[76:79], a[104:107], v[40:43]
  ds_read_b64 a[10:11], v10 offset:19528
  ds_read_b128 a[40:43], v11 offset:1088
  v_mfma_f32_16x16x32_bf16 v[44:47], a[76:79], a[108:111], v[44:47]
  ds_read_b64 a[12:13], v10 offset:19008
  s_waitcnt lgkmcnt(15)
  v_mfma_f32_16x16x32_bf16 v[40:43], a[68:71], a[112:115], v[40:43]
  ds_read_b64 a[14:15], v10 offset:19016
  v_mfma_f32_16x16x32_bf16 v[40:43], a[80:83], a[100:103], v[40:43]
  ds_read_b128 a[44:47], v11 offset:1600
  v_mfma_f32_16x16x32_bf16 v[44:47], a[72:75], a[112:115], v[44:47]
  ds_read_b64 a[16:17], v10 offset:18496
  v_mfma_f32_16x16x32_bf16 v[44:47], a[80:83], a[104:107], v[44:47]
  ds_read_b64 a[18:19], v10 offset:18504
  s_waitcnt lgkmcnt(15)
  v_mfma_f32_16x16x32_bf16 v[40:43], a[64:67], a[116:119], v[40:43]
  ds_read_b128 a[48:51], v11 offset:2112
  ds_read_b64 a[20:21], v10 offset:17984
  v_mfma_f32_16x16x32_bf16 v[40:43], a[84:87], a[96:99], v[40:43]
  ds_read_b64 a[22:23], v10 offset:17992
  v_mfma_f32_16x16x32_bf16 v[44:47], a[68:71], a[116:119], v[44:47]
  ds_read_b128 a[52:55], v11 offset:2624
  v_mfma_f32_16x16x32_bf16 v[44:47], a[84:87], a[100:103], v[44:47]
  ds_read_b64 a[24:25], v10 offset:17472
  s_waitcnt lgkmcnt(15)
  v_mfma_f32_16x16x32_bf16 v[44:47], a[64:67], a[120:123], v[44:47]
  ds_read_b64 a[26:27], v10 offset:17480
  v_mfma_f32_16x16x32_bf16 v[44:47], a[88:91], a[96:99], v[44:47]
  ds_read_b128 a[56:59], v11 offset:3136
  s_waitcnt lgkmcnt(15)
  v_mfma_f32_16x16x32_bf16 v[32:35], a[0:3], a[36:39], v[32:35]
  ds_read_b64 a[64:65], v10 offset:20480
  ds_read_b64 a[66:67], v10 offset:20488
  v_mfma_f32_16x16x32_bf16 v[32:35], a[4:7], a[32:35], v[32:35]
  ds_read_b128 a[96:99], v11 offset:0
  v_mfma_f32_16x16x32_bf16 v[36:39], a[4:7], a[36:39], v[36:39]
  ds_read_b64 a[68:69], v10 offset:19968
  s_waitcnt lgkmcnt(15)
  v_mfma_f32_16x16x32_bf16 v[36:39], a[0:3], a[40:43], v[36:39]
  ds_read_b64 a[70:71], v10 offset:19976
  v_mfma_f32_16x16x32_bf16 v[36:39], a[8:11], a[32:35], v[36:39]
  ds_read_b128 a[100:103], v11 offset:512
  s_waitcnt lgkmcnt(15)
  v_mfma_f32_16x16x32_bf16 v[40:43], a[8:11], a[44:47], v[40:43]
  ds_read_b64 a[72:73], v10 offset:19456
  v_mfma_f32_16x16x32_bf16 v[40:43], a[12:15], a[40:43], v[40:43]
  ds_read_b64 a[74:75], v10 offset:19464
  ds_read_b128 a[104:107], v11 offset:1024
  v_mfma_f32_16x16x32_bf16 v[44:47], a[12:15], a[44:47], v[44:47]
  ds_read_b64 a[76:77], v10 offset:18944
  s_waitcnt lgkmcnt(15)
  v_mfma_f32_16x16x32_bf16 v[40:43], a[4:7], a[48:51], v[40:43]
  ds_read_b64 a[78:79], v10 offset:18952
  v_mfma_f32_16x16x32_bf16 v[40:43], a[16:19], a[36:39], v[40:43]
  ds_read_b128 a[108:111], v11 offset:1536
  v_mfma_f32_16x16x32_bf16 v[44:47], a[8:11], a[48:51], v[44:47]
  ds_read_b64 a[80:81], v10 offset:18432
  v_mfma_f32_16x16x32_bf16 v[44:47], a[16:19], a[40:43], v[44:47]
  ds_read_b64 a[82:83], v10 offset:18440
  s_waitcnt lgkmcnt(15)
  v_mfma_f32_16x16x32_bf16 v[40:43], a[0:3], a[52:55], v[40:43]
  ds_read_b128 a[112:115], v11 offset:2048
  ds_read_b64 a[84:85], v10 offset:17920
  v_mfma_f32_16x16x32_bf16 v[40:43], a[20:23], a[32:35], v[40:43]
  ds_read_b64 a[86:87], v10 offset:17928
  v_mfma_f32_16x16x32_bf16 v[44:47], a[4:7], a[52:55], v[44:47]
  ds_read_b128 a[116:119], v11 offset:2560
  v_mfma_f32_16x16x32_bf16 v[44:47], a[20:23], a[36:39], v[44:47]
  ds_read_b64 a[88:89], v10 offset:17408
  s_waitcnt lgkmcnt(15)
  v_mfma_f32_16x16x32_bf16 v[44:47], a[0:3], a[56:59], v[44:47]
  ds_read_b64 a[90:91], v10 offset:17416
  v_mfma_f32_16x16x32_bf16 v[44:47], a[24:27], a[32:35], v[44:47]
  ds_read_b128 a[120:123], v11 offset:3072
  s_waitcnt lgkmcnt(15)
  v_mfma_f32_16x16x32_bf16 v[32:35], a[64:67], a[100:103], v[32:35]
  v_mfma_f32_16x16x32_bf16 v[32:35], a[68:71], a[96:99], v[32:35]
  v_mfma_f32_16x16x32_bf16 v[36:39], a[68:71], a[100:103], v[36:39]
  s_waitcnt lgkmcnt(12)
  v_mfma_f32_16x16x32_bf16 v[36:39], a[64:67], a[104:107], v[36:39]
  v_mfma_f32_16x16x32_bf16 v[36:39], a[72:75], a[96:99], v[36:39]
  s_waitcnt lgkmcnt(9)
  v_mfma_f32_16x16x32_bf16 v[40:43], a[72:75], a[108:111], v[40:43]
  v_mfma_f32_16x16x32_bf16 v[40:43], a[76:79], a[104:107], v[40:43]
  v_mfma_f32_16x16x32_bf16 v[44:47], a[76:79], a[108:111], v[44:47]
  s_waitcnt lgkmcnt(6)
  v_mfma_f32_16x16x32_bf16 v[40:43], a[68:71], a[112:115], v[40:43]
  v_mfma_f32_16x16x32_bf16 v[40:43], a[80:83], a[100:103], v[40:43]
  v_mfma_f32_16x16x32_bf16 v[44:47], a[72:75], a[112:115], v[44:47]
  v_mfma_f32_16x16x32_bf16 v[44:47], a[80:83], a[104:107], v[44:47]
  s_waitcnt lgkmcnt(3)
  v_mfma_f32_16x16x32_bf16 v[40:43], a[64:67], a[116:119], v[40:43]
  v_mfma_f32_16x16x32_bf16 v[40:43], a[84:87], a[96:99], v[40:43]
  v_mfma_f32_16x16x32_bf16 v[44:47], a[68:71], a[116:119], v[44:47]
  v_mfma_f32_16x16x32_bf16 v[44:47], a[84:87], a[100:103], v[44:47]
  s_waitcnt lgkmcnt(0)
  v_mfma_f32_16x16x32_bf16 v[44:47], a[64:67], a[120:123], v[44:47]
  v_mfma_f32_16x16x32_bf16 v[44:47], a[88:91], a[96:99], v[44:47]
  s_cmp_eq_u32 s59, 0
  s_cbranch_scc1 L_x011
  ds_write_b128 v14, v[32:35] offset:8192
  ds_write_b128 v14, v[36:39] offset:9216
  ds_write_b128 v14, v[40:43] offset:10240
  s_nop 2
  ds_write_b128 v14, v[44:47] offset:11264
L_x011:
  v_add_u32 v11, 4608, v11
  s_add_u32 s38, s38, 1
  s_waitcnt lgkmcnt(0)
  s_barrier
  s_branch L_cloop1
L_cend1:
  s_cmp_eq_u32 s59, 0
  s_cbranch_scc1 L_f01e
  s_cmp_ge_u32 s38, 8
  s_cbranch_scc1 L_fe1e
  s_waitcnt vmcnt(0)
  v_perm_b32 v90, v89, v88, s57
  ds_write_b32 v5, v90
  v_add_u32 v5, 512, v5
  s_add_u32 s65, s65, 294912
  buffer_load_ushort v88, v6, s[8:11], s65 offen
  buffer_load_ushort v89, v6, s[8:11], s65 offen offset:1152
  s_branch L_fe1e
L_f01e:
  s_cmp_eq_u32 s38, 0
  s_cbranch_scc1 L_fe1e
  ds_read_b128 v[48:51], v14 offset:0
  ds_read_b128 v[52:55], v14 offset:1024
  ds_read_b128 v[56:59], v14 offset:2048
  ds_read_b128 v[60:63], v14 offset:3072
  s_waitcnt lgkmcnt(3)
  v_add_f32 v32, v32, v48
  v_add_f32 v33, v33, v49
  v_add_f32 v34, v34, v50
  v_add_f32 v35, v35, v51
  v_cvt_pk_bf16_f32 v48, v32, v33
  v_cvt_pk_bf16_f32 v49, v34, v35
  s_waitcnt lgkmcnt(2)
  v_add_f32 v36, v36, v52
  v_add_f32 v37, v37, v53
  v_add_f32 v38, v38, v54
  v_add_f32 v39, v39, v55
  v_cvt_pk_bf16_f32 v50, v36, v37
  v_cvt_pk_bf16_f32 v51, v38, v39
  s_waitcnt lgkmcnt(1)
  v_add_f32 v40, v40, v56
  v_add_f32 v41, v41, v57
  v_add_f32 v42, v42, v58
  v_add_f32 v43, v43, v59
  v_cvt_pk_bf16_f32 v52, v40, v41
  v_cvt_pk_bf16_f32 v53, v42, v43
  s_waitcnt lgkmcnt(0)
  v_add_f32 v44, v44, v60
  v_add_f32 v45, v45, v61
  v_add_f32 v46, v46, v62
  v_add_f32 v47, v47, v63
  v_cvt_pk_bf16_f32 v54, v44, v45
  v_cvt_pk_bf16_f32 v55, v46, v47
  v_permlane16_swap_b32 v48, v50
  v_permlane16_swap_b32 v49, v51
  buffer_store_dwordx4 v[48:51], v12, s[20:23], s63 offen offset:512 sc1
  v_permlane16_swap_b32 v52, v54
  v_permlane16_swap_b32 v53, v55
  buffer_store_dwordx4 v[52:55], v12, s[20:23], s63 offen offset:2560 sc1
  s_add_u32 s63, s63, 4096
  s_cmp_lg_u32 s38, 8
  s_cbranch_scc1 L_fe1e
  s_lshl_b32 s63, s36, 12
  s_add_u32 s63, s63, 35651584
L_fe1e:
  s_branch L_abr_end
L_abr_end:
L_fin:
L_main_end:
  s_endpgm
.p2align 4
.type L_ktab,@object
L_ktab:
.long 0xafc0afc, 0xafc0afc, 0xaf80af8, 0xaf80af8, 0xaf80af8, 0x80af8
.long 0xaf80af8, 0xaf40af8, 0xaf40af4, 0xaf40af4, 0xaf40af4, 0x1080af4
.long 0xaf40af4, 0xaf40af4, 0xaf00af0, 0xaf00af0, 0xaf00af0, 0x2080af0
.long 0xaf00af0, 0xaec0af0, 0xaec0aec, 0xaec0aec, 0xaec0aec, 0x3080aec
.long 0xaec0aec, 0xaec0aec, 0xae80ae8, 0xae80ae8, 0xae80ae8, 0x10ae8
.long 0xae80ae8, 0xae40ae8, 0xae40ae4, 0xae40ae4, 0xae40ae4, 0x20ae4
.long 0xae40ae4, 0xae40ae4, 0xae00ae0, 0xae00ae0, 0xae00ae0, 0x30ae0
.long 0xae00ae0, 0xadc0ae0, 0xadc0adc, 0xadc0adc, 0xadc0adc, 0x40adc
.long 0xadc0adc, 0xadc0adc, 0xad80ad8, 0xad80ad8, 0xad80ad8, 0x50ad8
.long 0xad80ad8, 0xad40ad8, 0xad40ad4, 0xad40ad4, 0xad40ad4, 0x60ad4
.long 0xad40ad4, 0xad40ad4, 0xad00ad0, 0xad00ad0, 0xad00ad0, 0x70ad0
.long 0xad00ad0, 0xacc0ad0, 0xacc0acc, 0xacc0acc, 0xacc0acc, 0x1020acc
.long 0xacc0acc, 0xacc0acc, 0xac80ac8, 0xac80ac8, 0xac80ac8, 0x1040ac8
.long 0xac80ac8, 0xac40ac8, 0xac40ac4, 0xac40ac4, 0xac40ac4, 0x1060ac4
.long 0xac40ac4, 0xac40ac4, 0xac00ac0, 0xac00ac0, 0xac00ac0, 0x2040ac0
.long 0xac00ac0, 0x8fc0ac0, 0x8fc08fc, 0x8fc08fc, 0x8fc08fc, 0x30408fc
.long 0x8fc08fc, 0x8fc08fc, 0x8f808f8, 0x8f808f8, 0x8f808f8, 0x808f8
.long 0x8f808f8, 0x8f408f8, 0x8f408f4, 0x8f408f4, 0x8f408f4, 0x10808f4
.long 0x8f408f4, 0x8f408f4, 0x8f008f0, 0x8f008f0, 0x8f008f0, 0x20808f0
.long 0x8f008f0, 0x8ec08f0, 0x8ec08ec, 0x8ec08ec, 0x8ec08ec, 0x30808ec
.long 0x8ec08ec, 0x8ec08ec, 0x8e808e8, 0x8e808e8, 0x8e808e8, 0x108e8
.long 0x8e808e8, 0x8e408e8, 0x8e408e4, 0x8e408e4, 0x8e408e4, 0x208e4
.long 0x8e408e4, 0x8e408e4, 0x8e008e0, 0x8e008e0, 0x8e008e0, 0x308e0
.long 0x8e008e0, 0x8dc08e0, 0x8dc08dc, 0x8dc08dc, 0x8dc08dc, 0x408dc
.long 0x8dc08dc, 0x8dc08dc, 0x8d808d8, 0x8d808d8, 0x8d808d8, 0x508d8
.long 0x8d808d8, 0x8d408d8, 0x8d408d4, 0x8d408d4, 0x8d408d4, 0x608d4
.long 0x8d408d4, 0x8d408d4, 0x8d008d0, 0x8d008d0, 0x8d008d0, 0x708d0
.long 0x8d008d0, 0x8cc08d0, 0x8cc08cc, 0x8cc08cc, 0x8cc08cc, 0x10208cc
.long 0x8cc08cc, 0x8cc08cc, 0x8c808c8, 0x8c808c8, 0x8c808c8, 0x10408c8
.long 0x8c808c8, 0x8c408c8, 0x8c408c4, 0x8c408c4, 0x8c408c4, 0x10608c4
.long 0x8c408c4, 0x8c408c4, 0x8c008c0, 0x8c008c0, 0x8c008c0, 0x20408c0
.long 0x8c008c0, 0xabc08c0, 0xabc0abc, 0xabc0abc, 0xabc0abc, 0x3040abc
.long 0xabc0abc, 0xabc0abc, 0xab80ab8, 0xab80ab8, 0xab80ab8, 0x80ab8
.long 0xab80ab8, 0xab40ab8, 0xab40ab4, 0xab40ab4, 0xab40ab4, 0x1080ab4
.long 0xab40ab4, 0xab40ab4, 0xab00ab0, 0xab00ab0, 0xab00ab0, 0x2080ab0
.long 0xab00ab0, 0xaac0ab0, 0xaac0aac, 0xaac0aac, 0xaac0aac, 0x3080aac
.long 0xaac0aac, 0xaac0aac, 0xaa80aa8, 0xaa80aa8, 0xaa80aa8, 0x10aa8
.long 0xaa80aa8, 0xaa40aa8, 0xaa40aa4, 0xaa40aa4, 0xaa40aa4, 0x20aa4
.long 0xaa40aa4, 0xaa40aa4, 0xaa00aa0, 0xaa00aa0, 0xaa00aa0, 0x30aa0
.long 0xaa00aa0, 0xa9c0aa0, 0xa9c0a9c, 0xa9c0a9c, 0xa9c0a9c, 0x40a9c
.long 0xa9c0a9c, 0xa9c0a9c, 0xa980a98, 0xa980a98, 0xa980a98, 0x50a98
.long 0xa980a98, 0xa940a98, 0xa940a94, 0xa940a94, 0xa940a94, 0x60a94
.long 0xa940a94, 0xa940a94, 0xa900a90, 0xa900a90, 0xa900a90, 0x70a90
.long 0xa900a90, 0xa8c0a90, 0xa8c0a8c, 0xa8c0a8c, 0xa8c0a8c, 0x1020a8c
.long 0xa8c0a8c, 0xa8c0a8c, 0xa880a88, 0xa880a88, 0xa880a88, 0x1040a88
.long 0xa880a88, 0xa840a88, 0xa840a84, 0xa840a84, 0xa840a84, 0x1060a84
.long 0xa840a84, 0xa840a84, 0xa800a80, 0xa800a80, 0xa800a80, 0x2040a80
.long 0xa800a80, 0x8bc0a80, 0x8bc08bc, 0x8bc08bc, 0x8bc08bc, 0x30408bc
.long 0x8bc08bc, 0x8bc08bc, 0x8b808b8, 0x8b808b8, 0x8b808b8, 0x808b8
.long 0x8b808b8, 0x8b408b8, 0x8b408b4, 0x8b408b4, 0x8b408b4, 0x10808b4
.long 0x8b408b4, 0x8b408b4, 0x8b008b0, 0x8b008b0, 0x8b008b0, 0x20808b0
.long 0x8b008b0, 0x8ac08b0, 0x8ac08ac, 0x8ac08ac, 0x8ac08ac, 0x30808ac
.long 0x8ac08ac, 0x8ac08ac, 0x8a808a8, 0x8a808a8, 0x8a808a8, 0x108a8
.long 0x8a808a8, 0x8a408a8, 0x8a408a4, 0x8a408a4, 0x8a408a4, 0x208a4
.long 0x8a408a4, 0x8a408a4, 0x8a008a0, 0x8a008a0, 0x8a008a0, 0x308a0
.long 0x8a008a0, 0x89c08a0, 0x89c089c, 0x89c089c, 0x89c089c, 0x4089c
.long 0x89c089c, 0x89c089c, 0x8980898, 0x8980898, 0x8980898, 0x50898
.long 0x8980898, 0x8940898, 0x8940894, 0x8940894, 0x8940894, 0x60894
.long 0x8940894, 0x8940894, 0x8900890, 0x8900890, 0x8900890, 0x70890
.long 0x8900890, 0x88c0890, 0x88c088c, 0x88c088c, 0x88c088c, 0x102088c
.long 0x88c088c, 0x88c088c, 0x8880888, 0x8880888, 0x8880888, 0x1040888
.long 0x8880888, 0x8840888, 0x8840884, 0x8840884, 0x8840884, 0x1060884
.long 0x8840884, 0x8840884, 0x8800880, 0x8800880, 0x8800880, 0x2040880
.long 0x8800880, 0xa7c0880, 0xa7c0a7c, 0xa7c0a7c, 0xa7c0a7c, 0x3040a7c
.long 0xa7c0a7c, 0xa7c0a7c, 0xa780a78, 0xa780a78, 0xa780a78, 0x80a78
.long 0xa780a78, 0xa740a78, 0xa740a74, 0xa740a74, 0xa740a74, 0x1080a74
.long 0xa740a74, 0xa740a74, 0xa700a70, 0xa700a70, 0xa700a70, 0x2080a70
.long 0xa700a70, 0xa6c0a70, 0xa6c0a6c, 0xa6c0a6c, 0xa6c0a6c, 0x3080a6c
.long 0xa6c0a6c, 0xa6c0a6c, 0xa680a68, 0xa680a68, 0xa680a68, 0x10a68
.long 0xa680a68, 0xa640a68, 0xa640a64, 0xa640a64, 0xa640a64, 0x20a64
.long 0xa640a64, 0xa640a64, 0xa600a60, 0xa600a60, 0xa600a60, 0x30a60
.long 0xa600a60, 0xa5c0a60, 0xa5c0a5c, 0xa5c0a5c, 0xa5c0a5c, 0x40a5c
.long 0xa5c0a5c, 0xa5c0a5c, 0xa580a58, 0xa580a58, 0xa580a58, 0x50a58
.long 0xa580a58, 0xa540a58, 0xa540a54, 0xa540a54, 0xa540a54, 0x60a54
.long 0xa540a54, 0xa540a54, 0xa500a50, 0xa500a50, 0xa500a50, 0x70a50
.long 0xa500a50, 0xa4c0a50, 0xa4c0a4c, 0xa4c0a4c, 0xa4c0a4c, 0x1020a4c
.long 0xa4c0a4c, 0xa4c0a4c, 0xa480a48, 0xa480a48, 0xa480a48, 0x1040a48
.long 0xa480a48, 0xa440a48, 0xa440a44, 0xa440a44, 0xa440a44, 0x1060a44
.long 0xa440a44, 0xa440a44, 0xa400a40, 0xa400a40, 0xa400a40, 0x2040a40
.long 0xa400a40, 0x87c0a40, 0x87c087c, 0x87c087c, 0x87c087c, 0x304087c
.long 0x87c087c, 0x87c087c, 0x8780878, 0x8780878, 0x8780878, 0x80878
.long 0x8780878, 0x8740878, 0x8740874, 0x8740874, 0x8740874, 0x1080874
.long 0x8740874, 0x8740874, 0x8700870, 0x8700870, 0x8700870, 0x2080870
.long 0x8700870, 0x86c0870, 0x86c086c, 0x86c086c, 0x86c086c, 0x308086c
.long 0x86c086c, 0x86c086c, 0x8680868, 0x8680868, 0x8680868, 0x10868
.long 0x8680868, 0x8640868, 0x8640864, 0x8640864, 0x8640864, 0x20864
.long 0x8640864, 0x8640864, 0x8600860, 0x8600860, 0x8600860, 0x30860
.long 0x8600860, 0x85c0860, 0x85c085c, 0x85c085c, 0x85c085c, 0x4085c
.long 0x85c085c, 0x85c085c, 0x8580858, 0x8580858, 0x8580858, 0x50858
.long 0x8580858, 0x8540858, 0x8540854, 0x8540854, 0x8540854, 0x60854
.long 0x8540854, 0x8540854, 0x8500850, 0x8500850, 0x8500850, 0x70850
.long 0x8500850, 0x84c0850, 0x84c084c, 0x84c084c, 0x84c084c, 0x102084c
.long 0x84c084c, 0x84c084c, 0x8480848, 0x8480848, 0x8480848, 0x1040848
.long 0x8480848, 0x8440848, 0x8440844, 0x8440844, 0x8440844, 0x1060844
.long 0x8440844, 0x8440844, 0x8400840, 0x8400840, 0x8400840, 0x2040840
.long 0x8400840, 0xa3c0840, 0xa3c0a3c, 0xa3c0a3c, 0xa3c0a3c, 0x3040a3c
.long 0xa3c0a3c, 0xa3c0a3c, 0xa380a38, 0xa380a38, 0xa380a38, 0x80a38
.long 0xa380a38, 0xa340a38, 0xa340a34, 0xa340a34, 0xa340a34, 0x1080a34
.long 0xa340a34, 0xa340a34, 0xa300a30, 0xa300a30, 0xa300a30, 0x2080a30
.long 0xa300a30, 0xa2c0a30, 0xa2c0a2c, 0xa2c0a2c, 0xa2c0a2c, 0x3080a2c
.long 0xa2c0a2c, 0xa2c0a2c, 0xa280a28, 0xa280a28, 0xa280a28, 0x10a28
.long 0xa280a28, 0xa240a28, 0xa240a24, 0xa240a24, 0xa240a24, 0x20a24
.long 0xa240a24, 0xa240a24, 0xa200a20, 0xa200a20, 0xa200a20, 0x30a20
.long 0xa200a20, 0xa1c0a20, 0xa1c0a1c, 0xa1c0a1c, 0xa1c0a1c, 0x40a1c
.long 0xa1c0a1c, 0xa1c0a1c, 0xa180a18, 0xa180a18, 0xa180a18, 0x50a18
.long 0xa180a18, 0xa140a18, 0xa140a14, 0xa140a14, 0xa140a14, 0x60a14
.long 0xa140a14, 0xa140a14, 0xa100a10, 0xa100a10, 0xa100a10, 0x70a10
.long 0xa100a10, 0xa0c0a10, 0xa0c0a0c, 0xa0c0a0c, 0xa0c0a0c, 0x1020a0c
.long 0xa0c0a0c, 0xa0c0a0c, 0xa080a08, 0xa080a08, 0xa080a08, 0x1040a08
.long 0xa080a08, 0xa040a08, 0xa040a04, 0xa040a04, 0xa040a04, 0x1060a04
.long 0xa040a04, 0xa040a04, 0xa000a00, 0xa000a00, 0xa000a00, 0x2040a00
.long 0xa000a00, 0x83c0a00, 0x83c083c, 0x83c083c, 0x83c083c, 0x304083c
.long 0x83c083c, 0x83c083c, 0x8380838, 0x8380838, 0x8380838, 0x80838
.long 0x8380838, 0x8340838, 0x8340834, 0x8340834, 0x8340834, 0x1080834
.long 0x8340834, 0x8340834, 0x8300830, 0x8300830, 0x8300830, 0x2080830
.long 0x8300830, 0x82c0830, 0x82c082c, 0x82c082c, 0x82c082c, 0x308082c
.long 0x82c082c, 0x82c082c, 0x8280828, 0x8280828, 0x8280828, 0x10828
.long 0x8280828, 0x8240828, 0x8240824, 0x8240824, 0x8240824, 0x20824
.long 0x8240824, 0x8240824, 0x8200820, 0x8200820, 0x8200820, 0x30820
.long 0x8200820, 0x81c0820, 0x81c081c, 0x81c081c, 0x81c081c, 0x4081c
.long 0x81c081c, 0x81c081c, 0x8180818, 0x8180818, 0x8180818, 0x50818
.long 0x8180818, 0x8140818, 0x8140814, 0x8140814, 0x8140814, 0x60814
.long 0x8140814, 0x8140814, 0x8100810, 0x8100810, 0x8100810, 0x70810
.long 0x8100810, 0x80c0810, 0x80c080c, 0x80c080c, 0x80c080c, 0x102080c
.long 0x80c080c, 0x80c080c, 0x8080808, 0x8080808, 0x8080808, 0x1040808
.long 0x8080808, 0x8040808, 0x8040804, 0x8040804, 0x8040804, 0x1060804
.long 0x8040804, 0x8040804, 0x8000800, 0x8000800, 0x8000800, 0x2040800
.long 0x8000800, 0x4fc0800, 0x4fc04fc, 0x4fc04fc, 0x4fc04fc, 0x30407fc
.long 0x4fc04fc, 0x7fc07fc, 0x4f807fc, 0x4f804f8, 0x4f804f8, 0x807f8
.long 0x4f804f8, 0x7f807f8, 0x4f407f8, 0x4f404f4, 0x4f404f4, 0x10807f4
.long 0x4f404f4, 0x7f407f4, 0x4f007f4, 0x4f004f0, 0x4f004f0, 0x20807f0
.long 0x4f004f0, 0x7f007f0, 0x4ec07f0, 0x4ec04ec, 0x4ec04ec, 0x30807ec
.long 0x4ec04ec, 0x7ec07ec, 0x4e807ec, 0x4e804e8, 0x4e804e8, 0x107e8
.long 0x4e804e8, 0x7e807e8, 0x4e407e8, 0x4e404e4, 0x4e404e4, 0x207e4
.long 0x4e404e4, 0x7e407e4, 0x4e007e4, 0x4e004e0, 0x4e004e0, 0x307e0
.long 0x4e004e0, 0x7e007e0, 0x4dc07e0, 0x4dc04dc, 0x4dc04dc, 0x407dc
.long 0x4dc04dc, 0x7dc07dc, 0x4d807dc, 0x4d804d8, 0x4d804d8, 0x507d8
.long 0x4d804d8, 0x7d807d8, 0x4d407d8, 0x4d404d4, 0x4d404d4, 0x607d4
.long 0x4d404d4, 0x7d407d4, 0x4d007d4, 0x4d004d0, 0x4d004d0, 0x707d0
.long 0x4d004d0, 0x7d007d0, 0x4cc07d0, 0x4cc04cc, 0x4cc04cc, 0x10207cc
.long 0x4cc04cc, 0x7cc07cc, 0x4c807cc, 0x4c804c8, 0x4c804c8, 0x10407c8
.long 0x4c804c8, 0x7c807c8, 0x4c407c8, 0x4c404c4, 0x4c404c4, 0x10607c4
.long 0x4c404c4, 0x7c407c4, 0x4c007c4, 0x4c004c0, 0x4c004c0, 0x20407c0
.long 0x4c004c0, 0x7c007c0, 0xfc07c0, 0xfc00fc, 0xfc00fc, 0x30403fc
.long 0xfc00fc, 0x3fc03fc, 0xf803fc, 0xf800f8, 0xf800f8, 0x803f8
.long 0xf800f8, 0x3f803f8, 0xf403f8, 0xf400f4, 0xf400f4, 0x10803f4
.long 0xf400f4, 0x3f403f4, 0xf003f4, 0xf000f0, 0xf000f0, 0x20803f0
.long 0xf000f0, 0x3f003f0, 0xec03f0, 0xec00ec, 0xec00ec, 0x30803ec
.long 0xec00ec, 0x3ec03ec, 0xe803ec, 0xe800e8, 0xe800e8, 0x103e8
.long 0xe800e8, 0x3e803e8, 0xe403e8, 0xe400e4, 0xe400e4, 0x203e4
.long 0xe400e4, 0x3e403e4, 0xe003e4, 0xe000e0, 0xe000e0, 0x303e0
.long 0xe000e0, 0x3e003e0, 0xdc03e0, 0xdc00dc, 0xdc00dc, 0x403dc
.long 0xdc00dc, 0x3dc03dc, 0xd803dc, 0xd800d8, 0xd800d8, 0x503d8
.long 0xd800d8, 0x3d803d8, 0xd403d8, 0xd400d4, 0xd400d4, 0x603d4
.long 0xd400d4, 0x3d403d4, 0xd003d4, 0xd000d0, 0xd000d0, 0x703d0
.long 0xd000d0, 0x3d003d0, 0xcc03d0, 0xcc00cc, 0xcc00cc, 0x10203cc
.long 0xcc00cc, 0x3cc03cc, 0xc803cc, 0xc800c8, 0xc800c8, 0x10403c8
.long 0xc800c8, 0x3c803c8, 0xc403c8, 0xc400c4, 0xc400c4, 0x10603c4
.long 0xc400c4, 0x3c403c4, 0xc003c4, 0xc000c0, 0xc000c0, 0x20403c0
.long 0xc000c0, 0x3c003c0, 0x4bc03c0, 0x4bc04bc, 0x4bc04bc, 0x30407bc
.long 0x4bc04bc, 0x7bc07bc, 0x4b807bc, 0x4b804b8, 0x4b804b8, 0x807b8
.long 0x4b804b8, 0x7b807b8, 0x4b407b8, 0x4b404b4, 0x4b404b4, 0x10807b4
.long 0x4b404b4, 0x7b407b4, 0x4b007b4, 0x4b004b0, 0x4b004b0, 0x20807b0
.long 0x4b004b0, 0x7b007b0, 0x4ac07b0, 0x4ac04ac, 0x4ac04ac, 0x30807ac
.long 0x4ac04ac, 0x7ac07ac, 0x4a807ac, 0x4a804a8, 0x4a804a8, 0x107a8
.long 0x4a804a8, 0x7a807a8, 0x4a407a8, 0x4a404a4, 0x4a404a4, 0x207a4
.long 0x4a404a4, 0x7a407a4, 0x4a007a4, 0x4a004a0, 0x4a004a0, 0x307a0
.long 0x4a004a0, 0x7a007a0, 0x49c07a0, 0x49c049c, 0x49c049c, 0x4079c
.long 0x49c049c, 0x79c079c, 0x498079c, 0x4980498, 0x4980498, 0x50798
.long 0x4980498, 0x7980798, 0x4940798, 0x4940494, 0x4940494, 0x60794
.long 0x4940494, 0x7940794, 0x4900794, 0x4900490, 0x4900490, 0x70790
.long 0x4900490, 0x7900790, 0x48c0790, 0x48c048c, 0x48c048c, 0x102078c
.long 0x48c048c, 0x78c078c, 0x488078c, 0x4880488, 0x4880488, 0x1040788
.long 0x4880488, 0x7880788, 0x4840788, 0x4840484, 0x4840484, 0x1060784
.long 0x4840484, 0x7840784, 0x4800784, 0x4800480, 0x4800480, 0x2040780
.long 0x4800480, 0x7800780, 0xbc0780, 0xbc00bc, 0xbc00bc, 0x30403bc
.long 0xbc00bc, 0x3bc03bc, 0xb803bc, 0xb800b8, 0xb800b8, 0x803b8
.long 0xb800b8, 0x3b803b8, 0xb403b8, 0xb400b4, 0xb400b4, 0x10803b4
.long 0xb400b4, 0x3b403b4, 0xb003b4, 0xb000b0, 0xb000b0, 0x20803b0
.long 0xb000b0, 0x3b003b0, 0xac03b0, 0xac00ac, 0xac00ac, 0x30803ac
.long 0xac00ac, 0x3ac03ac, 0xa803ac, 0xa800a8, 0xa800a8, 0x103a8
.long 0xa800a8, 0x3a803a8, 0xa403a8, 0xa400a4, 0xa400a4, 0x203a4
.long 0xa400a4, 0x3a403a4, 0xa003a4, 0xa000a0, 0xa000a0, 0x303a0
.long 0xa000a0, 0x3a003a0, 0x9c03a0, 0x9c009c, 0x9c009c, 0x4039c
.long 0x9c009c, 0x39c039c, 0x98039c, 0x980098, 0x980098, 0x50398
.long 0x980098, 0x3980398, 0x940398, 0x940094, 0x940094, 0x60394
.long 0x940094, 0x3940394, 0x900394, 0x900090, 0x900090, 0x70390
.long 0x900090, 0x3900390, 0x8c0390, 0x8c008c, 0x8c008c, 0x102038c
.long 0x8c008c, 0x38c038c, 0x88038c, 0x880088, 0x880088, 0x1040388
.long 0x880088, 0x3880388, 0x840388, 0x840084, 0x840084, 0x1060384
.long 0x840084, 0x3840384, 0x800384, 0x800080, 0x800080, 0x2040380
.long 0x800080, 0x3800380, 0x47c0380, 0x47c047c, 0x77c047c, 0x304073c
.long 0x77c047c, 0x73c073c, 0x6fc073c, 0x4780478, 0x7780478, 0x80738
.long 0x7780478, 0x7380738, 0x6f80738, 0x4740474, 0x7740474, 0x1080734
.long 0x7740474, 0x7340734, 0x6f40734, 0x4700470, 0x7700470, 0x2080730
.long 0x7700470, 0x7300730, 0x6f00730, 0x46c046c, 0x76c046c, 0x308072c
.long 0x76c046c, 0x72c072c, 0x6ec072c, 0x4680468, 0x7680468, 0x10728
.long 0x7680468, 0x7280728, 0x6e80728, 0x4640464, 0x7640464, 0x20724
.long 0x7640464, 0x7240724, 0x6e40724, 0x4600460, 0x7600460, 0x30720
.long 0x7600460, 0x7200720, 0x6e00720, 0x45c045c, 0x75c045c, 0x4071c
.long 0x75c045c, 0x71c071c, 0x6dc071c, 0x4580458, 0x7580458, 0x50718
.long 0x7580458, 0x7180718, 0x6d80718, 0x4540454, 0x7540454, 0x60714
.long 0x7540454, 0x7140714, 0x6d40714, 0x4500450, 0x7500450, 0x70710
.long 0x7500450, 0x7100710, 0x6d00710, 0x44c044c, 0x74c044c, 0x102070c
.long 0x74c044c, 0x70c070c, 0x6cc070c, 0x4480448, 0x7480448, 0x1040708
.long 0x7480448, 0x7080708, 0x6c80708, 0x4440444, 0x7440444, 0x1060704
.long 0x7440444, 0x7040704, 0x6c40704, 0x4400440, 0x7400440, 0x2040700
.long 0x7400440, 0x7000700, 0x6c00700, 0x7c007c, 0x37c007c, 0x304033c
.long 0x37c007c, 0x33c033c, 0x2fc033c, 0x780078, 0x3780078, 0x80338
.long 0x3780078, 0x3380338, 0x2f80338, 0x740074, 0x3740074, 0x1080334
.long 0x3740074, 0x3340334, 0x2f40334, 0x700070, 0x3700070, 0x2080330
.long 0x3700070, 0x3300330, 0x2f00330, 0x6c006c, 0x36c006c, 0x308032c
.long 0x36c006c, 0x32c032c, 0x2ec032c, 0x680068, 0x3680068, 0x10328
.long 0x3680068, 0x3280328, 0x2e80328, 0x640064, 0x3640064, 0x20324
.long 0x3640064, 0x3240324, 0x2e40324, 0x600060, 0x3600060, 0x30320
.long 0x3600060, 0x3200320, 0x2e00320, 0x5c005c, 0x35c005c, 0x4031c
.long 0x35c005c, 0x31c031c, 0x2dc031c, 0x580058, 0x3580058, 0x50318
.long 0x3580058, 0x3180318, 0x2d80318, 0x540054, 0x3540054, 0x60314
.long 0x3540054, 0x3140314, 0x2d40314, 0x500050, 0x3500050, 0x70310
.long 0x3500050, 0x3100310, 0x2d00310, 0x4c004c, 0x34c004c, 0x102030c
.long 0x34c004c, 0x30c030c, 0x2cc030c, 0x480048, 0x3480048, 0x1040308
.long 0x3480048, 0x3080308, 0x2c80308, 0x440044, 0x3440044, 0x1060304
.long 0x3440044, 0x3040304, 0x2c40304, 0x400040, 0x3400040, 0x2040300
.long 0x3400040, 0x3000300, 0x2c00300, 0x43c043c, 0x67c06bc, 0x304063c
.long 0x67c06bc, 0x5fc063c, 0x57c05bc, 0x438053c, 0x67806b8, 0x80638
.long 0x67806b8, 0x5f80638, 0x57805b8, 0x4340538, 0x67406b4, 0x1080634
.long 0x67406b4, 0x5f40634, 0x57405b4, 0x4300534, 0x67006b0, 0x2080630
.long 0x67006b0, 0x5f00630, 0x57005b0, 0x42c0530, 0x66c06ac, 0x308062c
.long 0x66c06ac, 0x5ec062c, 0x56c05ac, 0x428052c, 0x66806a8, 0x10628
.long 0x66806a8, 0x5e80628, 0x56805a8, 0x4240528, 0x66406a4, 0x20624
.long 0x66406a4, 0x5e40624, 0x56405a4, 0x4200524, 0x66006a0, 0x30620
.long 0x66006a0, 0x5e00620, 0x56005a0, 0x41c0520, 0x65c069c, 0x4061c
.long 0x65c069c, 0x5dc061c, 0x55c059c, 0x418051c, 0x6580698, 0x50618
.long 0x6580698, 0x5d80618, 0x5580598, 0x4140518, 0x6540694, 0x60614
.long 0x6540694, 0x5d40614, 0x5540594, 0x4100514, 0x6500690, 0x70610
.long 0x6500690, 0x5d00610, 0x5500590, 0x40c0510, 0x64c068c, 0x102060c
.long 0x64c068c, 0x5cc060c, 0x54c058c, 0x408050c, 0x6480688, 0x1040608
.long 0x6480688, 0x5c80608, 0x5480588, 0x4040508, 0x6440684, 0x1060604
.long 0x6440684, 0x5c40604, 0x5440584, 0x4000504, 0x6400680, 0x2040600
.long 0x6400680, 0x5c00600, 0x5400580, 0x3c0500, 0x27c02bc, 0x304023c
.long 0x27c02bc, 0x1fc023c, 0x17c01bc, 0x38013c, 0x27802b8, 0x80238
.long 0x27802b8, 0x1f80238, 0x17801b8, 0x340138, 0x27402b4, 0x1080234
.long 0x27402b4, 0x1f40234, 0x17401b4, 0x300134, 0x27002b0, 0x2080230
.long 0x27002b0, 0x1f00230, 0x17001b0, 0x2c0130, 0x26c02ac, 0x308022c
.long 0x26c02ac, 0x1ec022c, 0x16c01ac, 0x28012c, 0x26802a8, 0x10228
.long 0x26802a8, 0x1e80228, 0x16801a8, 0x240128, 0x26402a4, 0x20224
.long 0x26402a4, 0x1e40224, 0x16401a4, 0x200124, 0x26002a0, 0x30220
.long 0x26002a0, 0x1e00220, 0x16001a0, 0x1c0120, 0x25c029c, 0x4021c
.long 0x25c029c, 0x1dc021c, 0x15c019c, 0x18011c, 0x2580298, 0x50218
.long 0x2580298, 0x1d80218, 0x1580198, 0x140118, 0x2540294, 0x60214
.long 0x2540294, 0x1d40214, 0x1540194, 0x100114, 0x2500290, 0x70210
.long 0x2500290, 0x1d00210, 0x1500190, 0xc0110, 0x24c028c, 0x102020c
.long 0x24c028c, 0x1cc020c, 0x14c018c, 0x8010c, 0x2480288, 0x1040208
.long 0x2480288, 0x1c80208, 0x1480188, 0x40108, 0x2440284, 0x1060204
.long 0x2440284, 0x1c40204, 0x1440184, 0x104, 0x2400280, 0x2040200
.long 0x2400280, 0x1c00200, 0x1400180, 0x9000100, 0xc000c00, 0x3040c00
.globl red_kernel
.p2align 8
.type red_kernel,@function
red_kernel:
  s_cmp_ge_u32 s2, 256
  s_cbranch_scc1 L_red_end
  s_load_dwordx2 s[4:5], s[0:1], 96
  s_load_dwordx2 s[6:7], s[0:1], 112
  v_lshrrev_b32 v3, 6, v0
  v_and_b32 v1, 63, v0
  s_and_b32 s17, s2, 31
  s_lshr_b32 s18, s2, 5
  s_and_b32 s19, s18, 1
  s_lshr_b32 s18, s18, 1
  v_readfirstlane_b32 s20, v3
  s_lshl_b32 s17, s17, 1
  s_add_u32 s17, s17, s19
  v_lshrrev_b32 v4, 4, v1
  v_bfe_u32 v5, v1, 3, 1
  v_and_b32 v6, 7, v1
  s_lshl_b32 s18, s18, 3
  v_add_u32 v6, s18, v6
  v_lshlrev_b32 v2, 10, v4
  v_lshl_add_u32 v2, v5, 9, v2
  v_lshl_add_u32 v2, v6, 4, v2
  s_mul_i32 s21, s17, 36864
  s_lshl_b32 s22, s20, 12
  s_add_u32 s21, s21, s22
  s_waitcnt lgkmcnt(0)
  s_mov_b32 s8, s6
  s_mov_b32 s9, s7
  s_mov_b32 s10, 268435456
  s_mov_b32 s11, 0x20000
  s_add_u32 s16, s21, 0
  buffer_load_dwordx4 v[16:19], v2, s[8:11], s16 offen
  s_add_u32 s16, s21, 2359296
  buffer_load_dwordx4 v[20:23], v2, s[8:11], s16 offen
  s_add_u32 s16, s21, 4718592
  buffer_load_dwordx4 v[24:27], v2, s[8:11], s16 offen
  s_add_u32 s16, s21, 7077888
  buffer_load_dwordx4 v[28:31], v2, s[8:11], s16 offen
  s_add_u32 s16, s21, 9437184
  buffer_load_dwordx4 v[32:35], v2, s[8:11], s16 offen
  s_add_u32 s16, s21, 11796480
  buffer_load_dwordx4 v[36:39], v2, s[8:11], s16 offen
  s_cmp_lg_u32 s20, 4
  s_cbranch_scc1 L_red_a
  s_add_u32 s16, s21, 14155776
  buffer_load_dwordx4 v[40:43], v2, s[8:11], s16 offen
  s_add_u32 s16, s21, 16515072
  buffer_load_dwordx4 v[44:47], v2, s[8:11], s16 offen
  s_add_u32 s16, s21, 18874368
  buffer_load_dwordx4 v[48:51], v2, s[8:11], s16 offen
  s_add_u32 s16, s21, 21233664
  buffer_load_dwordx4 v[52:55], v2, s[8:11], s16 offen
  s_add_u32 s16, s21, 23592960
  buffer_load_dwordx4 v[56:59], v2, s[8:11], s16 offen
  s_add_u32 s16, s21, 25952256
  buffer_load_dwordx4 v[60:63], v2, s[8:11], s16 offen
L_red_a:
  s_lshl_b32 s23, s17, 5
  v_add_u32 v6, s23, v6
  v_lshlrev_b32 v68, 16, v4
  v_lshl_add_u32 v68, v5, 14, v68
  v_lshl_add_u32 v68, v6, 1, v68
  s_lshl_b32 s24, s20, 18
  s_add_u32 s24, s24, 33554432
  s_add_u32 s25, s24, 0
  buffer_load_ushort v70, v68, s[8:11], s25 offen
  s_add_u32 s25, s24, 4096
  buffer_load_ushort v71, v68, s[8:11], s25 offen
  s_add_u32 s25, s24, 8192
  buffer_load_ushort v72, v68, s[8:11], s25 offen
  s_add_u32 s25, s24, 12288
  buffer_load_ushort v73, v68, s[8:11], s25 offen
  s_add_u32 s25, s24, 32768
  buffer_load_ushort v74, v68, s[8:11], s25 offen
  s_add_u32 s25, s24, 36864
  buffer_load_ushort v75, v68, s[8:11], s25 offen
  s_add_u32 s25, s24, 40960
  buffer_load_ushort v76, v68, s[8:11], s25 offen
  s_add_u32 s25, s24, 45056
  buffer_load_ushort v77, v68, s[8:11], s25 offen
  v_lshlrev_b32 v69, 2, v6
  s_mov_b32 s25, 37748736
  buffer_load_dword v69, v69, s[8:11], s25 offen
  s_mov_b32 s12, s4
  s_mov_b32 s13, s5
  s_mov_b32 s14, 2359296
  s_mov_b32 s15, 0x20000
  s_mov_b32 s28, 0x3f80
  s_mov_b32 s29, 0x3f800000
  v_mul_u32_u24 v7, 1152, v6
  v_lshl_add_u32 v7, v4, 5, v7
  v_lshl_add_u32 v7, v5, 4, v7
  s_lshl_b32 s22, s20, 7
  v_cmp_eq_u32 vcc, 1, v5
  s_waitcnt vmcnt(14)
  v_lshlrev_b32 v8, 16, v16
  v_and_b32 v9, 0xffff0000, v16
  v_lshlrev_b32 v10, 16, v17
  v_and_b32 v11, 0xffff0000, v17
  v_lshlrev_b32 v12, 16, v18
  v_and_b32 v13, 0xffff0000, v18
  v_lshlrev_b32 v14, 16, v19
  v_and_b32 v15, 0xffff0000, v19
  s_waitcnt vmcnt(13)
  v_dot2_f32_bf16 v8, v20, s28, v8
  v_dot2_f32_bf16 v9, v20, s29, v9
  v_dot2_f32_bf16 v10, v21, s28, v10
  v_dot2_f32_bf16 v11, v21, s29, v11
  v_dot2_f32_bf16 v12, v22, s28, v12
  v_dot2_f32_bf16 v13, v22, s29, v13
  v_dot2_f32_bf16 v14, v23, s28, v14
  v_dot2_f32_bf16 v15, v23, s29, v15
  s_waitcnt vmcnt(12)
  v_dot2_f32_bf16 v8, v24, s28, v8
  v_dot2_f32_bf16 v9, v24, s29, v9
  v_dot2_f32_bf16 v10, v25, s28, v10
  v_dot2_f32_bf16 v11, v25, s29, v11
  v_dot2_f32_bf16 v12, v26, s28, v12
  v_dot2_f32_bf16 v13, v26, s29, v13
  v_dot2_f32_bf16 v14, v27, s28, v14
  v_dot2_f32_bf16 v15, v27, s29, v15
  s_waitcnt vmcnt(11)
  v_dot2_f32_bf16 v8, v28, s28, v8
  v_dot2_f32_bf16 v9, v28, s29, v9
  v_dot2_f32_bf16 v10, v29, s28, v10
  v_dot2_f32_bf16 v11, v29, s29, v11
  v_dot2_f32_bf16 v12, v30, s28, v12
  v_dot2_f32_bf16 v13, v30, s29, v13
  v_dot2_f32_bf16 v14, v31, s28, v14
  v_dot2_f32_bf16 v15, v31, s29, v15
  s_waitcnt vmcnt(10)
  v_dot2_f32_bf16 v8, v32, s28, v8
  v_dot2_f32_bf16 v9, v32, s29, v9
  v_dot2_f32_bf16 v10, v33, s28, v10
  v_dot2_f32_bf16 v11, v33, s29, v11
  v_dot2_f32_bf16 v12, v34, s28, v12
  v_dot2_f32_bf16 v13, v34, s29, v13
  v_dot2_f32_bf16 v14, v35, s28, v14
  v_dot2_f32_bf16 v15, v35, s29, v15
  s_waitcnt vmcnt(9)
  v_dot2_f32_bf16 v8, v36, s28, v8
  v_dot2_f32_bf16 v9, v36, s29, v9
  v_dot2_f32_bf16 v10, v37, s28, v10
  v_dot2_f32_bf16 v11, v37, s29, v11
  v_dot2_f32_bf16 v12, v38, s28, v12
  v_dot2_f32_bf16 v13, v38, s29, v13
  v_dot2_f32_bf16 v14, v39, s28, v14
  v_dot2_f32_bf16 v15, v39, s29, v15
  s_cmp_lg_u32 s20, 4
  s_cbranch_scc1 L_red_b
  v_dot2_f32_bf16 v8, v40, s28, v8
  v_dot2_f32_bf16 v9, v40, s29, v9
  v_dot2_f32_bf16 v10, v41, s28, v10
  v_dot2_f32_bf16 v11, v41, s29, v11
  v_dot2_f32_bf16 v12, v42, s28, v12
  v_dot2_f32_bf16 v13, v42, s29, v13
  v_dot2_f32_bf16 v14, v43, s28, v14
  v_dot2_f32_bf16 v15, v43, s29, v15
  v_dot2_f32_bf16 v8, v44, s28, v8
  v_dot2_f32_bf16 v9, v44, s29, v9
  v_dot2_f32_bf16 v10, v45, s28, v10
  v_dot2_f32_bf16 v11, v45, s29, v11
  v_dot2_f32_bf16 v12, v46, s28, v12
  v_dot2_f32_bf16 v13, v46, s29, v13
  v_dot2_f32_bf16 v14, v47, s28, v14
  v_dot2_f32_bf16 v15, v47, s29, v15
  v_dot2_f32_bf16 v8, v48, s28, v8
  v_dot2_f32_bf16 v9, v48, s29, v9
  v_dot2_f32_bf16 v10, v49, s28, v10
  v_dot2_f32_bf16 v11, v49, s29, v11
  v_dot2_f32_bf16 v12, v50, s28, v12
  v_dot2_f32_bf16 v13, v50, s29, v13
  v_dot2_f32_bf16 v14, v51, s28, v14
  v_dot2_f32_bf16 v15, v51, s29, v15
  v_dot2_f32_bf16 v8, v52, s28, v8
  v_dot2_f32_bf16 v9, v52, s29, v9
  v_dot2_f32_bf16 v10, v53, s28, v10
  v_dot2_f32_bf16 v11, v53, s29, v11
  v_dot2_f32_bf16 v12, v54, s28, v12
  v_dot2_f32_bf16 v13, v54, s29, v13
  v_dot2_f32_bf16 v14, v55, s28, v14
  v_dot2_f32_bf16 v15, v55, s29, v15
  v_dot2_f32_bf16 v8, v56, s28, v8
  v_dot2_f32_bf16 v9, v56, s29, v9
  v_dot2_f32_bf16 v10, v57, s28, v10
  v_dot2_f32_bf16 v11, v57, s29, v11
  v_dot2_f32_bf16 v12, v58, s28, v12
  v_dot2_f32_bf16 v13, v58, s29, v13
  v_dot2_f32_bf16 v14, v59, s28, v14
  v_dot2_f32_bf16 v15, v59, s29, v15
  v_dot2_f32_bf16 v8, v60, s28, v8
  v_dot2_f32_bf16 v9, v60, s29, v9
  v_dot2_f32_bf16 v10, v61, s28, v10
  v_dot2_f32_bf16 v11, v61, s29, v11
  v_dot2_f32_bf16 v12, v62, s28, v12
  v_dot2_f32_bf16 v13, v62, s29, v13
  v_dot2_f32_bf16 v14, v63, s28, v14
  v_dot2_f32_bf16 v15, v63, s29, v15
L_red_b:
  s_waitcnt vmcnt(8)
  v_lshlrev_b32 v70, 16, v70
  s_waitcnt vmcnt(7)
  v_lshlrev_b32 v71, 16, v71
  s_waitcnt vmcnt(6)
  v_lshlrev_b32 v72, 16, v72
  s_waitcnt vmcnt(5)
  v_lshlrev_b32 v73, 16, v73
  s_waitcnt vmcnt(4)
  v_lshlrev_b32 v74, 16, v74
  s_waitcnt vmcnt(3)
  v_lshlrev_b32 v75, 16, v75
  s_waitcnt vmcnt(2)
  v_lshlrev_b32 v76, 16, v76
  s_waitcnt vmcnt(1)
  v_lshlrev_b32 v77, 16, v77
  v_sub_f32 v70, v70, v8
  v_sub_f32 v71, v71, v9
  v_sub_f32 v72, v72, v10
  v_sub_f32 v73, v73, v11
  v_sub_f32 v74, v74, v12
  v_sub_f32 v75, v75, v13
  v_sub_f32 v76, v76, v14
  v_sub_f32 v77, v77, v15
  s_waitcnt vmcnt(0)
  v_fmac_f32 v8, v70, v69
  v_fmac_f32 v9, v71, v69
  v_fmac_f32 v10, v72, v69
  v_fmac_f32 v11, v73, v69
  v_fmac_f32 v12, v74, v69
  v_fmac_f32 v13, v75, v69
  v_fmac_f32 v14, v76, v69
  v_fmac_f32 v15, v77, v69
  v_cvt_pk_bf16_f32 v64, v8, v9
  v_cvt_pk_bf16_f32 v65, v10, v11
  v_cvt_pk_bf16_f32 v66, v12, v13
  v_cvt_pk_bf16_f32 v67, v14, v15
  v_cndmask_b32 v16, v66, v64, vcc
  v_cndmask_b32 v17, v67, v65, vcc
  s_nop 0
  v_mov_b32_dpp v18, v16 row_ror:8 row_mask:0xf bank_mask:0xf
  v_mov_b32_dpp v19, v17 row_ror:8 row_mask:0xf bank_mask:0xf
  v_cndmask_b32 v20, v64, v18, vcc
  v_cndmask_b32 v21, v65, v19, vcc
  v_cndmask_b32 v22, v18, v66, vcc
  v_cndmask_b32 v23, v19, v67, vcc
  buffer_store_dwordx4 v[20:23], v7, s[12:15], s22 offen sc1
L_red_end:
  s_endpgm
.section .rodata,"a"
.p2align 6
.amdhsa_kernel main_kernel
  .amdhsa_next_free_vgpr 256
  .amdhsa_next_free_sgpr 102
  .amdhsa_accum_offset 96
  .amdhsa_group_segment_fixed_size 0
  .amdhsa_kernarg_size 120
  .amdhsa_user_sgpr_count 2
  .amdhsa_user_sgpr_kernarg_segment_ptr 1
  .amdhsa_system_sgpr_workgroup_id_x 1
.end_amdhsa_kernel
.p2align 6
.amdhsa_kernel red_kernel
  .amdhsa_next_free_vgpr 80
  .amdhsa_next_free_sgpr 102
  .amdhsa_accum_offset 80
  .amdhsa_group_segment_fixed_size 0
  .amdhsa_kernarg_size 120
  .amdhsa_user_sgpr_count 2
  .amdhsa_user_sgpr_kernarg_segment_ptr 1
  .amdhsa_system_sgpr_workgroup_id_x 1
.end_amdhsa_kernel
```
